```python
import torch

def _softmax(x, axis=-1):
    return torch.softmax(x, dim=axis)
def _gelu(x):
    return torch.nn.functional.gelu(x, approximate="tanh")
def _silu(x):
    return torch.nn.functional.silu(x)
def _sigmoid(x):
    return torch.sigmoid(x)
def _layernorm(x, axis=-1, eps=1e-5):
    m = x.mean(dim=axis, keepdim=True)
    v = x.var(dim=axis, keepdim=True, unbiased=False)
    return (x - m) / torch.sqrt(v + eps)
def _scatter_add(tgt, idx, src, axis=0):
    return tgt.clone().index_add_(axis, idx, src)
def _segment_sum(src, seg, n):
    out = torch.zeros((n,) + src.shape[1:], dtype=src.dtype)
    return out.index_add_(0, seg, src)
def _pad(x, pw):
    flat = tuple(v for pair in reversed(pw) for v in pair)
    return torch.nn.functional.pad(x, flat)

kernel_name = 'interleave_layers__linear_attn_block__geglu_ffn__prompt'

def setup_inputs():

    _w = (lambda a: (lambda t: t.to(torch.bfloat16) if t.is_floating_point() else t)(torch.as_tensor(a)))
    def _A_setup():
        B, S, D = 1, 2048, 640
        return {
            "x": _w((lambda *s: torch.randn(*s, dtype=torch.bfloat16) * 0.05)(B, S, D)),
            "wqkv": _w((lambda *s: torch.randn(*s, dtype=torch.bfloat16) * 0.05)(D, 3 * D)),
            "wo": _w((lambda *s: torch.randn(*s, dtype=torch.bfloat16) * 0.05)(D, D)),
        }
    _A_in = _A_setup()

    def _B_setup():
        B, S, D, F = 1, 2048, 640, 1536
        return {
            "x": _w((lambda *s: torch.randn(*s, dtype=torch.bfloat16) * 0.05)(B, S, D)),
            "w_gate": _w((lambda *s: torch.randn(*s, dtype=torch.bfloat16) * 0.05)(D, F)),
            "w_up": _w((lambda *s: torch.randn(*s, dtype=torch.bfloat16) * 0.05)(D, F)),
            "w_down": _w((lambda *s: torch.randn(*s, dtype=torch.bfloat16) * 0.05)(F, D)),
        }
    _B_in = _B_setup()

    return {
        "A_x": _A_in["x"],
        "A_wqkv": _A_in["wqkv"],
        "A_wo": _A_in["wo"],
        "B_x": _B_in["x"],
        "B_w_gate": _B_in["w_gate"],
        "B_w_up": _B_in["w_up"],
        "B_w_down": _B_in["w_down"],
    }

def reference(A_x, A_wqkv, A_wo, B_x, B_w_gate, B_w_up, B_w_down):
    def _A_ref(x, wqkv, wo):
        B, S, D = x.shape
        H = 32; Dh = D // H
        qkv = (lambda x, *d: x.permute(*d))((x @ wqkv).reshape(B, S, 3, H, Dh), 2, 0, 3, 1, 4)
        q, k, v = qkv[0], qkv[1], qkv[2]
        phi = lambda t: torch.where(t > 0, t + 1, torch.exp(t)) + 1e-6
        pq, pk = phi(q), phi(k)
        kv = torch.einsum("bhsd,bhse->bhde", pk, v)
        z = torch.einsum("bhsd->bhd", pk)
        num = torch.einsum("bhqd,bhde->bhqe", pq, kv)
        den = torch.einsum("bhqd,bhd->bhq", pq, z)[..., None] + 1e-6
        o = num / den
        return (lambda x, *d: x.permute(*d))(o, 0, 2, 1, 3).reshape(B, S, D) @ wo

    def _B_ref(x, w_gate, w_up, w_down):
        return (_gelu(x @ w_gate) * (x @ w_up)) @ w_down

    x = A_x
    x = x + _A_ref(_layernorm(x, axis=-1), A_wqkv, A_wo)
    x = x + _B_ref(_layernorm(x, axis=-1), B_w_gate, B_w_up, B_w_down)
    x = x + _A_ref(_layernorm(x, axis=-1), A_wqkv, A_wo)
    x = x + _B_ref(_layernorm(x, axis=-1), B_w_gate, B_w_up, B_w_down)
    return x
```

```asm
; @launch grid=(256,1,1) block=(256,1,1) lds=163840
.amdgcn_target "amdgcn-amd-amdhsa--gfx950"
.text
.globl interleave_layers__linear_attn_block__geglu_ffn__prompt_kernel
.p2align 8
.type interleave_layers__linear_attn_block__geglu_ffn__prompt_kernel,@function
interleave_layers__linear_attn_block__geglu_ffn__prompt_kernel:
    s_cmp_ge_u32 s2, 256
    s_cbranch_scc1 interleave_layers__linear_attn_block__geglu_ffn__prompt_kernel_end
    s_load_dwordx16 s[56:71], s[0:1], 0
    s_load_dwordx4 s[48:51], s[0:1], 64
    s_memrealtime s[94:95]
    s_getpc_b64 s[76:77]
    s_and_b32 s76, s76, 0xffffff00
    s_mov_b32 s78, interleave_layers__linear_attn_block__geglu_ffn__prompt_kernel_end-interleave_layers__linear_attn_block__geglu_ffn__prompt_kernel
    s_mov_b32 s79, 0x20000
    s_lshr_b32 s55, s2, 3
    s_and_b32 s55, s55, 7
    s_mul_i32 s55, s55, 6144
    v_lshlrev_b32 v40, 7, v0
    v_cmp_gt_u32 vcc, 48, v0
    s_nop 1
    s_mov_b64 exec, vcc
    s_cbranch_execz interleave_layers__linear_attn_block__geglu_ffn__prompt_kernel_pf1
    buffer_load_dword v40, v40, s[76:79], s55 offen
interleave_layers__linear_attn_block__geglu_ffn__prompt_kernel_pf1:
    s_mov_b64 exec, -1
    s_and_b32 s12, s2, 7
    s_lshl_b32 s12, s12, 1
    s_lshr_b32 s55, s2, 7
    s_add_u32 s12, s12, s55
    s_lshr_b32 s13, s2, 3
    s_and_b32 s13, s13, 15
    v_lshrrev_b32 v41, 6, v0
    v_lshlrev_b32 v29, 4, v0
    v_readfirstlane_b32 s14, v41
    v_mov_b32 v43, v0
    v_and_b32 v1, 63, v0
    v_lshlrev_b32 v0, 4, v1
    s_lshr_b32 s15, s13, 3
    s_and_b32 s16, s13, 7
    s_lshl_b32 s73, s14, 12
    v_and_b32 v48, 31, v1
    v_lshrrev_b32 v49, 5, v1
    v_and_b32 v50, 15, v1
    v_lshrrev_b32 v51, 4, v1
    v_mov_b32 v52, 0x40000000
    v_and_b32 v44, 7, v1
    s_lshl_b32 s55, s14, 3
    v_add_u32 v44, s55, v44
    v_lshrrev_b32 v45, 3, v1
    v_mul_u32_u24 v45, 3840, v45
    v_lshl_add_u32 v45, v44, 4, v45
    v_add_u32 v46, 1280, v45
    v_add_u32 v47, 2480, v45
    v_cmp_lt_u32 vcc, 4, v44
    s_nop 1
    v_cndmask_b32 v46, v46, v47, vcc
    v_subrev_u32 v47, 160, v45
    v_cmp_lt_u32 vcc, 9, v44
    s_nop 1
    v_cndmask_b32 v46, v46, v47, vcc
    v_cmp_gt_u32 vcc, 15, v44
    s_nop 1
    v_cndmask_b32 v56, v52, v46, vcc
    v_and_b32 v88, 7, v1
    v_lshrrev_b32 v89, 3, v1
    v_mul_u32_u24 v90, 1280, v88
    v_lshl_add_u32 v90, v89, 4, v90
    s_mul_i32 s52, s12, 153600
    s_mul_i32 s55, s13, 80
    s_add_u32 s52, s52, s55
    s_mul_i32 s53, s12, 163840
    s_mul_i32 s55, s13, 10240
    s_add_u32 s53, s53, s55
    s_mul_i32 s55, s14, 640
    s_add_u32 s53, s53, s55
    s_add_u32 s53, s53, 4294966016
    s_mul_i32 s55, s14, 5120
    s_add_u32 m0, s55, 153600
    s_waitcnt lgkmcnt(0)
    s_mov_b32 s44, s58
    s_mov_b32 s45, s59
    s_mov_b32 s46, 2457600
    s_mov_b32 s47, 0x20000
    s_mov_b32 s4, s50
    s_mov_b32 s5, s51
    s_mov_b32 s6, 268435456
    s_mov_b32 s7, 0x20000
    s_mov_b32 s96, s48
    s_mov_b32 s97, s49
    s_mov_b32 s98, 256
    s_mov_b32 s99, 0x20000
    s_add_u32 s55, s2, s14
    s_cmp_lg_u32 s55, 0
    s_cbranch_scc1 interleave_layers__linear_attn_block__geglu_ffn__prompt_kernel_nn2
    s_lshl_b32 s55, s94, 4
    s_or_b32 s55, s55, 1
    v_mov_b32 v44, s55
    v_mov_b32 v45, 0
    s_mov_b64 exec, 1
    buffer_store_dword v44, v45, s[96:99], 0 offen sc1
    s_mov_b64 exec, -1
interleave_layers__linear_attn_block__geglu_ffn__prompt_kernel_nn2:
    s_mov_b32 s76, s56
    s_mov_b32 s77, s57
    s_mov_b32 s78, 2621440
    s_mov_b32 s79, 0x20000
    s_cmp_lt_u32 s14, 2
    s_cbranch_scc1 interleave_layers__linear_attn_block__geglu_ffn__prompt_kernel_nx3
    buffer_load_dwordx4 v[68:71], v90, s[76:79], s53 offen offset:0
    buffer_load_dwordx4 v[72:75], v90, s[76:79], s53 offen offset:128
    buffer_load_dwordx4 v[76:79], v90, s[76:79], s53 offen offset:256
    buffer_load_dwordx4 v[80:83], v90, s[76:79], s53 offen offset:384
    buffer_load_dwordx4 v[84:87], v90, s[76:79], s53 offen offset:512
    s_branch interleave_layers__linear_attn_block__geglu_ffn__prompt_kernel_ny4
interleave_layers__linear_attn_block__geglu_ffn__prompt_kernel_nx3:
    buffer_load_dwordx4 v56, s[44:47], s52 offen nt lds
    s_add_u32 m0, m0, 1024
    s_add_u32 s52, s52, 30720
    buffer_load_dwordx4 v56, s[44:47], s52 offen nt lds
    s_add_u32 m0, m0, 1024
    s_add_u32 s52, s52, 30720
    buffer_load_dwordx4 v56, s[44:47], s52 offen nt lds
    s_add_u32 m0, m0, 1024
    s_add_u32 s52, s52, 30720
    buffer_load_dwordx4 v56, s[44:47], s52 offen nt lds
    s_add_u32 m0, m0, 1024
    s_add_u32 s52, s52, 30720
    buffer_load_dwordx4 v56, s[44:47], s52 offen nt lds
    s_add_u32 m0, m0, 1024
    s_add_u32 s52, s52, 30720
interleave_layers__linear_attn_block__geglu_ffn__prompt_kernel_ny4:
    s_cmp_lt_u32 s12, 8
    s_cselect_b32 s82, s64, s66
    s_cselect_b32 s83, s65, s67
    s_mov_b64 s[84:85], s[60:61]
    s_mov_b64 s[90:91], s[68:69]
    s_mov_b64 s[86:87], s[56:57]
    s_lshl_b32 s88, s15, 4
    s_add_u32 s88, s88, s12
    s_mul_i32 s39, s88, 5
    s_lshr_b32 s39, s39, 1
    v_add_u32 v44, 0, v43
    v_mul_u32_u24 v45, 5462, v44
    v_lshrrev_b32 v45, 16, v45
    v_mul_u32_u24 v46, 12, v45
    v_sub_u32 v46, v44, v46
    v_mul_u32_u24 v45, 3072, v45
    v_lshl_add_u32 v59, v46, 4, v45
    v_add_u32 v44, 256, v43
    v_mul_u32_u24 v45, 5462, v44
    v_lshrrev_b32 v45, 16, v45
    v_mul_u32_u24 v46, 12, v45
    v_sub_u32 v46, v44, v46
    v_mul_u32_u24 v45, 3072, v45
    v_lshl_add_u32 v60, v46, 4, v45
    v_add_u32 v44, 512, v43
    v_mul_u32_u24 v45, 5462, v44
    v_lshrrev_b32 v45, 16, v45
    v_mul_u32_u24 v46, 12, v45
    v_sub_u32 v46, v44, v46
    v_mul_u32_u24 v45, 3072, v45
    v_lshl_add_u32 v61, v46, 4, v45
    v_add_u32 v44, 768, v43
    v_mul_u32_u24 v45, 5462, v44
    v_lshrrev_b32 v45, 16, v45
    v_mul_u32_u24 v46, 12, v45
    v_sub_u32 v46, v44, v46
    v_mul_u32_u24 v45, 3072, v45
    v_lshl_add_u32 v62, v46, 4, v45
    v_cmp_gt_u32 vcc, 960, v44
    s_nop 1
    v_cndmask_b32 v62, v52, v62, vcc
    v_add_u32 v44, 0, v43
    v_mul_u32_u24 v45, 6554, v44
    v_lshrrev_b32 v45, 16, v45
    v_mul_u32_u24 v46, 10, v45
    v_sub_u32 v46, v44, v46
    v_mul_u32_u24 v45, 1280, v45
    v_lshl_add_u32 v63, v46, 4, v45
    v_cmp_gt_u32 vcc, 240, v44
    s_nop 1
    v_cndmask_b32 v63, v52, v63, vcc
    v_add_u32 v44, 0, v43
    v_mul_u32_u24 v45, 6554, v44
    v_lshrrev_b32 v45, 16, v45
    v_mul_u32_u24 v46, 10, v45
    v_sub_u32 v46, v44, v46
    v_mul_u32_u24 v45, 1280, v45
    v_lshl_add_u32 v64, v46, 4, v45
    v_add_u32 v44, 256, v43
    v_mul_u32_u24 v45, 6554, v44
    v_lshrrev_b32 v45, 16, v45
    v_mul_u32_u24 v46, 10, v45
    v_sub_u32 v46, v44, v46
    v_mul_u32_u24 v45, 1280, v45
    v_lshl_add_u32 v65, v46, 4, v45
    v_cmp_gt_u32 vcc, 480, v44
    s_nop 1
    v_cndmask_b32 v65, v52, v65, vcc
    s_mov_b32 s8, s70
    s_mov_b32 s9, s71
    s_mov_b32 s10, 2621440
    s_mov_b32 s11, 0x20000
    s_mov_b32 s44, s4
    s_mov_b32 s45, s5
    s_mov_b32 s46, 268435456
    s_mov_b32 s47, 0x20000
    s_mul_i32 s20, s13, 163840
    s_mul_i32 s55, s14, 4096
    s_add_u32 s20, s20, s55
    s_add_u32 s20, s20, 3145728
    s_mul_i32 s24, s12, 163840
    s_mul_i32 s55, s14, 40960
    s_add_u32 s24, s24, s55
    s_add_u32 s24, s24, 12582912
    s_mul_i32 s26, s12, 8192
    s_mul_i32 s55, s14, 512
    s_add_u32 s26, s26, s55
    s_add_u32 s26, s26, 2490368
    s_mul_i32 s21, s13, 245760
    s_mul_i32 s55, s14, 4096
    s_add_u32 s21, s21, s55
    s_add_u32 s21, s21, 5767168
    s_mul_i32 s22, s16, 102400
    s_mul_i32 s55, s14, 25600
    s_add_u32 s22, s22, s55
    s_add_u32 s22, s22, 9699328
    s_mul_i32 s23, s16, 245760
    s_mul_i32 s55, s14, 61440
    s_add_u32 s23, s23, s55
    s_add_u32 s23, s23, 10551296
    s_mul_i32 s25, s12, 163840
    s_mul_i32 s55, s15, 81920
    s_add_u32 s25, s25, s55
    s_mul_i32 s55, s14, 20480
    s_add_u32 s25, s25, s55
    s_mul_i32 s55, s16, 1024
    s_add_u32 s25, s25, s55
    s_add_u32 s25, s25, 12582912
    s_mul_i32 s66, s12, 163840
    s_mul_i32 s55, s15, 81920
    s_add_u32 s66, s66, s55
    s_mul_i32 s55, s14, 20480
    s_add_u32 s66, s66, s55
    s_mul_i32 s55, s16, 1536
    s_add_u32 s66, s66, s55
    s_add_u32 s66, s66, 12591104
    s_lshr_b32 s48, s16, 1
    s_and_b32 s49, s16, 1
    s_mul_i32 s27, s12, 8192
    s_mul_i32 s55, s48, 2048
    s_add_u32 s27, s27, s55
    s_mul_i32 s55, s49, 8
    s_add_u32 s27, s27, s55
    s_mul_i32 s55, s15, 1024
    s_add_u32 s27, s27, s55
    s_mul_i32 s55, s14, 256
    s_add_u32 s27, s27, s55
    s_add_u32 s27, s27, 2490368
    s_mul_i32 s28, s12, 163840
    s_mul_i32 s55, s14, 40960
    s_add_u32 s28, s28, s55
    s_mul_i32 s55, s13, 1280
    s_add_u32 s28, s28, s55
    s_add_u32 s28, s28, 23068672
    s_mul_i32 s33, s12, 393216
    s_mul_i32 s55, s14, 98304
    s_add_u32 s33, s33, s55
    s_mul_i32 s55, s13, 3072
    s_add_u32 s33, s33, s55
    s_add_u32 s33, s33, 28311552
    s_add_u32 s48, s14, 1
    s_and_b32 s48, s48, 3
    s_mul_i32 s29, s12, 163840
    s_mul_i32 s55, s15, 81920
    s_add_u32 s29, s29, s55
    s_mul_i32 s55, s48, 20480
    s_add_u32 s29, s29, s55
    s_mul_i32 s55, s14, 5120
    s_add_u32 s29, s29, s55
    s_add_u32 s29, s29, 23068672
    s_mul_i32 s34, s12, 393216
    s_mul_i32 s55, s15, 196608
    s_add_u32 s34, s34, s55
    s_mul_i32 s55, s48, 49152
    s_add_u32 s34, s34, s55
    s_mul_i32 s55, s14, 12288
    s_add_u32 s34, s34, s55
    s_add_u32 s34, s34, 28311552
    s_mul_i32 s56, s48, 16384
    s_cmp_eq_u32 s48, 3
    s_cselect_b32 s56, 131072, s56
    s_add_u32 s48, s14, 2
    s_and_b32 s48, s48, 3
    s_mul_i32 s30, s12, 163840
    s_mul_i32 s55, s15, 81920
    s_add_u32 s30, s30, s55
    s_mul_i32 s55, s48, 20480
    s_add_u32 s30, s30, s55
    s_mul_i32 s55, s14, 5120
    s_add_u32 s30, s30, s55
    s_add_u32 s30, s30, 23068672
    s_mul_i32 s35, s12, 393216
    s_mul_i32 s55, s15, 196608
    s_add_u32 s35, s35, s55
    s_mul_i32 s55, s48, 49152
    s_add_u32 s35, s35, s55
    s_mul_i32 s55, s14, 12288
    s_add_u32 s35, s35, s55
    s_add_u32 s35, s35, 28311552
    s_mul_i32 s57, s48, 16384
    s_add_u32 s57, s57, 5120
    s_cmp_eq_u32 s48, 3
    s_cselect_b32 s57, 136192, s57
    s_add_u32 s48, s14, 3
    s_and_b32 s48, s48, 3
    s_mul_i32 s31, s12, 163840
    s_mul_i32 s55, s15, 81920
    s_add_u32 s31, s31, s55
    s_mul_i32 s55, s48, 20480
    s_add_u32 s31, s31, s55
    s_mul_i32 s55, s14, 5120
    s_add_u32 s31, s31, s55
    s_add_u32 s31, s31, 23068672
    s_mul_i32 s36, s12, 393216
    s_mul_i32 s55, s15, 196608
    s_add_u32 s36, s36, s55
    s_mul_i32 s55, s48, 49152
    s_add_u32 s36, s36, s55
    s_mul_i32 s55, s14, 12288
    s_add_u32 s36, s36, s55
    s_add_u32 s36, s36, 28311552
    s_mul_i32 s58, s48, 16384
    s_add_u32 s58, s58, 10240
    s_cmp_eq_u32 s48, 3
    s_cselect_b32 s58, 141312, s58
    s_add_u32 s48, s14, 4
    s_and_b32 s48, s48, 3
    s_mul_i32 s32, s12, 163840
    s_mul_i32 s55, s15, 81920
    s_add_u32 s32, s32, s55
    s_mul_i32 s55, s48, 20480
    s_add_u32 s32, s32, s55
    s_mul_i32 s55, s14, 5120
    s_add_u32 s32, s32, s55
    s_add_u32 s32, s32, 23068672
    s_mul_i32 s37, s12, 393216
    s_mul_i32 s55, s15, 196608
    s_add_u32 s37, s37, s55
    s_mul_i32 s55, s48, 49152
    s_add_u32 s37, s37, s55
    s_mul_i32 s55, s14, 12288
    s_add_u32 s37, s37, s55
    s_add_u32 s37, s37, 28311552
    s_mul_i32 s59, s48, 16384
    s_cmp_eq_u32 s48, 3
    s_cselect_b32 s59, 131072, s59
    s_mul_i32 s38, s13, 4096
    s_add_u32 s38, s38, 458752
    s_mul_i32 s40, s12, 256
    s_mul_i32 s55, s13, 16
    s_add_u32 s40, s40, s55
    s_mul_i32 s55, s14, 4
    s_add_u32 s40, s40, s55
    s_mul_i32 s41, s12, 256
    s_mul_i32 s42, s12, 16
    s_mul_i32 s55, s14, 4
    s_add_u32 s42, s42, s55
    s_add_u32 s42, s42, 8192
    s_mul_i32 s43, s13, 8192
    s_mul_i32 s55, s12, 512
    s_add_u32 s43, s43, s55
    s_add_u32 s43, s43, 8192
    s_xor_b32 s48, s13, 8
    s_lshl_b32 s48, s48, 13
    s_add_u32 s48, s48, 256
    s_lshl_b32 s49, s13, 13
    v_mov_b32 v44, s48
    v_mov_b32 v45, s49
    v_cmp_gt_u32 vcc, 16, v1
    s_nop 1
    v_cndmask_b32 v44, v44, v45, vcc
    v_lshl_add_u32 v39, v50, 9, v44
    s_lshl_b32 s48, s15, 1
    s_lshl_b32 s49, s14, 4
    s_add_u32 s48, s48, s49
    s_mov_b64 s[68:69], 0x3333
    s_lshl_b64 s[68:69], s[68:69], s48
    s_and_b32 s48, s14, 1
    s_lshl_b32 s48, s48, 1
    s_lshr_b32 s49, s14, 1
    s_lshl_b32 s49, s49, 5
    s_add_u32 s48, s48, s49
    s_mov_b64 s[70:71], 0x33333333
    s_lshl_b64 s[70:71], s[70:71], s48
    s_lshl_b32 s74, s2, 11
    s_lshl_b32 s48, s14, 9
    s_add_u32 s74, s74, s48
    s_add_u32 s74, s74, 41943040
    s_mov_b32 s17, 0
    s_mov_b32 s18, 0
    s_mov_b32 s60, 0x3fb8aa3b
    s_mov_b32 s61, 0x3fb8aa3b
    s_mov_b32 s62, 0x358637bd
    s_mov_b32 s63, 0x358637bd
    v_mov_b32 v37, 0xb5c1a2a0
    s_mov_b32 s64, 0x11111111
    s_mov_b32 s65, 0x11111111
    v_mul_u32_u24 v44, 205, v43
    v_lshrrev_b32 v44, 10, v44
    v_mul_u32_u24 v45, 5, v44
    v_sub_u32 v45, v43, v45
    v_cmp_lt_u32 vcc, 20, v44
    s_nop 1
    v_cndmask_b32 v46, 8, 24, vcc
    v_cmp_eq_u32 vcc, 4, v45
    v_lshlrev_b32 v45, 4, v45
    s_nop 0
    v_cndmask_b32 v45, v45, v46, vcc
    v_lshl_add_u32 v30, v44, 6, v45
    v_add_u32 v30, 148736, v30
    v_add_u32 v2, 0x10000, v0
    v_add_u32 v3, 0x20000, v0
    v_add_u32 v14, 20480, v0
    v_lshlrev_b32 v44, 4, v50
    v_lshl_add_u32 v15, v49, 8, v44
    v_and_b32 v45, 1, v51
    v_lshl_add_u32 v15, v45, 3, v15
    v_lshlrev_b32 v16, 4, v50
    v_lshl_add_u32 v16, v51, 11, v16
    s_mul_i32 s48, s14, 3360
    s_add_u32 s48, s48, 15744
    v_lshlrev_b32 v47, 4, v51
    v_mul_u32_u24 v44, 80, v50
    v_add3_u32 v17, v44, v47, s48
    v_and_b32 v44, 12, v50
    v_add_u32 v44, v44, v50
    v_add_u32 v45, 1, v44
    v_cmp_gt_u32 vcc, 20, v44
    s_nop 1
    v_cndmask_b32 v18, 52, v44, vcc
    v_cndmask_b32 v19, v45, 52, vcc
    v_add_u32 v44, 4, v44
    v_add_u32 v45, 1, v44
    v_cmp_gt_u32 vcc, 20, v44
    s_nop 1
    v_cndmask_b32 v20, 52, v44, vcc
    v_cndmask_b32 v21, v45, 52, vcc
    v_add_u32 v45, 33, v50
    v_cmp_gt_u32 vcc, 8, v50
    s_nop 1
    v_cndmask_b32 v22, 52, v45, vcc
    v_and_b32 v54, 3, v50
    v_lshrrev_b32 v53, 2, v50
    v_cmp_eq_u32 vcc, 0, v54
    s_nop 1
    v_cndmask_b32 v23, 52, 20, vcc
    v_cmp_eq_u32 vcc, 1, v54
    s_nop 1
    v_cndmask_b32 v24, 52, 41, vcc
    v_add_u32 v45, 148736, v47
    v_lshl_add_u32 v18, v18, 6, v45
    v_lshl_add_u32 v19, v19, 6, v45
    v_lshl_add_u32 v20, v20, 6, v45
    v_lshl_add_u32 v21, v21, 6, v45
    v_lshl_add_u32 v22, v22, 6, v45
    v_lshl_add_u32 v23, v23, 6, v45
    v_lshl_add_u32 v24, v24, 6, v45
    s_lshl_b32 s48, s14, 8
    s_add_u32 s48, s48, 152128
    v_lshlrev_b32 v31, 2, v1
    v_add_u32 v25, s48, v31
    v_add_u32 v26, s48, v47
    v_add_u32 v28, 147456, v47
    v_lshlrev_b32 v27, 2, v50
    v_add_u32 v27, 147456, v27
    v_mov_b32 v32, 0x3f803f80
    v_lshlrev_b32 v44, 7, v48
    s_mul_i32 s48, s16, 512
    s_add_u32 s48, s48, 7168
    v_add_u32 v45, s48, v44
    v_cmp_gt_u32 vcc, 8, v1
    s_nop 1
    v_cndmask_b32 v45, v45, v44, vcc
    v_cmp_gt_u32 vcc, 20, v1
    s_nop 1
    v_cndmask_b32 v33, v52, v45, vcc
    v_mul_u32_u24 v45, 20480, v49
    v_add_u32 v34, v44, v45
    v_cmp_gt_u32 vcc, 10, v48
    s_nop 1
    v_cndmask_b32 v34, v52, v34, vcc
    v_mul_u32_u24 v45, 49152, v49
    v_add_u32 v35, v44, v45
    v_cmp_gt_u32 vcc, 24, v48
    s_nop 1
    v_cndmask_b32 v35, v52, v35, vcc
    v_mov_b32 v96, 0
    v_mov_b32 v97, 0
    v_mov_b32 v98, 0
    v_mov_b32 v99, 0
    v_add_u32 v44, 147456, v29
    ds_write_b128 v44, v[96:99]
    ds_write_b128 v44, v[96:99] offset:576
    s_and_b32 s48, s14, 1
    s_lshl_b32 s48, s48, 2
    v_add_u32 v44, s48, v51
    v_lshlrev_b32 v45, 2, v54
    v_lshl_add_u32 v46, v51, 4, v45
    v_add_u32 v47, 36, v45
    v_cmp_eq_u32 vcc, 6, v44
    s_nop 1
    v_cndmask_b32 v46, v46, v47, vcc
    v_mul_u32_u24 v47, 20, v54
    v_min_u32 v47, 20, v47
    v_add_u32 v47, 32, v47
    v_cmp_eq_u32 vcc, 7, v44
    s_nop 1
    v_cndmask_b32 v46, v46, v47, vcc
    v_lshlrev_b32 v47, 7, v53
    v_lshl_add_u32 v100, v46, 1, v47
    s_mul_i32 s49, s14, 5120
    s_add_u32 s49, s49, 153600
    v_add_u32 v100, s49, v100
    v_add_u32 v45, 95, v44
    v_cmp_gt_u32 vcc, 5, v44
    s_nop 1
    v_cndmask_b32 v45, v45, v44, vcc
    v_cndmask_b32 v102, 3, 5, vcc
    v_lshlrev_b32 v102, 10, v102
    v_lshlrev_b32 v46, 4, v50
    v_lshl_add_u32 v101, v45, 10, v46
    s_cmp_eq_u32 s14, 1
    s_cselect_b32 s93, 0xff000000, 0
    s_mov_b32 s92, 0
    v_mov_b32 v103, 0
    s_mul_i32 s53, s12, 5
    s_mul_i32 s55, s53, 205
    s_lshr_b32 s55, s55, 11
    s_mul_i32 s49, s55, 10
    s_sub_u32 s49, s53, s49
    s_cmp_lt_u32 s49, 4
    s_cselect_b32 s48, 4, 6
    s_mul_i32 s55, s55, s48
    s_cselect_b32 s48, 0, 28
    s_add_u32 s48, s48, s55
    s_add_u32 s48, s48, s49
    s_and_b32 s49, s48, 3
    s_lshr_b32 s48, s48, 2
    s_lshl_b32 s49, s49, 8
    v_mad_u32_u24 v112, v102, s48, v101
    v_add_u32 v112, s49, v112
    s_add_u32 s53, s53, 1
    s_mul_i32 s55, s53, 205
    s_lshr_b32 s55, s55, 11
    s_mul_i32 s49, s55, 10
    s_sub_u32 s49, s53, s49
    s_cmp_lt_u32 s49, 4
    s_cselect_b32 s48, 4, 6
    s_mul_i32 s55, s55, s48
    s_cselect_b32 s48, 0, 28
    s_add_u32 s48, s48, s55
    s_add_u32 s48, s48, s49
    s_and_b32 s49, s48, 3
    s_lshr_b32 s48, s48, 2
    s_lshl_b32 s49, s49, 8
    v_mad_u32_u24 v113, v102, s48, v101
    v_add_u32 v113, s49, v113
    s_add_u32 s53, s53, 1
    s_mul_i32 s55, s53, 205
    s_lshr_b32 s55, s55, 11
    s_mul_i32 s49, s55, 10
    s_sub_u32 s49, s53, s49
    s_cmp_lt_u32 s49, 4
    s_cselect_b32 s48, 4, 6
    s_mul_i32 s55, s55, s48
    s_cselect_b32 s48, 0, 28
    s_add_u32 s48, s48, s55
    s_add_u32 s48, s48, s49
    s_and_b32 s49, s48, 3
    s_lshr_b32 s48, s48, 2
    s_lshl_b32 s49, s49, 8
    v_mad_u32_u24 v114, v102, s48, v101
    v_add_u32 v114, s49, v114
    s_add_u32 s53, s53, 1
    s_mul_i32 s55, s53, 205
    s_lshr_b32 s55, s55, 11
    s_mul_i32 s49, s55, 10
    s_sub_u32 s49, s53, s49
    s_cmp_lt_u32 s49, 4
    s_cselect_b32 s48, 4, 6
    s_mul_i32 s55, s55, s48
    s_cselect_b32 s48, 0, 28
    s_add_u32 s48, s48, s55
    s_add_u32 s48, s48, s49
    s_and_b32 s49, s48, 3
    s_lshr_b32 s48, s48, 2
    s_lshl_b32 s49, s49, 8
    v_mad_u32_u24 v115, v102, s48, v101
    v_add_u32 v115, s49, v115
    s_add_u32 s53, s53, 1
    s_mul_i32 s55, s53, 205
    s_lshr_b32 s55, s55, 11
    s_mul_i32 s49, s55, 10
    s_sub_u32 s49, s53, s49
    s_cmp_lt_u32 s49, 4
    s_cselect_b32 s48, 4, 6
    s_mul_i32 s55, s55, s48
    s_cselect_b32 s48, 0, 28
    s_add_u32 s48, s48, s55
    s_add_u32 s48, s48, s49
    s_and_b32 s49, s48, 3
    s_lshr_b32 s48, s48, 2
    s_lshl_b32 s49, s49, 8
    v_mad_u32_u24 v116, v102, s48, v101
    v_add_u32 v116, s49, v116
    s_add_u32 s53, s53, 1
    v_lshrrev_b32 v44, 3, v1
    v_and_b32 v45, 7, v1
    v_xor_b32 v45, v45, v44
    v_mul_u32_u24 v44, 1280, v44
    v_lshl_add_u32 v104, v45, 4, v44
    s_mul_i32 s0, s14, 20480
    s_add_u32 s0, s0, 32768
    v_and_b32 v46, 7, v50
    v_lshlrev_b32 v47, 7, v50
    v_add_u32 v47, s0, v47
    v_mul_u32_u24 v44, 0, v49
    v_add3_u32 v44, v44, v51, 0
    v_lshrrev_b32 v45, 3, v44
    v_and_b32 v44, 7, v44
    v_xor_b32 v44, v44, v46
    v_lshl_add_u32 v44, v44, 4, v47
    v_lshl_add_u32 v105, v45, 12, v44
    v_mul_u32_u24 v44, 0, v49
    v_add3_u32 v44, v44, v51, 4
    v_lshrrev_b32 v45, 3, v44
    v_and_b32 v44, 7, v44
    v_xor_b32 v44, v44, v46
    v_lshl_add_u32 v44, v44, 4, v47
    v_lshl_add_u32 v106, v45, 12, v44
    v_mul_u32_u24 v44, 4, v49
    v_add3_u32 v44, v44, v51, 0
    v_lshrrev_b32 v45, 3, v44
    v_and_b32 v44, 7, v44
    v_xor_b32 v44, v44, v46
    v_lshl_add_u32 v44, v44, 4, v47
    v_lshl_add_u32 v107, v45, 12, v44
    v_mul_u32_u24 v44, 0, v49
    v_add3_u32 v44, v44, v51, 2
    v_lshrrev_b32 v45, 3, v44
    v_and_b32 v44, 7, v44
    v_xor_b32 v44, v44, v46
    v_lshl_add_u32 v44, v44, 4, v47
    v_lshl_add_u32 v108, v45, 12, v44
    v_mul_u32_u24 v44, 0, v49
    v_add3_u32 v44, v44, v51, 6
    v_lshrrev_b32 v45, 3, v44
    v_and_b32 v44, 7, v44
    v_xor_b32 v44, v44, v46
    v_lshl_add_u32 v44, v44, 4, v47
    v_lshl_add_u32 v109, v45, 12, v44
    v_mul_u32_u24 v44, 4, v49
    v_add3_u32 v44, v44, v51, 4
    v_lshrrev_b32 v45, 3, v44
    v_and_b32 v44, 7, v44
    v_xor_b32 v44, v44, v46
    v_lshl_add_u32 v44, v44, 4, v47
    v_lshl_add_u32 v110, v45, 12, v44
    s_mul_i32 s101, s14, 8192
    s_add_u32 s101, s101, 114688
    s_sub_u32 s48, s101, s0
    v_add_u32 v208, s48, v105
    v_add_u32 v209, s48, v106
    v_add_u32 v210, s48, v107
    v_add_u32 v211, s48, v108
    v_add_u32 v212, s48, v109
    v_add_u32 v213, s48, v110
    v_mov_b32 v214, v104
    s_mul_i32 s1, s12, 163840
    s_mul_i32 s55, s14, 40960
    s_add_u32 s1, s1, s55
    s_waitcnt vmcnt(0)
    s_waitcnt lgkmcnt(0)
    s_cmp_ge_u32 s14, 2
    s_cbranch_scc1 interleave_layers__linear_attn_block__geglu_ffn__prompt_kernel_px5
    ds_read_b64_tr_b16 v[68:69], v100 offset:0
    ds_read_b64_tr_b16 v[70:71], v100 offset:512
    ds_read_b64_tr_b16 v[72:73], v100 offset:1024
    ds_read_b64_tr_b16 v[74:75], v100 offset:1536
    ds_read_b64_tr_b16 v[76:77], v100 offset:2048
    ds_read_b64_tr_b16 v[78:79], v100 offset:2560
    ds_read_b64_tr_b16 v[80:81], v100 offset:3072
    ds_read_b64_tr_b16 v[82:83], v100 offset:3584
    ds_read_b64_tr_b16 v[84:85], v100 offset:4096
    ds_read_b64_tr_b16 v[86:87], v100 offset:4608
    s_mul_i32 s52, s13, 163840
    s_add_u32 s52, s52, 3145728
    s_waitcnt lgkmcnt(8)
    v_cndmask_b32 v68, v68, v96, s[92:93]
    v_cndmask_b32 v69, v69, v96, s[92:93]
    v_cndmask_b32 v70, v70, v96, s[92:93]
    v_cndmask_b32 v71, v71, v96, s[92:93]
    buffer_store_dwordx4 v[68:71], v112, s[4:7], s52 offen sc1
    s_waitcnt lgkmcnt(6)
    v_cndmask_b32 v72, v72, v96, s[92:93]
    v_cndmask_b32 v73, v73, v96, s[92:93]
    v_cndmask_b32 v74, v74, v96, s[92:93]
    v_cndmask_b32 v75, v75, v96, s[92:93]
    buffer_store_dwordx4 v[72:75], v113, s[4:7], s52 offen sc1
    s_waitcnt lgkmcnt(4)
    v_cndmask_b32 v76, v76, v96, s[92:93]
    v_cndmask_b32 v77, v77, v96, s[92:93]
    v_cndmask_b32 v78, v78, v96, s[92:93]
    v_cndmask_b32 v79, v79, v96, s[92:93]
    buffer_store_dwordx4 v[76:79], v114, s[4:7], s52 offen sc1
    s_waitcnt lgkmcnt(2)
    v_cndmask_b32 v80, v80, v96, s[92:93]
    v_cndmask_b32 v81, v81, v96, s[92:93]
    v_cndmask_b32 v82, v82, v96, s[92:93]
    v_cndmask_b32 v83, v83, v96, s[92:93]
    buffer_store_dwordx4 v[80:83], v115, s[4:7], s52 offen sc1
    s_waitcnt lgkmcnt(0)
    v_cndmask_b32 v84, v84, v96, s[92:93]
    v_cndmask_b32 v85, v85, v96, s[92:93]
    v_cndmask_b32 v86, v86, v96, s[92:93]
    v_cndmask_b32 v87, v87, v96, s[92:93]
    buffer_store_dwordx4 v[84:87], v116, s[4:7], s52 offen sc1
    v_dot2c_f32_bf16 v103, v68, v32
    v_dot2c_f32_bf16 v103, v69, v32
    v_dot2c_f32_bf16 v103, v70, v32
    v_dot2c_f32_bf16 v103, v71, v32
    v_dot2c_f32_bf16 v103, v72, v32
    v_dot2c_f32_bf16 v103, v73, v32
    v_dot2c_f32_bf16 v103, v74, v32
    v_dot2c_f32_bf16 v103, v75, v32
    v_dot2c_f32_bf16 v103, v76, v32
    v_dot2c_f32_bf16 v103, v77, v32
    v_dot2c_f32_bf16 v103, v78, v32
    v_dot2c_f32_bf16 v103, v79, v32
    v_dot2c_f32_bf16 v103, v80, v32
    v_dot2c_f32_bf16 v103, v81, v32
    v_dot2c_f32_bf16 v103, v82, v32
    v_dot2c_f32_bf16 v103, v83, v32
    v_dot2c_f32_bf16 v103, v84, v32
    v_dot2c_f32_bf16 v103, v85, v32
    v_dot2c_f32_bf16 v103, v86, v32
    v_dot2c_f32_bf16 v103, v87, v32
    s_mul_i32 s48, s13, 8192
    s_mul_i32 s55, s12, 512
    s_add_u32 s48, s48, s55
    s_mul_i32 s55, s14, 256
    s_add_u32 s48, s48, s55
    s_add_u32 s48, s48, 196608
    buffer_store_dword v103, v31, s[4:7], s48 offen sc1
    s_branch interleave_layers__linear_attn_block__geglu_ffn__prompt_kernel_pj6
interleave_layers__linear_attn_block__geglu_ffn__prompt_kernel_px5:
    s_lshr_b32 s48, s13, 1
    s_and_b32 s49, s13, 1
    s_mul_i32 s52, s12, 163840
    s_mul_i32 s55, s48, 20480
    s_add_u32 s52, s52, s55
    s_mul_i32 s55, s49, 128
    s_add_u32 s52, s52, s55
    s_mul_i32 s55, s14, 10240
    s_add_u32 s52, s52, s55
    s_add_u32 s52, s52, 12562432
    v_lshlrev_b32 v44, 4, v88
    v_lshl_add_u32 v44, v89, 8, v44
    v_mov_b32 v46, 0
    v_mov_b32 v47, 0
    v_dot2c_f32_bf16 v46, v68, v32
    v_dot2c_f32_bf16 v47, v68, v68
    v_dot2c_f32_bf16 v46, v69, v32
    v_dot2c_f32_bf16 v47, v69, v69
    v_dot2c_f32_bf16 v46, v70, v32
    v_dot2c_f32_bf16 v47, v70, v70
    v_dot2c_f32_bf16 v46, v71, v32
    v_dot2c_f32_bf16 v47, v71, v71
    s_add_u32 s52, s52, 4096
    v_dot2c_f32_bf16 v46, v72, v32
    v_dot2c_f32_bf16 v47, v72, v72
    v_dot2c_f32_bf16 v46, v73, v32
    v_dot2c_f32_bf16 v47, v73, v73
    v_dot2c_f32_bf16 v46, v74, v32
    v_dot2c_f32_bf16 v47, v74, v74
    v_dot2c_f32_bf16 v46, v75, v32
    v_dot2c_f32_bf16 v47, v75, v75
    v_dot2c_f32_bf16 v46, v76, v32
    v_dot2c_f32_bf16 v47, v76, v76
    v_dot2c_f32_bf16 v46, v77, v32
    v_dot2c_f32_bf16 v47, v77, v77
    v_dot2c_f32_bf16 v46, v78, v32
    v_dot2c_f32_bf16 v47, v78, v78
    v_dot2c_f32_bf16 v46, v79, v32
    v_dot2c_f32_bf16 v47, v79, v79
    s_add_u32 s52, s52, 4096
    v_dot2c_f32_bf16 v46, v80, v32
    v_dot2c_f32_bf16 v47, v80, v80
    v_dot2c_f32_bf16 v46, v81, v32
    v_dot2c_f32_bf16 v47, v81, v81
    v_dot2c_f32_bf16 v46, v82, v32
    v_dot2c_f32_bf16 v47, v82, v82
    v_dot2c_f32_bf16 v46, v83, v32
    v_dot2c_f32_bf16 v47, v83, v83
    v_dot2c_f32_bf16 v46, v84, v32
    v_dot2c_f32_bf16 v47, v84, v84
    v_dot2c_f32_bf16 v46, v85, v32
    v_dot2c_f32_bf16 v47, v85, v85
    v_dot2c_f32_bf16 v46, v86, v32
    v_dot2c_f32_bf16 v47, v86, v86
    v_dot2c_f32_bf16 v46, v87, v32
    v_dot2c_f32_bf16 v47, v87, v87
    s_cmp_ge_u32 s12, 2
    s_cbranch_scc1 interleave_layers__linear_attn_block__geglu_ffn__prompt_kernel_kz7
    s_mul_i32 s48, s12, 65536
    s_mul_i32 s55, s13, 4096
    s_add_u32 s48, s48, s55
    s_mul_i32 s55, s14, 2048
    s_add_u32 s48, s48, s55
    s_add_u32 s48, s48, 454656
    buffer_store_dwordx4 v[96:99], v0, s[4:7], s48 offen sc1
    buffer_store_dwordx4 v[96:99], v0, s[4:7], s48 offen offset:1024 sc1
    s_nop 1
interleave_layers__linear_attn_block__geglu_ffn__prompt_kernel_kz7:
    v_add_f32_dpp v46, v46, v46 row_ror:8 row_mask:0xf bank_mask:0xf
    v_add_f32_dpp v47, v47, v47 row_ror:8 row_mask:0xf bank_mask:0xf
    v_mov_b32 v44, v46
    v_mov_b32 v45, v47
    s_nop 0
    v_permlane16_swap_b32 v46, v44
    v_permlane16_swap_b32 v47, v45
    v_pk_add_f32 v[46:47], v[46:47], v[44:45]
    v_mov_b32 v44, v46
    v_mov_b32 v45, v47
    s_nop 0
    v_permlane32_swap_b32 v46, v44
    v_permlane32_swap_b32 v47, v45
    v_pk_add_f32 v[46:47], v[46:47], v[44:45]
    s_mul_i32 s48, s14, 3
    s_sub_u32 s48, s48, 5
    s_sub_u32 s49, s14, 2
    v_add_u32 v44, s48, v89
    v_mov_b32 v45, s49
    v_cmp_eq_u32 vcc, 0, v89
    s_nop 1
    v_cndmask_b32 v44, v44, v45, vcc
    v_cndmask_b32 v46, 0, v46, vcc
    v_cndmask_b32 v47, 0, v47, vcc
    v_and_b32 v45, 1, v44
    v_lshl_add_u32 v45, v88, 1, v45
    v_lshrrev_b32 v44, 1, v44
    v_lshlrev_b32 v44, 11, v44
    v_lshl_add_u32 v44, v45, 3, v44
    s_mul_i32 s48, s12, 8192
    s_mul_i32 s55, s13, 128
    s_add_u32 s48, s48, s55
    s_add_u32 s48, s48, 2490368
    s_mov_b32 exec_hi, 0
    buffer_store_dwordx2 v[46:47], v44, s[4:7], s48 offen sc1
    s_mov_b64 exec, -1
interleave_layers__linear_attn_block__geglu_ffn__prompt_kernel_pj6:
    buffer_load_dword v38, v96, s[96:99], 0 offen sc1
    s_and_b32 s48, s12, 7
    s_mul_i32 s52, s48, 245760
    s_mul_i32 s55, s13, 192
    s_add_u32 s52, s52, s55
    s_mov_b32 s76, s82
    s_mov_b32 s77, s83
    s_mov_b32 s78, 1966080
    s_mov_b32 s79, 0x20000
    s_lshl_b32 s55, s14, 10
    s_add_u32 m0, s55, 114688
    s_nop 0
    buffer_load_dwordx4 v59, s[76:79], s52 offen nt lds
    s_add_u32 m0, m0, 4096
    s_nop 0
    buffer_load_dwordx4 v60, s[76:79], s52 offen nt lds
    s_add_u32 m0, m0, 4096
    s_nop 0
    buffer_load_dwordx4 v61, s[76:79], s52 offen nt lds
    s_add_u32 m0, m0, 4096
    s_nop 0
    buffer_load_dwordx4 v62, s[76:79], s52 offen nt lds
    s_mul_i32 s52, s39, 10240
    s_mul_i32 s55, s16, 160
    s_add_u32 s52, s52, s55
    s_mov_b32 s76, s84
    s_mov_b32 s77, s85
    s_mov_b32 s78, 819200
    s_mov_b32 s79, 0x20000
    s_add_u32 m0, m0, 4096
    s_nop 0
    buffer_load_dwordx4 v63, s[76:79], s52 offen nt lds
    s_mul_i32 s52, s88, 61440
    s_mul_i32 s55, s16, 160
    s_add_u32 s52, s52, s55
    s_mov_b32 s76, s90
    s_mov_b32 s77, s91
    s_mov_b32 s78, 1966080
    s_mov_b32 s79, 0x20000
    s_add_u32 m0, m0, 4096
    s_nop 0
    buffer_load_dwordx4 v64, s[76:79], s52 offen nt lds
    s_add_u32 m0, m0, 4096
    s_nop 0
    buffer_load_dwordx4 v65, s[76:79], s52 offen nt lds
    s_mov_b32 s76, s86
    s_mov_b32 s77, s87
    s_mov_b32 s78, 2621440
    s_mov_b32 s79, 0x20000
    s_mul_i32 s88, s88, 6
    s_cmp_eq_u32 s14, 3
    s_cselect_b32 s39, s88, s39
    s_add_u32 s48, s14, 1
    s_and_b32 s48, s48, 3
    s_mul_i32 s86, s48, 16384
    s_add_u32 s86, s86, 81920
    s_add_u32 s48, s14, 2
    s_and_b32 s48, s48, 3
    s_mul_i32 s87, s48, 16384
    s_add_u32 s87, s87, 87040
    s_add_u32 s48, s14, 3
    s_and_b32 s48, s48, 3
    s_mul_i32 s88, s48, 16384
    s_add_u32 s88, s88, 92160
    s_add_u32 s48, s14, 4
    s_and_b32 s48, s48, 3
    s_mul_i32 s89, s48, 16384
    s_add_u32 s89, s89, 81920
    s_lshl_b32 s49, s14, 4
    s_mov_b64 s[90:91], 0xcccc
    s_lshl_b64 s[90:91], s[90:91], s49
    s_waitcnt vmcnt(7)
    s_mov_b32 s72, 0x20000
interleave_layers__linear_attn_block__geglu_ffn__prompt_kernel_tg8:
    v_readfirstlane_b32 s3, v38
    s_nop 1
    s_bitcmp1_b32 s3, 0
    s_cbranch_scc1 interleave_layers__linear_attn_block__geglu_ffn__prompt_kernel_tgd9
    buffer_load_dword v38, v96, s[96:99], 0 offen sc1
    s_waitcnt vmcnt(0)
    s_sub_u32 s72, s72, 1
    s_cbranch_scc0 interleave_layers__linear_attn_block__geglu_ffn__prompt_kernel_tg8
    s_branch interleave_layers__linear_attn_block__geglu_ffn__prompt_kernel_end
interleave_layers__linear_attn_block__geglu_ffn__prompt_kernel_tgd9:
    s_sub_u32 s3, s3, 1
    s_add_u32 s19, s3, 1
    s_add_u32 s75, s3, 3
    v_mov_b32 v44, s19
    s_mov_b64 exec, 1
    buffer_store_dword v44, v96, s[4:7], s40 offen sc1
    s_mov_b64 exec, -1
    s_barrier
    s_cmp_lg_u32 s14, 0
    s_cbranch_scc1 interleave_layers__linear_attn_block__geglu_ffn__prompt_kernel_fa10
    s_mov_b64 exec, 0xffff
    buffer_store_dword v44, v39, s[4:7], s42 offen sc1
    s_mov_b64 exec, 1
    s_getreg_b32 s50, hwreg(HW_REG_XCC_ID, 0, 4)
    s_and_b32 s50, s50, 7
    s_add_u32 s50, s50, s19
    v_mov_b32 v45, s50
    s_mul_i32 s48, s12, 128
    s_mul_i32 s55, s13, 4
    s_add_u32 s48, s48, s55
    s_add_u32 s48, s48, 4096
    buffer_store_dword v45, v96, s[4:7], s48 offen sc1
    s_mov_b64 exec, -1
interleave_layers__linear_attn_block__geglu_ffn__prompt_kernel_fa10:
    v_and_b32 v44, 1, v51
    v_lshl_add_u32 v44, v44, 3, v53
    v_mul_u32_u24 v44, 192, v44
    v_lshl_add_u32 v44, v54, 4, v44
    v_lshl_add_u32 v44, v49, 3, v44
    s_lshl_b32 s48, s14, 6
    s_add_u32 s48, s48, 114688
    v_add_u32 v172, s48, v44
    v_lshlrev_b32 v44, 4, v48
    v_lshl_add_u32 v175, v49, 10, v44
    v_mul_u32_u24 v44, 160, v53
    v_lshl_add_u32 v45, v54, 4, v44
    v_lshl_add_u32 v45, v49, 6, v45
    v_and_b32 v46, 1, v51
    v_lshl_add_u32 v173, v46, 3, v45
    v_lshl_add_u32 v44, v54, 3, v44
    v_mul_u32_u24 v45, 1280, v51
    v_add3_u32 v174, v44, v45, 64
    v_add_u32 v174, 64, v174
    v_lshlrev_b32 v44, 4, v50
    v_lshl_add_u32 v176, v51, 10, v44
    s_mov_b32 s49, 4096
    s_add_u32 s48, s39, 0
    v_add_u32 v45, s48, v51
    v_lshrrev_b32 v46, 2, v45
    v_and_b32 v45, 3, v45
    v_mul_u32_u24 v46, 5120, v46
    v_lshl_add_u32 v45, v45, 8, v46
    v_add3_u32 v177, v45, v44, s49
    s_add_u32 s48, s39, 4
    v_add_u32 v45, s48, v51
    v_lshrrev_b32 v46, 2, v45
    v_and_b32 v45, 3, v45
    v_mul_u32_u24 v46, 5120, v46
    v_lshl_add_u32 v45, v45, 8, v46
    v_add3_u32 v178, v45, v44, s49
    v_cmp_gt_u32 vcc, 2, v51
    s_nop 1
    v_cndmask_b32 v178, v52, v178, vcc
    s_mul_i32 s48, s14, 1280
    s_add_u32 s48, s48, 131072
    s_cmp_eq_u32 s14, 3
    s_cselect_b32 s48, 135168, s48
    s_cselect_b32 s49, 4096, 0
    s_cselect_b32 s50, 4, 3
    v_add_u32 v173, s48, v173
    s_add_u32 s49, s49, 131072
    v_add_u32 v174, s49, v174
    v_cmp_gt_u32 vcc, s50, v51
    s_nop 1
    v_cndmask_b32 v177, v52, v177, vcc
    v_lshlrev_b32 v179, 2, v50
    v_lshl_add_u32 v179, v49, 6, v179
    s_add_u32 m0, s0, 0
    s_add_u32 s48, s1, 0
    buffer_load_dwordx4 v104, s[76:79], s48 offen lds
    s_add_u32 m0, s0, 1024
    s_add_u32 s48, s1, 10240
    buffer_load_dwordx4 v104, s[76:79], s48 offen lds
    s_add_u32 m0, s0, 2048
    s_add_u32 s48, s1, 20480
    buffer_load_dwordx4 v104, s[76:79], s48 offen lds
    s_add_u32 m0, s0, 3072
    s_add_u32 s48, s1, 30720
    buffer_load_dwordx4 v104, s[76:79], s48 offen lds
    s_add_u32 m0, s0, 4096
    s_add_u32 s48, s1, 128
    buffer_load_dwordx4 v104, s[76:79], s48 offen lds
    s_add_u32 m0, s0, 5120
    s_add_u32 s48, s1, 10368
    buffer_load_dwordx4 v104, s[76:79], s48 offen lds
    s_add_u32 m0, s0, 6144
    s_add_u32 s48, s1, 20608
    buffer_load_dwordx4 v104, s[76:79], s48 offen lds
    s_add_u32 m0, s0, 7168
    s_add_u32 s48, s1, 30848
    buffer_load_dwordx4 v104, s[76:79], s48 offen lds
    s_add_u32 m0, s0, 8192
    s_add_u32 s48, s1, 256
    buffer_load_dwordx4 v104, s[76:79], s48 offen lds
    s_add_u32 m0, s0, 9216
    s_add_u32 s48, s1, 10496
    buffer_load_dwordx4 v104, s[76:79], s48 offen lds
    s_add_u32 m0, s0, 10240
    s_add_u32 s48, s1, 20736
    buffer_load_dwordx4 v104, s[76:79], s48 offen lds
    s_add_u32 m0, s0, 11264
    s_add_u32 s48, s1, 30976
    buffer_load_dwordx4 v104, s[76:79], s48 offen lds
    s_add_u32 m0, s0, 12288
    s_add_u32 s48, s1, 384
    buffer_load_dwordx4 v104, s[76:79], s48 offen lds
    s_add_u32 m0, s0, 13312
    s_add_u32 s48, s1, 10624
    buffer_load_dwordx4 v104, s[76:79], s48 offen lds
    s_add_u32 m0, s0, 14336
    s_add_u32 s48, s1, 20864
    buffer_load_dwordx4 v104, s[76:79], s48 offen lds
    s_add_u32 m0, s0, 15360
    s_add_u32 s48, s1, 31104
    buffer_load_dwordx4 v104, s[76:79], s48 offen lds
    s_add_u32 m0, s0, 16384
    s_add_u32 s48, s1, 512
    buffer_load_dwordx4 v104, s[76:79], s48 offen lds
    s_add_u32 m0, s0, 17408
    s_add_u32 s48, s1, 10752
    buffer_load_dwordx4 v104, s[76:79], s48 offen lds
    s_add_u32 m0, s0, 18432
    s_add_u32 s48, s1, 20992
    buffer_load_dwordx4 v104, s[76:79], s48 offen lds
    s_add_u32 m0, s0, 19456
    s_add_u32 s48, s1, 31232
    buffer_load_dwordx4 v104, s[76:79], s48 offen lds
    s_cmp_eq_u32 s14, 3
    s_cbranch_scc1 interleave_layers__linear_attn_block__geglu_ffn__prompt_kernel_qx11
    s_lshr_b32 s50, s12, 3
    s_cmp_lt_u32 s14, 2
    s_cselect_b32 s54, 8, 4
    s_cselect_b32 s48, 0, 152
    s_lshl_b32 s54, s54, 10
    s_mul_i32 s52, s48, 1024
    s_mul_i32 s55, s14, 4096
    s_add_u32 s52, s52, s55
    s_mul_i32 s55, s50, 2048
    s_add_u32 s52, s52, s55
    s_mul_i32 s55, s13, 245760
    s_add_u32 s52, s52, s55
    s_add_u32 s52, s52, 5767168
    s_and_b32 s53, s12, 7
    s_mul_i32 s51, s13, 6144
    s_mul_i32 s55, s53, 768
    s_add_u32 s51, s51, s55
    s_mul_i32 s55, s14, 256
    s_add_u32 s51, s51, s55
    s_mul_i32 s55, s50, 128
    s_add_u32 s51, s51, s55
    s_add_u32 s51, s51, 327680
    s_mul_i32 s53, s53, 10
    s_mul_i32 s55, s53, 205
    s_lshr_b32 s55, s55, 11
    s_mul_i32 s49, s55, 10
    s_sub_u32 s49, s53, s49
    s_cmp_lt_u32 s49, 4
    s_cselect_b32 s48, 4, 6
    s_mul_i32 s55, s55, s48
    s_cselect_b32 s48, 0, 28
    s_add_u32 s48, s48, s55
    s_add_u32 s48, s48, s49
    s_and_b32 s49, s48, 2
    s_lshr_b32 s48, s48, 2
    s_mul_i32 s48, s48, s54
    s_lshl_b32 s49, s49, 8
    s_add_u32 s48, s48, s49
    s_add_u32 s82, s48, s52
    s_add_u32 s53, s53, 2
    s_mul_i32 s55, s53, 205
    s_lshr_b32 s55, s55, 11
    s_mul_i32 s49, s55, 10
    s_sub_u32 s49, s53, s49
    s_cmp_lt_u32 s49, 4
    s_cselect_b32 s48, 4, 6
    s_mul_i32 s55, s55, s48
    s_cselect_b32 s48, 0, 28
    s_add_u32 s48, s48, s55
    s_add_u32 s48, s48, s49
    s_and_b32 s49, s48, 2
    s_lshr_b32 s48, s48, 2
    s_mul_i32 s48, s48, s54
    s_lshl_b32 s49, s49, 8
    s_add_u32 s48, s48, s49
    s_add_u32 s83, s48, s52
    s_add_u32 s53, s53, 2
    s_mul_i32 s55, s53, 205
    s_lshr_b32 s55, s55, 11
    s_mul_i32 s49, s55, 10
    s_sub_u32 s49, s53, s49
    s_cmp_lt_u32 s49, 4
    s_cselect_b32 s48, 4, 6
    s_mul_i32 s55, s55, s48
    s_cselect_b32 s48, 0, 28
    s_add_u32 s48, s48, s55
    s_add_u32 s48, s48, s49
    s_and_b32 s49, s48, 2
    s_lshr_b32 s48, s48, 2
    s_mul_i32 s48, s48, s54
    s_lshl_b32 s49, s49, 8
    s_add_u32 s48, s48, s49
    s_add_u32 s84, s48, s52
    s_add_u32 s53, s53, 2
    s_mul_i32 s55, s53, 205
    s_lshr_b32 s55, s55, 11
    s_mul_i32 s49, s55, 10
    s_sub_u32 s49, s53, s49
    s_cmp_lt_u32 s49, 4
    s_cselect_b32 s48, 4, 6
    s_mul_i32 s55, s55, s48
    s_cselect_b32 s48, 0, 28
    s_add_u32 s48, s48, s55
    s_add_u32 s48, s48, s49
    s_and_b32 s49, s48, 2
    s_lshr_b32 s48, s48, 2
    s_mul_i32 s48, s48, s54
    s_lshl_b32 s49, s49, 8
    s_add_u32 s48, s48, s49
    s_add_u32 s85, s48, s52
    s_add_u32 s53, s53, 2
    s_mul_i32 s55, s53, 205
    s_lshr_b32 s55, s55, 11
    s_mul_i32 s49, s55, 10
    s_sub_u32 s49, s53, s49
    s_cmp_lt_u32 s49, 4
    s_cselect_b32 s48, 4, 6
    s_mul_i32 s55, s55, s48
    s_cselect_b32 s48, 0, 28
    s_add_u32 s48, s48, s55
    s_add_u32 s48, s48, s49
    s_and_b32 s49, s48, 2
    s_lshr_b32 s48, s48, 2
    s_mul_i32 s48, s48, s54
    s_lshl_b32 s49, s49, 8
    s_add_u32 s48, s48, s49
    s_add_u32 s96, s48, s52
    s_add_u32 s53, s53, 2
    s_mul_i32 s98, s16, 102400
    s_add_u32 s98, s98, 9699328
    s_add_u32 s53, s39, s14
    s_lshr_b32 s48, s53, 2
    s_mul_i32 s48, s48, 5120
    s_and_b32 s49, s53, 3
    s_lshl_b32 s49, s49, 8
    s_add_u32 s48, s48, s49
    s_add_u32 s97, s48, s98
    s_branch interleave_layers__linear_attn_block__geglu_ffn__prompt_kernel_qj12
interleave_layers__linear_attn_block__geglu_ffn__prompt_kernel_qx11:
    s_mul_i32 s98, s16, 245760
    s_add_u32 s98, s98, 10551296
    s_lshr_b32 s48, s39, 2
    s_mul_i32 s48, s48, 5120
    s_and_b32 s49, s39, 3
    s_lshl_b32 s49, s49, 8
    s_add_u32 s48, s48, s49
    s_add_u32 s82, s48, s98
    s_add_u32 s39, s39, 1
    s_lshr_b32 s48, s39, 2
    s_mul_i32 s48, s48, 5120
    s_and_b32 s49, s39, 3
    s_lshl_b32 s49, s49, 8
    s_add_u32 s48, s48, s49
    s_add_u32 s83, s48, s98
    s_add_u32 s39, s39, 1
    s_lshr_b32 s48, s39, 2
    s_mul_i32 s48, s48, 5120
    s_and_b32 s49, s39, 3
    s_lshl_b32 s49, s49, 8
    s_add_u32 s48, s48, s49
    s_add_u32 s84, s48, s98
    s_add_u32 s39, s39, 1
    s_lshr_b32 s48, s39, 2
    s_mul_i32 s48, s48, 5120
    s_and_b32 s49, s39, 3
    s_lshl_b32 s49, s49, 8
    s_add_u32 s48, s48, s49
    s_add_u32 s85, s48, s98
    s_add_u32 s39, s39, 1
    s_lshr_b32 s48, s39, 2
    s_mul_i32 s48, s48, 5120
    s_and_b32 s49, s39, 3
    s_lshl_b32 s49, s49, 8
    s_add_u32 s48, s48, s49
    s_add_u32 s96, s48, s98
    s_add_u32 s39, s39, 1
    s_lshr_b32 s48, s39, 2
    s_mul_i32 s48, s48, 5120
    s_and_b32 s49, s39, 3
    s_lshl_b32 s49, s49, 8
    s_add_u32 s48, s48, s49
    s_add_u32 s97, s48, s98
    s_add_u32 s39, s39, 1
    s_mov_b32 s51, 0
interleave_layers__linear_attn_block__geglu_ffn__prompt_kernel_qj12:
    s_mov_b32 s99, s98
    s_mov_b32 s39, s51
    s_cmp_eq_u32 s14, 3
    s_cselect_b64 s[92:93], -1, 0
    s_cselect_b32 s54, 5, 12
    s_cselect_b32 s49, 5, 6
    s_cselect_b32 s50, 25, 0
    s_lshl_b32 s54, s54, 8
    s_lshl_b32 s49, s49, 7
    s_lshl_b32 s50, s50, 8
    v_cndmask_b32 v118, v172, v173, s[92:93]
    v_cndmask_b32 v175, v175, v176, s[92:93]
    v_cndmask_b32 v178, v52, v178, s[92:93]
    v_cndmask_b32 v179, v179, v52, s[92:93]
    v_add_u32 v119, s49, v118
    v_add_u32 v173, s50, v173
    s_waitcnt vmcnt(21)
    s_barrier
    ds_read_b64_tr_b16 v[216:217], v118
    ds_read_b64_tr_b16 v[218:219], v119
    v_add_u32 v118, s54, v118
    v_add_u32 v119, s54, v119
    ds_read_b64_tr_b16 v[220:221], v118
    ds_read_b64_tr_b16 v[222:223], v119
    v_add_u32 v118, s54, v118
    v_add_u32 v119, s54, v119
    ds_read_b64_tr_b16 v[224:225], v118
    ds_read_b64_tr_b16 v[226:227], v119
    v_add_u32 v118, s54, v118
    v_add_u32 v119, s54, v119
    ds_read_b64_tr_b16 v[228:229], v118
    ds_read_b64_tr_b16 v[230:231], v119
    v_add_u32 v118, s54, v118
    v_add_u32 v119, s54, v119
    ds_read_b64_tr_b16 v[232:233], v118
    ds_read_b64_tr_b16 v[234:235], v119
    ds_read_b64_tr_b16 v[236:237], v173 offset:0
    ds_read_b64_tr_b16 v[238:239], v173 offset:640
    ds_read_b64_tr_b16 v[240:241], v174 offset:0
    ds_read_b64_tr_b16 v[242:243], v174 offset:640
    ds_read_b64_tr_b16 v[244:245], v174 offset:5120
    ds_read_b64_tr_b16 v[246:247], v174 offset:5760
    v_mov_b32 v180, 0
    s_waitcnt lgkmcnt(0)
    v_dot2c_f32_bf16 v180, v216, v32
    v_dot2c_f32_bf16 v180, v217, v32
    v_dot2c_f32_bf16 v180, v218, v32
    v_dot2c_f32_bf16 v180, v219, v32
    v_dot2c_f32_bf16 v180, v220, v32
    v_dot2c_f32_bf16 v180, v221, v32
    v_dot2c_f32_bf16 v180, v222, v32
    v_dot2c_f32_bf16 v180, v223, v32
    v_dot2c_f32_bf16 v180, v224, v32
    v_dot2c_f32_bf16 v180, v225, v32
    v_dot2c_f32_bf16 v180, v226, v32
    v_dot2c_f32_bf16 v180, v227, v32
    v_dot2c_f32_bf16 v180, v228, v32
    v_dot2c_f32_bf16 v180, v229, v32
    v_dot2c_f32_bf16 v180, v230, v32
    v_dot2c_f32_bf16 v180, v231, v32
    v_dot2c_f32_bf16 v180, v232, v32
    v_dot2c_f32_bf16 v180, v233, v32
    v_dot2c_f32_bf16 v180, v234, v32
    v_dot2c_f32_bf16 v180, v235, v32
    s_nop 2
    v_mov_b32 v181, v180
    s_nop 1
    v_permlane16_swap_b32 v180, v181
    v_add_f32 v180, v180, v181
    buffer_store_dwordx4 v[236:239], v176, s[4:7], s97 offen sc1
    buffer_store_dwordx4 v[240:243], v177, s[4:7], s98 offen sc1
    buffer_store_dwordx4 v[216:219], v175, s[4:7], s82 offen sc1
    buffer_store_dwordx4 v[220:223], v175, s[4:7], s83 offen sc1
    buffer_store_dwordx4 v[224:227], v175, s[4:7], s84 offen sc1
    buffer_store_dwordx4 v[228:231], v175, s[4:7], s85 offen sc1
    buffer_store_dwordx4 v[232:235], v175, s[4:7], s96 offen sc1
    buffer_store_dwordx4 v[244:247], v178, s[4:7], s99 offen sc1
    s_mov_b32 exec_lo, 0xffff
    s_mov_b32 exec_hi, 0xffff
    buffer_store_dword v180, v179, s[4:7], s39 offen sc1
    s_mov_b64 exec, -1
    s_barrier
    s_add_u32 m0, s101, 0
    s_add_u32 s48, s1, 640
    buffer_load_dwordx4 v214, s[76:79], s48 offen lds
    s_add_u32 m0, s101, 1024
    s_add_u32 s48, s1, 10880
    buffer_load_dwordx4 v214, s[76:79], s48 offen lds
    s_add_u32 m0, s101, 2048
    s_add_u32 s48, s1, 21120
    buffer_load_dwordx4 v214, s[76:79], s48 offen lds
    s_add_u32 m0, s101, 3072
    s_add_u32 s48, s1, 31360
    buffer_load_dwordx4 v214, s[76:79], s48 offen lds
    s_add_u32 m0, s101, 4096
    s_add_u32 s48, s1, 768
    buffer_load_dwordx4 v214, s[76:79], s48 offen lds
    s_add_u32 m0, s101, 5120
    s_add_u32 s48, s1, 11008
    buffer_load_dwordx4 v214, s[76:79], s48 offen lds
    s_add_u32 m0, s101, 6144
    s_add_u32 s48, s1, 21248
    buffer_load_dwordx4 v214, s[76:79], s48 offen lds
    s_add_u32 m0, s101, 7168
    s_add_u32 s48, s1, 31488
    buffer_load_dwordx4 v214, s[76:79], s48 offen lds
    s_waitcnt vmcnt(33)
    ds_read_b128 a[0:3], v105 offset:0
    ds_read_b128 a[4:7], v105 offset:2048
    ds_read_b128 a[64:67], v106 offset:0
    ds_read_b128 a[68:71], v106 offset:2048
    s_waitcnt vmcnt(29)
    ds_read_b128 a[8:11], v108 offset:4096
    ds_read_b128 a[12:15], v108 offset:6144
    ds_read_b128 a[72:75], v107 offset:4096
    ds_read_b128 a[76:79], v107 offset:6144
    s_waitcnt vmcnt(25)
    ds_read_b128 a[16:19], v106 offset:8192
    ds_read_b128 a[20:23], v106 offset:10240
    ds_read_b128 a[80:83], v105 offset:8192
    ds_read_b128 a[84:87], v105 offset:10240
    s_waitcnt vmcnt(21)
    ds_read_b128 a[88:91], v105 offset:12288
    ds_read_b128 a[92:95], v105 offset:14336
    s_waitcnt vmcnt(17)
    ds_read_b128 a[24:27], v109 offset:12288
    ds_read_b128 a[28:31], v109 offset:14336
    ds_read_b128 a[96:99], v110 offset:12288
    ds_read_b128 a[100:103], v110 offset:14336
    ds_read_b128 a[104:107], v106 offset:16384
    ds_read_b128 a[108:111], v106 offset:18432
    v_mul_u32_u24 v44, 1280, v50
    v_lshl_add_u32 v45, v51, 4, v44
    v_lshl_add_u32 v46, v51, 3, v44
    s_mul_i32 s48, s12, 163840
    s_mul_i32 s55, s15, 81920
    s_add_u32 s48, s48, s55
    s_mul_i32 s55, s14, 20480
    s_add_u32 s48, s48, s55
    s_mul_i32 s55, s16, 160
    s_add_u32 s48, s48, s55
    buffer_load_dwordx4 v[4:7], v45, s[76:79], s48 offen
    buffer_load_dwordx4 v[8:11], v45, s[76:79], s48 offen offset:64
    buffer_load_dwordx2 v[12:13], v46, s[76:79], s48 offen offset:128
    buffer_load_dword v40, v31, s[4:7], s41 offen sc1
    s_mov_b32 s72, 0x20000
    s_mov_b64 exec, s[64:65]
interleave_layers__linear_attn_block__geglu_ffn__prompt_kernel_poll13:
    buffer_load_dword v41, v31, s[4:7], s43 offen sc1
    s_waitcnt vmcnt(0)
    v_subrev_u32 v42, s19, v41
    v_cmp_lt_u32 vcc, 3, v42
    s_cbranch_vccz interleave_layers__linear_attn_block__geglu_ffn__prompt_kernel_pdone14
    s_sub_u32 s72, s72, 1
    s_cbranch_scc0 interleave_layers__linear_attn_block__geglu_ffn__prompt_kernel_poll13
    s_branch interleave_layers__linear_attn_block__geglu_ffn__prompt_kernel_end
interleave_layers__linear_attn_block__geglu_ffn__prompt_kernel_pdone14:
    s_mov_b64 exec, -1
    s_add_u32 s54, s20, 0
    s_add_u32 m0, s73, 0
    s_nop 0
    buffer_load_dwordx4 v0, s[44:47], s54 offen offset:0 sc1 lds
    buffer_load_dwordx4 v0, s[44:47], s54 offen offset:1024 sc1 lds
    buffer_load_dwordx4 v0, s[44:47], s54 offen offset:2048 sc1 lds
    buffer_load_dwordx4 v0, s[44:47], s54 offen offset:3072 sc1 lds
    s_add_u32 s54, s20, 16384
    s_add_u32 m0, s73, 16384
    s_nop 0
    buffer_load_dwordx4 v0, s[44:47], s54 offen offset:0 sc1 lds
    buffer_load_dwordx4 v0, s[44:47], s54 offen offset:1024 sc1 lds
    buffer_load_dwordx4 v0, s[44:47], s54 offen offset:2048 sc1 lds
    buffer_load_dwordx4 v0, s[44:47], s54 offen offset:3072 sc1 lds
    ds_read_b128 a[32:35], v208 offset:0
    ds_read_b128 a[36:39], v208 offset:2048
    ds_read_b128 a[112:115], v209 offset:0
    ds_read_b128 a[116:119], v209 offset:2048
    ds_read_b128 a[40:43], v211 offset:4096
    ds_read_b128 a[44:47], v211 offset:6144
    ds_read_b128 a[120:123], v210 offset:4096
    ds_read_b128 a[124:127], v210 offset:6144
    v_subrev_u32 v40, s19, v40
    v_cmp_lt_u32 vcc, 12, v40
    s_nop 1
    s_and_b64 vcc, vcc, s[90:91]
    s_cbranch_scc1 interleave_layers__linear_attn_block__geglu_ffn__prompt_kernel_aspin16
interleave_layers__linear_attn_block__geglu_ffn__prompt_kernel_adone15:
    buffer_load_dwordx4 v[132:135], v16, s[4:7], s26 offen offset:0 sc1
    buffer_load_dwordx4 v[136:139], v16, s[4:7], s26 offen offset:256 sc1
    s_waitcnt lgkmcnt(0)
    s_waitcnt vmcnt(6)
    s_barrier
    ds_read_b128 v[108:111], v0 offset:0
    ds_read_b128 v[112:115], v0 offset:1024
    ds_read_b128 v[116:119], v0 offset:2048
    ds_read_b128 v[120:123], v0 offset:3072
    ds_read_b128 v[124:127], v0 offset:4096
    ds_read_b128 v[128:131], v0 offset:5120
    s_waitcnt lgkmcnt(3)
    v_mfma_f32_16x16x32_bf16 v[44:47], a[0:3], v[108:111], 0
    s_add_u32 m0, s101, 0
    s_add_u32 s48, s1, 896
    buffer_load_dwordx4 v214, s[76:79], s48 offen lds
    s_add_u32 m0, s101, 1024
    s_add_u32 s48, s1, 11136
    buffer_load_dwordx4 v214, s[76:79], s48 offen lds
    s_add_u32 m0, s101, 2048
    s_add_u32 s48, s1, 21376
    buffer_load_dwordx4 v214, s[76:79], s48 offen lds
    s_add_u32 m0, s101, 3072
    s_add_u32 s48, s1, 31616
    buffer_load_dwordx4 v214, s[76:79], s48 offen lds
    s_add_u32 m0, s101, 4096
    s_add_u32 s48, s1, 1152
    buffer_load_dwordx4 v214, s[76:79], s48 offen lds
    s_add_u32 m0, s101, 5120
    s_add_u32 s48, s1, 11392
    buffer_load_dwordx4 v214, s[76:79], s48 offen lds
    s_add_u32 m0, s101, 6144
    s_add_u32 s48, s1, 21632
    buffer_load_dwordx4 v214, s[76:79], s48 offen lds
    s_add_u32 m0, s101, 7168
    s_add_u32 s48, s1, 31872
    buffer_load_dwordx4 v214, s[76:79], s48 offen lds
    v_mfma_f32_16x16x32_bf16 v[48:51], a[4:7], v[108:111], 0
    ds_read_b128 v[108:111], v0 offset:6144
    s_barrier
    s_cmp_lg_u32 s14, 0
    s_cbranch_scc1 interleave_layers__linear_attn_block__geglu_ffn__prompt_kernel_cf19
    s_add_u32 s48, s3, 2
    v_mov_b32 v41, s48
    s_mov_b32 exec_lo, 0xffffffff
    s_mov_b32 exec_hi, 0x0
    buffer_store_dword v41, v39, s[4:7], s42 offen sc1
    s_mov_b64 exec, -1
interleave_layers__linear_attn_block__geglu_ffn__prompt_kernel_cf19:
    v_mfma_f32_16x16x32_bf16 v[52:55], a[0:3], v[112:115], 0
    s_add_u32 s54, s20, 32768
    s_add_u32 m0, s73, 32768
    s_nop 0
    buffer_load_dwordx4 v0, s[44:47], s54 offen offset:0 sc1 lds
    v_mfma_f32_16x16x32_bf16 v[56:59], a[4:7], v[112:115], 0
    ds_read_b128 v[112:115], v0 offset:7168
    v_mfma_f32_16x16x32_bf16 v[60:63], a[0:3], v[116:119], 0
    v_mfma_f32_16x16x32_bf16 v[64:67], a[4:7], v[116:119], 0
    ds_read_b128 v[116:119], v0 offset:8192
    s_waitcnt lgkmcnt(3)
    v_mfma_f32_16x16x32_bf16 v[68:71], a[0:3], v[120:123], 0
    v_mfma_f32_16x16x32_bf16 v[72:75], a[4:7], v[120:123], 0
    ds_read_b128 v[120:123], v0 offset:9216
    v_mfma_f32_16x16x32_bf16 v[76:79], a[0:3], v[124:127], 0
    buffer_load_dwordx4 v0, s[44:47], s54 offen offset:1024 sc1 lds
    v_mfma_f32_16x16x32_bf16 v[80:83], a[4:7], v[124:127], 0
    ds_read_b128 v[124:127], v0 offset:10240
    v_lshlrev_b32 v192, 3, v1
    s_mul_i32 s0, s13, 8192
    s_lshl_b32 s48, s14, 11
    s_add_u32 s0, s0, s48
    s_add_u32 s0, s0, 196608
    buffer_load_dwordx2 v[184:185], v192, s[4:7], s0 offen offset:0 sc1
    v_mfma_f32_16x16x32_bf16 v[44:47], a[8:11], v[128:131], v[44:47]
    v_mfma_f32_16x16x32_bf16 v[48:51], a[12:15], v[128:131], v[48:51]
    ds_read_b128 v[128:131], v0 offset:11264
    s_waitcnt lgkmcnt(3)
    v_mfma_f32_16x16x32_bf16 v[52:55], a[8:11], v[108:111], v[52:55]
    buffer_load_dwordx2 v[186:187], v192, s[4:7], s0 offen offset:512 sc1
    v_mfma_f32_16x16x32_bf16 v[56:59], a[12:15], v[108:111], v[56:59]
    ds_read_b128 v[108:111], v0 offset:12288
    v_mfma_f32_16x16x32_bf16 v[60:63], a[8:11], v[112:115], v[60:63]
    buffer_load_dwordx4 v0, s[44:47], s54 offen offset:2048 sc1 lds
    v_mfma_f32_16x16x32_bf16 v[64:67], a[12:15], v[112:115], v[64:67]
    ds_read_b128 v[112:115], v0 offset:13312
    v_mfma_f32_16x16x32_bf16 v[68:71], a[8:11], v[116:119], v[68:71]
    buffer_load_dwordx2 v[188:189], v192, s[4:7], s0 offen offset:1024 sc1
    v_mfma_f32_16x16x32_bf16 v[72:75], a[12:15], v[116:119], v[72:75]
    ds_read_b128 v[116:119], v0 offset:14336
    s_waitcnt lgkmcnt(3)
    v_mfma_f32_16x16x32_bf16 v[76:79], a[8:11], v[120:123], v[76:79]
    v_mfma_f32_16x16x32_bf16 v[80:83], a[12:15], v[120:123], v[80:83]
    ds_read_b128 v[120:123], v0 offset:15360
    v_mfma_f32_16x16x32_bf16 v[44:47], a[16:19], v[124:127], v[44:47]
    buffer_load_dwordx4 v0, s[44:47], s54 offen offset:3072 sc1 lds
    v_mfma_f32_16x16x32_bf16 v[48:51], a[20:23], v[124:127], v[48:51]
    s_waitcnt vmcnt(17)
    s_barrier
    ds_read_b128 v[124:127], v0 offset:16384
    buffer_load_dwordx2 v[190:191], v192, s[4:7], s0 offen offset:1536 sc1
    v_mfma_f32_16x16x32_bf16 v[52:55], a[16:19], v[128:131], v[52:55]
    v_mfma_f32_16x16x32_bf16 v[56:59], a[20:23], v[128:131], v[56:59]
    ds_read_b128 v[128:131], v0 offset:17408
    s_waitcnt lgkmcnt(3)
    v_mfma_f32_16x16x32_bf16 v[60:63], a[16:19], v[108:111], v[60:63]
    s_waitcnt vmcnt(12)
    ds_read_b128 a[48:51], v209 offset:0
    ds_read_b128 a[52:55], v209 offset:2048
    ds_read_b128 a[128:131], v208 offset:0
    ds_read_b128 a[132:135], v208 offset:2048
    v_mfma_f32_16x16x32_bf16 v[64:67], a[20:23], v[108:111], v[64:67]
    ds_read_b128 v[108:111], v0 offset:18432
    v_mfma_f32_16x16x32_bf16 v[68:71], a[16:19], v[112:115], v[68:71]
    s_add_u32 s54, s20, 49152
    s_add_u32 m0, s73, 49152
    s_nop 0
    buffer_load_dwordx4 v0, s[44:47], s54 offen offset:0 sc1 lds
    v_mfma_f32_16x16x32_bf16 v[72:75], a[20:23], v[112:115], v[72:75]
    ds_read_b128 v[112:115], v0 offset:19456
    v_mfma_f32_16x16x32_bf16 v[76:79], a[16:19], v[116:119], v[76:79]
    v_mfma_f32_16x16x32_bf16 v[80:83], a[20:23], v[116:119], v[80:83]
    ds_read_b128 v[116:119], v0 offset:20480
    s_waitcnt lgkmcnt(7)
    v_mfma_f32_16x16x32_bf16 v[44:47], a[24:27], v[120:123], v[44:47]
    v_mfma_f32_16x16x32_bf16 v[48:51], a[28:31], v[120:123], v[48:51]
    ds_read_b128 v[120:123], v0 offset:21504
    v_mfma_f32_16x16x32_bf16 v[52:55], a[24:27], v[124:127], v[52:55]
    buffer_load_dwordx4 v0, s[44:47], s54 offen offset:1024 sc1 lds
    v_mfma_f32_16x16x32_bf16 v[56:59], a[28:31], v[124:127], v[56:59]
    ds_read_b128 v[124:127], v0 offset:22528
    s_waitcnt lgkmcnt(5)
    s_add_u32 m0, s101, 0
    s_add_u32 s48, s1, 1024
    buffer_load_dwordx4 v214, s[76:79], s48 offen lds
    s_add_u32 m0, s101, 1024
    s_add_u32 s48, s1, 11264
    buffer_load_dwordx4 v214, s[76:79], s48 offen lds
    s_add_u32 m0, s101, 2048
    s_add_u32 s48, s1, 21504
    buffer_load_dwordx4 v214, s[76:79], s48 offen lds
    s_add_u32 m0, s101, 3072
    s_add_u32 s48, s1, 31744
    buffer_load_dwordx4 v214, s[76:79], s48 offen lds
    v_mfma_f32_16x16x32_bf16 v[60:63], a[24:27], v[128:131], v[60:63]
    v_mfma_f32_16x16x32_bf16 v[64:67], a[28:31], v[128:131], v[64:67]
    ds_read_b128 v[128:131], v0 offset:23552
    s_waitcnt lgkmcnt(3)
    v_mfma_f32_16x16x32_bf16 v[68:71], a[24:27], v[108:111], v[68:71]
    v_mfma_f32_16x16x32_bf16 v[72:75], a[28:31], v[108:111], v[72:75]
    ds_read_b128 v[108:111], v0 offset:24576
    v_mfma_f32_16x16x32_bf16 v[76:79], a[24:27], v[112:115], v[76:79]
    s_add_u32 m0, s73, 49152
    s_nop 0
    buffer_load_dwordx4 v0, s[44:47], s54 offen offset:2048 sc1 lds
    v_mfma_f32_16x16x32_bf16 v[80:83], a[28:31], v[112:115], v[80:83]
    ds_read_b128 v[112:115], v0 offset:25600
    v_mfma_f32_16x16x32_bf16 v[44:47], a[32:35], v[116:119], v[44:47]
    v_mfma_f32_16x16x32_bf16 v[48:51], a[36:39], v[116:119], v[48:51]
    ds_read_b128 v[116:119], v0 offset:26624
    s_waitcnt lgkmcnt(3)
    v_mfma_f32_16x16x32_bf16 v[52:55], a[32:35], v[120:123], v[52:55]
    v_mfma_f32_16x16x32_bf16 v[56:59], a[36:39], v[120:123], v[56:59]
    ds_read_b128 v[120:123], v0 offset:27648
    v_mfma_f32_16x16x32_bf16 v[60:63], a[32:35], v[124:127], v[60:63]
    v_mfma_f32_16x16x32_bf16 v[64:67], a[36:39], v[124:127], v[64:67]
    ds_read_b128 v[124:127], v0 offset:28672
    v_mfma_f32_16x16x32_bf16 v[68:71], a[32:35], v[128:131], v[68:71]
    buffer_load_dwordx4 v0, s[44:47], s54 offen offset:3072 sc1 lds
    v_mfma_f32_16x16x32_bf16 v[72:75], a[36:39], v[128:131], v[72:75]
    ds_read_b128 v[128:131], v0 offset:29696
    s_waitcnt lgkmcnt(3)
    v_mfma_f32_16x16x32_bf16 v[76:79], a[32:35], v[108:111], v[76:79]
    s_waitcnt vmcnt(8)
    s_lshl_b32 s48, s14, 9
    s_add_u32 s48, s48, 153600
    v_add_u32 v192, s48, v192
    v_mfma_f32_16x16x32_bf16 v[80:83], a[36:39], v[108:111], v[80:83]
    ds_read_b128 v[108:111], v0 offset:30720
    v_mfma_f32_16x16x32_bf16 v[44:47], a[40:43], v[112:115], v[44:47]
    v_add_f32 v184, v184, v186
    v_mfma_f32_16x16x32_bf16 v[48:51], a[44:47], v[112:115], v[48:51]
    ds_read_b128 v[112:115], v0 offset:31744
    v_mfma_f32_16x16x32_bf16 v[52:55], a[40:43], v[116:119], v[52:55]
    s_add_u32 s54, s20, 65536
    s_add_u32 m0, s73, 65536
    s_nop 0
    buffer_load_dwordx4 v0, s[44:47], s54 offen offset:0 sc1 lds
    v_mfma_f32_16x16x32_bf16 v[56:59], a[44:47], v[116:119], v[56:59]
    s_barrier
    ds_read_b128 v[116:119], v0 offset:32768
    v_add_f32 v185, v185, v187
    s_waitcnt lgkmcnt(3)
    v_mfma_f32_16x16x32_bf16 v[60:63], a[40:43], v[120:123], v[60:63]
    v_add_f32 v184, v184, v188
    v_mfma_f32_16x16x32_bf16 v[64:67], a[44:47], v[120:123], v[64:67]
    ds_read_b128 v[120:123], v0 offset:33792
    v_mfma_f32_16x16x32_bf16 v[68:71], a[40:43], v[124:127], v[68:71]
    v_add_f32 v185, v185, v189
    v_mfma_f32_16x16x32_bf16 v[72:75], a[44:47], v[124:127], v[72:75]
    ds_read_b128 v[124:127], v0 offset:34816
    s_waitcnt vmcnt(3)
    ds_read_b128 a[136:139], v208 offset:0
    ds_read_b128 a[140:143], v208 offset:2048
    ds_read_b128 a[56:59], v212 offset:0
    ds_read_b128 a[60:63], v212 offset:2048
    ds_read_b128 a[144:147], v213 offset:0
    ds_read_b128 a[148:151], v213 offset:2048
    ds_read_b128 a[152:155], v209 offset:4096
    ds_read_b128 a[156:159], v209 offset:6144
    v_mfma_f32_16x16x32_bf16 v[76:79], a[40:43], v[128:131], v[76:79]
    buffer_load_dwordx4 v0, s[44:47], s54 offen offset:1024 sc1 lds
    v_mfma_f32_16x16x32_bf16 v[80:83], a[44:47], v[128:131], v[80:83]
    ds_read_b128 v[128:131], v0 offset:35840
    v_add_f32 v184, v184, v190
    s_waitcnt lgkmcnt(11)
    v_mfma_f32_16x16x32_bf16 v[44:47], a[48:51], v[108:111], v[44:47]
    v_add_f32 v185, v185, v191
    v_mfma_f32_16x16x32_bf16 v[48:51], a[52:55], v[108:111], v[48:51]
    ds_read_b128 v[108:111], v0 offset:36864
    v_mfma_f32_16x16x32_bf16 v[52:55], a[48:51], v[112:115], v[52:55]
    ds_write_b64 v192, v[184:185]
    v_mfma_f32_16x16x32_bf16 v[56:59], a[52:55], v[112:115], v[56:59]
    ds_read_b128 v[112:115], v0 offset:37888
    v_mfma_f32_16x16x32_bf16 v[60:63], a[48:51], v[116:119], v[60:63]
    buffer_load_dwordx4 v0, s[44:47], s54 offen offset:2048 sc1 lds
    v_mfma_f32_16x16x32_bf16 v[64:67], a[52:55], v[116:119], v[64:67]
    ds_read_b128 v[116:119], v0 offset:38912
    v_lshrrev_b32 v192, 2, v29
    s_waitcnt lgkmcnt(4)
    v_mfma_f32_16x16x32_bf16 v[68:71], a[48:51], v[120:123], v[68:71]
    v_and_b32 v192, 511, v192
    v_mfma_f32_16x16x32_bf16 v[72:75], a[52:55], v[120:123], v[72:75]
    ds_read_b128 v[120:123], v0 offset:39936
    v_mfma_f32_16x16x32_bf16 v[76:79], a[48:51], v[124:127], v[76:79]
    v_add_u32 v193, 153600, v192
    v_mfma_f32_16x16x32_bf16 v[80:83], a[52:55], v[124:127], v[80:83]
    ds_read_b128 v[124:127], v0 offset:40960
    v_mfma_f32_16x16x32_bf16 v[44:47], a[56:59], v[128:131], v[44:47]
    buffer_load_dwordx4 v0, s[44:47], s54 offen offset:3072 sc1 lds
    v_mfma_f32_16x16x32_bf16 v[48:51], a[60:63], v[128:131], v[48:51]
    ds_read_b128 v[128:131], v0 offset:41984
    v_add_u32 v192, 147456, v192
    s_waitcnt lgkmcnt(3)
    v_mfma_f32_16x16x32_bf16 v[52:55], a[56:59], v[108:111], v[52:55]
    s_barrier
    v_mfma_f32_16x16x32_bf16 v[56:59], a[60:63], v[108:111], v[56:59]
    ds_read_b128 v[108:111], v0 offset:43008
    v_mfma_f32_16x16x32_bf16 v[60:63], a[56:59], v[112:115], v[60:63]
    ds_read_b32 v184, v193 offset:0
    v_mfma_f32_16x16x32_bf16 v[64:67], a[60:63], v[112:115], v[64:67]
    ds_read_b128 v[112:115], v0 offset:44032
    v_mfma_f32_16x16x32_bf16 v[68:71], a[56:59], v[116:119], v[68:71]
    s_add_u32 s54, s20, 81920
    s_add_u32 m0, s73, 81920
    s_nop 0
    buffer_load_dwordx4 v0, s[44:47], s54 offen offset:0 sc1 lds
    v_mfma_f32_16x16x32_bf16 v[72:75], a[60:63], v[116:119], v[72:75]
    ds_read_b128 v[116:119], v0 offset:45056
    ds_read_b32 v185, v193 offset:512
    s_waitcnt lgkmcnt(5)
    v_mfma_f32_16x16x32_bf16 v[76:79], a[56:59], v[120:123], v[76:79]
    ds_read_b32 v186, v193 offset:1024
    v_mfma_f32_16x16x32_bf16 v[80:83], a[60:63], v[120:123], v[80:83]
    ds_read_b128 v[120:123], v0 offset:46080
    v_mfma_f32_16x16x32_bf16 v[44:47], a[64:67], v[124:127], v[44:47]
    ds_read_b32 v187, v193 offset:1536
    v_mfma_f32_16x16x32_bf16 v[48:51], a[68:71], v[124:127], v[48:51]
    ds_read_b128 v[124:127], v0 offset:47104
    s_lshr_b32 s51, s41, 1
    s_add_u32 s51, s51, 4096
    buffer_load_dword v38, v31, s[4:7], s51 offen sc1
    v_mfma_f32_16x16x32_bf16 v[52:55], a[64:67], v[128:131], v[52:55]
    buffer_load_dwordx4 v0, s[44:47], s54 offen offset:1024 sc1 lds
    v_mfma_f32_16x16x32_bf16 v[56:59], a[68:71], v[128:131], v[56:59]
    ds_read_b128 v[128:131], v0 offset:48128
    s_waitcnt lgkmcnt(6)
    v_mfma_f32_16x16x32_bf16 v[60:63], a[64:67], v[108:111], v[60:63]
    v_mfma_f32_16x16x32_bf16 v[64:67], a[68:71], v[108:111], v[64:67]
    ds_read_b128 v[108:111], v0 offset:49152
    v_mfma_f32_16x16x32_bf16 v[68:71], a[64:67], v[112:115], v[68:71]
    v_mfma_f32_16x16x32_bf16 v[72:75], a[68:71], v[112:115], v[72:75]
    ds_read_b128 v[112:115], v0 offset:50176
    v_mfma_f32_16x16x32_bf16 v[76:79], a[64:67], v[116:119], v[76:79]
    v_pk_add_f32 v[132:133], v[132:133], v[134:135]
    v_mfma_f32_16x16x32_bf16 v[80:83], a[68:71], v[116:119], v[80:83]
    s_waitcnt vmcnt(7)
    s_barrier
    ds_read_b128 v[116:119], v0 offset:51200
    s_waitcnt lgkmcnt(5)
    v_add_f32 v184, v184, v185
    s_waitcnt lgkmcnt(3)
    v_mfma_f32_16x16x32_bf16 v[44:47], a[72:75], v[120:123], v[44:47]
    buffer_load_dwordx4 v0, s[44:47], s54 offen offset:2048 sc1 lds
    v_pk_add_f32 v[136:137], v[136:137], v[138:139]
    v_mfma_f32_16x16x32_bf16 v[48:51], a[76:79], v[120:123], v[48:51]
    ds_read_b128 v[120:123], v0 offset:52224
    v_add_f32 v186, v186, v187
    v_mfma_f32_16x16x32_bf16 v[52:55], a[72:75], v[124:127], v[52:55]
    v_mov_b32 v134, v132
    v_mfma_f32_16x16x32_bf16 v[56:59], a[76:79], v[124:127], v[56:59]
    ds_read_b128 v[124:127], v0 offset:53248
    v_add_f32 v184, v184, v186
    v_mfma_f32_16x16x32_bf16 v[60:63], a[72:75], v[128:131], v[60:63]
    v_mov_b32 v135, v133
    v_mfma_f32_16x16x32_bf16 v[64:67], a[76:79], v[128:131], v[64:67]
    ds_read_b128 v[128:131], v0 offset:54272
    ds_write_b32 v192, v184
    s_waitcnt lgkmcnt(4)
    v_mfma_f32_16x16x32_bf16 v[68:71], a[72:75], v[108:111], v[68:71]
    buffer_load_dwordx4 v0, s[44:47], s54 offen offset:3072 sc1 lds
    v_mfma_f32_16x16x32_bf16 v[72:75], a[76:79], v[108:111], v[72:75]
    ds_read_b128 v[108:111], v0 offset:55296
    v_mov_b32 v138, v136
    v_mfma_f32_16x16x32_bf16 v[76:79], a[72:75], v[112:115], v[76:79]
    v_mov_b32 v139, v137
    v_mfma_f32_16x16x32_bf16 v[80:83], a[76:79], v[112:115], v[80:83]
    ds_read_b128 v[112:115], v0 offset:56320
    v_mfma_f32_16x16x32_bf16 v[44:47], a[80:83], v[116:119], v[44:47]
    v_permlane16_swap_b32 v132, v134
    v_mfma_f32_16x16x32_bf16 v[48:51], a[84:87], v[116:119], v[48:51]
    ds_read_b128 v[116:119], v0 offset:57344
    s_waitcnt lgkmcnt(4)
    v_mfma_f32_16x16x32_bf16 v[52:55], a[80:83], v[120:123], v[52:55]
    s_add_u32 s54, s20, 98304
    s_add_u32 m0, s73, 98304
    s_nop 0
    buffer_load_dwordx4 v0, s[44:47], s54 offen offset:0 sc1 lds
    v_mfma_f32_16x16x32_bf16 v[56:59], a[84:87], v[120:123], v[56:59]
    ds_read_b128 v[120:123], v0 offset:58368
    v_permlane16_swap_b32 v133, v135
    v_mfma_f32_16x16x32_bf16 v[60:63], a[80:83], v[124:127], v[60:63]
    v_permlane16_swap_b32 v136, v138
    v_mfma_f32_16x16x32_bf16 v[64:67], a[84:87], v[124:127], v[64:67]
    ds_read_b128 v[124:127], v0 offset:59392
    v_mfma_f32_16x16x32_bf16 v[68:71], a[80:83], v[128:131], v[68:71]
    v_permlane16_swap_b32 v137, v139
    v_mfma_f32_16x16x32_bf16 v[72:75], a[84:87], v[128:131], v[72:75]
    ds_read_b128 v[128:131], v0 offset:60416
    v_add_f32 v132, v132, v134
    s_waitcnt lgkmcnt(3)
    v_mfma_f32_16x16x32_bf16 v[76:79], a[80:83], v[108:111], v[76:79]
    buffer_load_dwordx4 v0, s[44:47], s54 offen offset:1024 sc1 lds
    v_add_f32 v133, v133, v135
    v_mfma_f32_16x16x32_bf16 v[80:83], a[84:87], v[108:111], v[80:83]
    ds_read_b128 v[108:111], v0 offset:61440
    s_waitcnt vmcnt(5)
    v_subrev_u32 v38, s19, v38
    v_cmp_lt_u32 vcc, 7, v38
    s_nop 1
    s_and_b64 vcc, vcc, 0xffff
    s_cbranch_scc1 interleave_layers__linear_attn_block__geglu_ffn__prompt_kernel_aspin21
interleave_layers__linear_attn_block__geglu_ffn__prompt_kernel_adone20:
    v_readfirstlane_b32 s50, v38
    s_mov_b64 exec, 0xffff
    s_nop 0
    v_cmp_ne_u32 vcc, s50, v38
    s_mov_b64 exec, -1
    s_nop 0
    s_cmp_eq_u64 vcc, 0
    s_cselect_b32 s18, 1, 0
    v_mfma_f32_16x16x32_bf16 v[44:47], a[88:91], v[112:115], v[44:47]
    v_add_f32 v136, v136, v138
    v_mfma_f32_16x16x32_bf16 v[48:51], a[92:95], v[112:115], v[48:51]
    ds_read_b128 v[112:115], v0 offset:62464
    v_mfma_f32_16x16x32_bf16 v[52:55], a[88:91], v[116:119], v[52:55]
    v_add_f32 v137, v137, v139
    v_mfma_f32_16x16x32_bf16 v[56:59], a[92:95], v[116:119], v[56:59]
    ds_read_b128 v[116:119], v0 offset:63488
    s_waitcnt lgkmcnt(3)
    v_mfma_f32_16x16x32_bf16 v[60:63], a[88:91], v[120:123], v[60:63]
    buffer_load_dwordx4 v0, s[44:47], s54 offen offset:2048 sc1 lds
    v_mfma_f32_16x16x32_bf16 v[64:67], a[92:95], v[120:123], v[64:67]
    ds_read_b128 v[120:123], v0 offset:64512
    v_mov_b32 v134, v132
    v_mfma_f32_16x16x32_bf16 v[68:71], a[88:91], v[124:127], v[68:71]
    v_mov_b32 v135, v133
    v_mfma_f32_16x16x32_bf16 v[72:75], a[92:95], v[124:127], v[72:75]
    s_barrier
    ds_read_b128 v[124:127], v2 offset:0
    v_mfma_f32_16x16x32_bf16 v[76:79], a[88:91], v[128:131], v[76:79]
    v_mov_b32 v138, v136
    v_mfma_f32_16x16x32_bf16 v[80:83], a[92:95], v[128:131], v[80:83]
    ds_read_b128 v[128:131], v2 offset:1024
    s_waitcnt lgkmcnt(3)
    v_mfma_f32_16x16x32_bf16 v[44:47], a[96:99], v[108:111], v[44:47]
    buffer_load_dwordx4 v0, s[44:47], s54 offen offset:3072 sc1 lds
    v_mfma_f32_16x16x32_bf16 v[48:51], a[100:103], v[108:111], v[48:51]
    ds_read_b128 v[108:111], v2 offset:2048
    v_mov_b32 v139, v137
    v_mfma_f32_16x16x32_bf16 v[52:55], a[96:99], v[112:115], v[52:55]
    v_permlane32_swap_b32 v132, v134
    v_mfma_f32_16x16x32_bf16 v[56:59], a[100:103], v[112:115], v[56:59]
    ds_read_b128 v[112:115], v2 offset:3072
    v_mfma_f32_16x16x32_bf16 v[60:63], a[96:99], v[116:119], v[60:63]
    v_permlane32_swap_b32 v133, v135
    v_mfma_f32_16x16x32_bf16 v[64:67], a[100:103], v[116:119], v[64:67]
    ds_read_b128 v[116:119], v2 offset:4096
    v_permlane32_swap_b32 v136, v138
    s_waitcnt lgkmcnt(3)
    v_mfma_f32_16x16x32_bf16 v[68:71], a[96:99], v[120:123], v[68:71]
    v_permlane32_swap_b32 v137, v139
    v_mfma_f32_16x16x32_bf16 v[72:75], a[100:103], v[120:123], v[72:75]
    ds_read_b128 v[120:123], v2 offset:5120
    v_mfma_f32_16x16x32_bf16 v[76:79], a[96:99], v[124:127], v[76:79]
    s_add_u32 s54, s20, 114688
    s_add_u32 m0, s73, 114688
    s_nop 0
    buffer_load_dwordx4 v0, s[44:47], s54 offen offset:0 sc1 lds
    v_mfma_f32_16x16x32_bf16 v[80:83], a[100:103], v[124:127], v[80:83]
    ds_read_b128 v[124:127], v2 offset:6144
    v_add_f32 v132, v132, v134
    v_mfma_f32_16x16x32_bf16 v[44:47], a[104:107], v[128:131], v[44:47]
    v_add_f32 v133, v133, v135
    v_mfma_f32_16x16x32_bf16 v[48:51], a[108:111], v[128:131], v[48:51]
    ds_read_b128 v[128:131], v2 offset:7168
    s_waitcnt lgkmcnt(3)
    v_mfma_f32_16x16x32_bf16 v[52:55], a[104:107], v[108:111], v[52:55]
    v_add_f32 v136, v136, v138
    v_mfma_f32_16x16x32_bf16 v[56:59], a[108:111], v[108:111], v[56:59]
    ds_read_b128 v[108:111], v2 offset:8192
    v_mfma_f32_16x16x32_bf16 v[60:63], a[104:107], v[112:115], v[60:63]
    buffer_load_dwordx4 v0, s[44:47], s54 offen offset:1024 sc1 lds
    v_mfma_f32_16x16x32_bf16 v[64:67], a[108:111], v[112:115], v[64:67]
    ds_read_b128 v[112:115], v2 offset:9216
    v_add_f32 v137, v137, v139
    v_mfma_f32_16x16x32_bf16 v[68:71], a[104:107], v[116:119], v[68:71]
    v_mul_f32 v135, 0x3acccccd, v133
    v_mfma_f32_16x16x32_bf16 v[72:75], a[108:111], v[116:119], v[72:75]
    ds_read_b128 v[116:119], v2 offset:10240
    s_waitcnt lgkmcnt(3)
    v_mfma_f32_16x16x32_bf16 v[76:79], a[104:107], v[120:123], v[76:79]
    v_mul_f32 v133, 0xbacccccd, v132
    v_mfma_f32_16x16x32_bf16 v[80:83], a[108:111], v[120:123], v[80:83]
    ds_read_b128 v[120:123], v2 offset:11264
    v_mfma_f32_16x16x32_bf16 v[44:47], a[112:115], v[124:127], v[44:47]
    buffer_load_dwordx4 v0, s[44:47], s54 offen offset:2048 sc1 lds
    v_mfma_f32_16x16x32_bf16 v[48:51], a[116:119], v[124:127], v[48:51]
    ds_read_b128 v[124:127], v2 offset:12288
    v_mul_f32 v139, 0x3acccccd, v137
    v_mfma_f32_16x16x32_bf16 v[52:55], a[112:115], v[128:131], v[52:55]
    v_mul_f32 v137, 0xbacccccd, v136
    v_mfma_f32_16x16x32_bf16 v[56:59], a[116:119], v[128:131], v[56:59]
    ds_read_b128 v[128:131], v2 offset:13312
    v_fma_f32 v135, -v133, v133, v135
    s_waitcnt lgkmcnt(3)
    v_mfma_f32_16x16x32_bf16 v[60:63], a[112:115], v[108:111], v[60:63]
    v_fma_f32 v139, -v137, v137, v139
    v_mfma_f32_16x16x32_bf16 v[64:67], a[116:119], v[108:111], v[64:67]
    ds_read_b128 v[108:111], v2 offset:14336
    v_mfma_f32_16x16x32_bf16 v[68:71], a[112:115], v[112:115], v[68:71]
    buffer_load_dwordx4 v0, s[44:47], s54 offen offset:3072 sc1 lds
    v_mfma_f32_16x16x32_bf16 v[72:75], a[116:119], v[112:115], v[72:75]
    ds_read_b128 v[112:115], v2 offset:15360
    v_max_f32 v135, 0, v135
    v_mfma_f32_16x16x32_bf16 v[76:79], a[112:115], v[116:119], v[76:79]
    v_max_f32 v139, 0, v139
    v_mfma_f32_16x16x32_bf16 v[80:83], a[116:119], v[116:119], v[80:83]
    ds_read_b128 v[116:119], v2 offset:16384
    s_waitcnt lgkmcnt(3)
    v_mfma_f32_16x16x32_bf16 v[44:47], a[120:123], v[120:123], v[44:47]
    v_add_f32 v135, 0x3727c5ac, v135
    v_mfma_f32_16x16x32_bf16 v[48:51], a[124:127], v[120:123], v[48:51]
    s_waitcnt vmcnt(8)
    s_barrier
    ds_read_b128 v[120:123], v2 offset:17408
    v_mfma_f32_16x16x32_bf16 v[52:55], a[120:123], v[124:127], v[52:55]
    v_add_f32 v139, 0x3727c5ac, v139
    v_mfma_f32_16x16x32_bf16 v[56:59], a[124:127], v[124:127], v[56:59]
    ds_read_b128 v[124:127], v2 offset:18432
    v_mfma_f32_16x16x32_bf16 v[60:63], a[120:123], v[128:131], v[60:63]
    v_rsq_f32 v132, v135
    v_mfma_f32_16x16x32_bf16 v[64:67], a[124:127], v[128:131], v[64:67]
    ds_read_b128 v[128:131], v2 offset:19456
    s_waitcnt lgkmcnt(3)
    v_mfma_f32_16x16x32_bf16 v[68:71], a[120:123], v[108:111], v[68:71]
    v_rsq_f32 v136, v139
    v_mfma_f32_16x16x32_bf16 v[72:75], a[124:127], v[108:111], v[72:75]
    ds_read_b128 v[108:111], v2 offset:20480
    v_mfma_f32_16x16x32_bf16 v[76:79], a[120:123], v[112:115], v[76:79]
    s_mov_b32 s92, 0xffff0000
    v_mfma_f32_16x16x32_bf16 v[80:83], a[124:127], v[112:115], v[80:83]
    ds_read_b128 v[112:115], v2 offset:21504
    v_mfma_f32_16x16x32_bf16 v[44:47], a[128:131], v[116:119], v[44:47]
    s_mov_b32 s93, 0xffff0000
    v_mfma_f32_16x16x32_bf16 v[48:51], a[132:135], v[116:119], v[48:51]
    ds_read_b128 v[116:119], v2 offset:22528
    v_cndmask_b32 v135, v132, v136, s[92:93]
    s_waitcnt lgkmcnt(3)
    v_mfma_f32_16x16x32_bf16 v[52:55], a[128:131], v[120:123], v[52:55]
    v_cndmask_b32 v139, v133, v137, s[92:93]
    v_mfma_f32_16x16x32_bf16 v[56:59], a[132:135], v[120:123], v[56:59]
    ds_read_b128 v[120:123], v2 offset:23552
    v_mfma_f32_16x16x32_bf16 v[60:63], a[128:131], v[124:127], v[60:63]
    s_mov_b32 s92, 0x0
    v_mfma_f32_16x16x32_bf16 v[64:67], a[132:135], v[124:127], v[64:67]
    ds_read_b128 v[124:127], v2 offset:24576
    v_mfma_f32_16x16x32_bf16 v[68:71], a[128:131], v[128:131], v[68:71]
    s_mov_b32 s93, 0xffffffff
    v_mfma_f32_16x16x32_bf16 v[72:75], a[132:135], v[128:131], v[72:75]
    ds_read_b128 v[128:131], v2 offset:25600
    s_waitcnt lgkmcnt(3)
    v_mfma_f32_16x16x32_bf16 v[76:79], a[128:131], v[108:111], v[76:79]
    v_cndmask_b32 v135, v135, v139, s[92:93]
    v_mfma_f32_16x16x32_bf16 v[80:83], a[132:135], v[108:111], v[80:83]
    ds_read_b128 v[108:111], v2 offset:26624
    v_mfma_f32_16x16x32_bf16 v[44:47], a[136:139], v[112:115], v[44:47]
    ds_write_b32 v25, v135
    v_mfma_f32_16x16x32_bf16 v[48:51], a[140:143], v[112:115], v[48:51]
    ds_read_b128 v[112:115], v2 offset:27648
    v_mfma_f32_16x16x32_bf16 v[52:55], a[136:139], v[116:119], v[52:55]
    ds_read_b128 v[140:143], v26 offset:0
    v_mfma_f32_16x16x32_bf16 v[56:59], a[140:143], v[116:119], v[56:59]
    ds_read_b128 v[116:119], v2 offset:28672
    s_waitcnt lgkmcnt(5)
    v_mfma_f32_16x16x32_bf16 v[60:63], a[136:139], v[120:123], v[60:63]
    ds_read_b128 v[148:151], v26 offset:128
    v_mfma_f32_16x16x32_bf16 v[64:67], a[140:143], v[120:123], v[64:67]
    ds_read_b128 v[120:123], v2 offset:29696
    v_mfma_f32_16x16x32_bf16 v[68:71], a[136:139], v[124:127], v[68:71]
    ds_read_b128 v[144:147], v26 offset:64
    buffer_load_dword v40, v31, s[4:7], s43 offen sc1
    v_mfma_f32_16x16x32_bf16 v[72:75], a[140:143], v[124:127], v[72:75]
    ds_read_b128 v[124:127], v2 offset:30720
    s_lshr_b32 s51, s43, 0
    s_add_u32 s51, s51, 256
    buffer_load_dword v38, v31, s[4:7], s51 offen sc1
    v_mfma_f32_16x16x32_bf16 v[76:79], a[136:139], v[128:131], v[76:79]
    ds_read_b128 v[152:155], v26 offset:192
    v_mfma_f32_16x16x32_bf16 v[80:83], a[140:143], v[128:131], v[80:83]
    ds_read_b128 v[128:131], v2 offset:31744
    s_mov_b32 s92, 0x800080
    s_waitcnt lgkmcnt(6)
    s_barrier
    v_mfma_f32_16x16x32_bf16 v[44:47], a[144:147], v[108:111], v[44:47]
    s_mov_b32 s93, 0x800080
    v_mfma_f32_16x16x32_bf16 v[48:51], a[148:151], v[108:111], v[48:51]
    s_waitcnt vmcnt(6)
    s_barrier
    ds_read_b128 v[108:111], v2 offset:32768
    v_mfma_f32_16x16x32_bf16 v[52:55], a[144:147], v[112:115], v[52:55]
    v_add_u32 v104, 1680, v17
    v_mfma_f32_16x16x32_bf16 v[56:59], a[148:151], v[112:115], v[56:59]
    ds_read_b128 v[112:115], v2 offset:33792
    v_mfma_f32_16x16x32_bf16 v[60:63], a[144:147], v[116:119], v[60:63]
    v_add_u32 v106, 2000, v17
    v_mfma_f32_16x16x32_bf16 v[64:67], a[148:151], v[116:119], v[64:67]
    ds_read_b128 v[116:119], v2 offset:34816
    s_waitcnt lgkmcnt(3)
    v_mfma_f32_16x16x32_bf16 v[68:71], a[144:147], v[120:123], v[68:71]
    v_cndmask_b32 v104, v17, v104, s[92:93]
    v_mfma_f32_16x16x32_bf16 v[72:75], a[148:151], v[120:123], v[72:75]
    ds_read_b128 v[120:123], v2 offset:35840
    v_mfma_f32_16x16x32_bf16 v[76:79], a[144:147], v[124:127], v[76:79]
    v_cndmask_b32 v106, v17, v106, s[92:93]
    v_mfma_f32_16x16x32_bf16 v[80:83], a[148:151], v[124:127], v[80:83]
    ds_read_b32 v156, v27 offset:0
    v_mfma_f32_16x16x32_bf16 v[44:47], a[152:155], v[128:131], v[44:47]
    s_mov_b32 s92, 0x800000
    v_mfma_f32_16x16x32_bf16 v[48:51], a[156:159], v[128:131], v[48:51]
    ds_read_b32 v157, v27 offset:64
    s_waitcnt lgkmcnt(3)
    v_mfma_f32_16x16x32_bf16 v[52:55], a[152:155], v[108:111], v[52:55]
    v_add_u32 v105, 1600, v104
    v_mfma_f32_16x16x32_bf16 v[56:59], a[156:159], v[108:111], v[56:59]
    ds_read_b32 v158, v27 offset:128
    v_mfma_f32_16x16x32_bf16 v[60:63], a[152:155], v[112:115], v[60:63]
    v_cndmask_b32 v105, v104, v105, s[92:93]
    v_mfma_f32_16x16x32_bf16 v[64:67], a[156:159], v[112:115], v[64:67]
    ds_read_b32 v159, v27 offset:192
    v_mfma_f32_16x16x32_bf16 v[68:71], a[152:155], v[116:119], v[68:71]
    buffer_load_dword v43, v34, s[4:7], s28 offen sc1
    v_mfma_f32_16x16x32_bf16 v[72:75], a[156:159], v[116:119], v[72:75]
    ds_read_b32 v160, v27 offset:256
    s_waitcnt lgkmcnt(5)
    v_mfma_f32_16x16x32_bf16 v[76:79], a[152:155], v[120:123], v[76:79]
    v_mfma_f32_16x16x32_bf16 v[80:83], a[156:159], v[120:123], v[80:83]
    s_waitcnt vmcnt(3)
    s_add_u32 s48, s3, 2
    s_waitcnt vmcnt(2)
    v_subrev_u32 v40, s48, v40
    v_cmp_lt_u32 vcc, 3, v40
    s_nop 1
    s_and_b64 vcc, vcc, s[64:65]
    s_cbranch_scc1 interleave_layers__linear_attn_block__geglu_ffn__prompt_kernel_aspin25
interleave_layers__linear_attn_block__geglu_ffn__prompt_kernel_adone24:
    s_add_u32 s48, s3, 2
    s_waitcnt vmcnt(1)
    v_subrev_u32 v38, s48, v38
    v_cmp_lt_u32 vcc, 3, v38
    s_nop 1
    s_and_b64 vcc, vcc, s[64:65]
    s_cbranch_scc1 interleave_layers__linear_attn_block__geglu_ffn__prompt_kernel_aspin29
interleave_layers__linear_attn_block__geglu_ffn__prompt_kernel_adone28:
    s_mul_i32 s48, s13, 6144
    s_mul_i32 s49, s14, 1536
    s_add_u32 s48, s48, s49
    s_add_u32 s48, s48, 327680
    buffer_load_dwordx4 v[172:175], v0, s[4:7], s48 offen offset:0 sc1
    buffer_load_dwordx4 v[176:179], v0, s[4:7], s48 offen offset:768 sc1
interleave_layers__linear_attn_block__geglu_ffn__prompt_kernel_merge:
    s_waitcnt lgkmcnt(0)
    v_pk_fma_f32 v[44:45], v[148:149], v[156:157], v[44:45] op_sel:[0,0,0] op_sel_hi:[1,0,1]
    s_add_u32 s54, s20, 131072
    s_add_u32 m0, s73, 131072
    s_nop 0
    buffer_load_dwordx4 v0, s[44:47], s54 offen offset:0 sc1 lds
    v_pk_fma_f32 v[46:47], v[150:151], v[156:157], v[46:47] op_sel:[0,0,0] op_sel_hi:[1,0,1]
    v_pk_fma_f32 v[48:49], v[152:153], v[156:157], v[48:49] op_sel:[0,0,0] op_sel_hi:[1,0,1]
    v_pk_fma_f32 v[50:51], v[154:155], v[156:157], v[50:51] op_sel:[0,0,0] op_sel_hi:[1,0,1]
    v_pk_fma_f32 v[44:45], v[44:45], v[140:141], s[62:63]
    v_pk_fma_f32 v[46:47], v[46:47], v[142:143], s[62:63]
    v_pk_fma_f32 v[48:49], v[48:49], v[144:145], s[62:63]
    v_pk_fma_f32 v[50:51], v[50:51], v[146:147], s[62:63]
    v_pk_fma_f32 v[52:53], v[148:149], v[156:157], v[52:53] op_sel:[0,1,0] op_sel_hi:[1,1,1]
    v_pk_fma_f32 v[54:55], v[150:151], v[156:157], v[54:55] op_sel:[0,1,0] op_sel_hi:[1,1,1]
    v_pk_fma_f32 v[56:57], v[152:153], v[156:157], v[56:57] op_sel:[0,1,0] op_sel_hi:[1,1,1]
    v_pk_fma_f32 v[58:59], v[154:155], v[156:157], v[58:59] op_sel:[0,1,0] op_sel_hi:[1,1,1]
    v_pk_fma_f32 v[52:53], v[52:53], v[140:141], s[62:63]
    v_pk_fma_f32 v[54:55], v[54:55], v[142:143], s[62:63]
    v_pk_fma_f32 v[56:57], v[56:57], v[144:145], s[62:63]
    v_pk_fma_f32 v[58:59], v[58:59], v[146:147], s[62:63]
    v_pk_fma_f32 v[60:61], v[148:149], v[158:159], v[60:61] op_sel:[0,0,0] op_sel_hi:[1,0,1]
    v_pk_fma_f32 v[62:63], v[150:151], v[158:159], v[62:63] op_sel:[0,0,0] op_sel_hi:[1,0,1]
    v_pk_fma_f32 v[64:65], v[152:153], v[158:159], v[64:65] op_sel:[0,0,0] op_sel_hi:[1,0,1]
    v_pk_fma_f32 v[66:67], v[154:155], v[158:159], v[66:67] op_sel:[0,0,0] op_sel_hi:[1,0,1]
    v_pk_mul_f32 v[60:61], v[60:61], v[140:141]
    v_pk_mul_f32 v[62:63], v[62:63], v[142:143]
    v_pk_mul_f32 v[64:65], v[64:65], v[144:145]
    v_pk_mul_f32 v[66:67], v[66:67], v[146:147]
    v_pk_fma_f32 v[68:69], v[148:149], v[158:159], v[68:69] op_sel:[0,1,0] op_sel_hi:[1,1,1]
    v_pk_fma_f32 v[70:71], v[150:151], v[158:159], v[70:71] op_sel:[0,1,0] op_sel_hi:[1,1,1]
    v_pk_fma_f32 v[72:73], v[152:153], v[158:159], v[72:73] op_sel:[0,1,0] op_sel_hi:[1,1,1]
    v_pk_fma_f32 v[74:75], v[154:155], v[158:159], v[74:75] op_sel:[0,1,0] op_sel_hi:[1,1,1]
    v_pk_mul_f32 v[68:69], v[68:69], v[140:141]
    v_pk_mul_f32 v[70:71], v[70:71], v[142:143]
    v_pk_mul_f32 v[72:73], v[72:73], v[144:145]
    v_pk_mul_f32 v[74:75], v[74:75], v[146:147]
    v_pk_fma_f32 v[76:77], v[148:149], v[160:161], v[76:77] op_sel:[0,0,0] op_sel_hi:[1,0,1]
    v_pk_fma_f32 v[78:79], v[150:151], v[160:161], v[78:79] op_sel:[0,0,0] op_sel_hi:[1,0,1]
    v_pk_fma_f32 v[80:81], v[152:153], v[160:161], v[80:81] op_sel:[0,0,0] op_sel_hi:[1,0,1]
    v_pk_fma_f32 v[82:83], v[154:155], v[160:161], v[82:83] op_sel:[0,0,0] op_sel_hi:[1,0,1]
    v_pk_mul_f32 v[76:77], v[76:77], v[140:141]
    buffer_load_dwordx4 v0, s[44:47], s54 offen offset:1024 sc1 lds
    v_pk_mul_f32 v[78:79], v[78:79], v[142:143]
    v_pk_mul_f32 v[80:81], v[80:81], v[144:145]
    v_pk_mul_f32 v[82:83], v[82:83], v[146:147]
    v_cvt_pk_bf16_f32 v96, v68, v69
    v_cvt_pk_bf16_f32 v97, v70, v71
    v_cvt_pk_bf16_f32 v98, v72, v73
    v_cvt_pk_bf16_f32 v99, v74, v75
    v_cvt_pk_bf16_f32 v100, v76, v77
    v_cvt_pk_bf16_f32 v101, v78, v79
    v_cvt_pk_bf16_f32 v102, v80, v81
    v_cvt_pk_bf16_f32 v103, v82, v83
    v_pk_fma_f32 v[108:109], v[44:45], s[60:61], v[36:37] op_sel:[0,0,1] op_sel_hi:[1,1,1]
    v_pk_fma_f32 v[110:111], v[46:47], s[60:61], v[36:37] op_sel:[0,0,1] op_sel_hi:[1,1,1]
    v_pk_fma_f32 v[112:113], v[48:49], s[60:61], v[36:37] op_sel:[0,0,1] op_sel_hi:[1,1,1]
    v_pk_fma_f32 v[114:115], v[50:51], s[60:61], v[36:37] op_sel:[0,0,1] op_sel_hi:[1,1,1]
    v_pk_fma_f32 v[116:117], v[52:53], s[60:61], v[36:37] op_sel:[0,0,1] op_sel_hi:[1,1,1]
    v_pk_fma_f32 v[118:119], v[54:55], s[60:61], v[36:37] op_sel:[0,0,1] op_sel_hi:[1,1,1]
    v_pk_fma_f32 v[120:121], v[56:57], s[60:61], v[36:37] op_sel:[0,0,1] op_sel_hi:[1,1,1]
    v_pk_fma_f32 v[122:123], v[58:59], s[60:61], v[36:37] op_sel:[0,0,1] op_sel_hi:[1,1,1]
    v_exp_f32_e64 v108, v108 clamp
    v_max_f32 v44, s62, v44
    v_exp_f32_e64 v109, v109 clamp
    v_max_f32 v45, s62, v45
    v_exp_f32_e64 v110, v110 clamp
    v_max_f32 v46, s62, v46
    v_exp_f32_e64 v111, v111 clamp
    v_max_f32 v47, s62, v47
    v_exp_f32_e64 v112, v112 clamp
    v_max_f32 v48, s62, v48
    v_exp_f32_e64 v113, v113 clamp
    buffer_load_dwordx4 v0, s[44:47], s54 offen offset:2048 sc1 lds
    v_max_f32 v49, s62, v49
    v_exp_f32_e64 v114, v114 clamp
    v_max_f32 v50, s62, v50
    v_exp_f32_e64 v115, v115 clamp
    v_max_f32 v51, s62, v51
    v_exp_f32_e64 v116, v116 clamp
    v_max_f32 v52, s62, v52
    v_exp_f32_e64 v117, v117 clamp
    v_max_f32 v53, s62, v53
    v_exp_f32_e64 v118, v118 clamp
    v_max_f32 v54, s62, v54
    v_exp_f32_e64 v119, v119 clamp
    v_max_f32 v55, s62, v55
    v_exp_f32_e64 v120, v120 clamp
    v_max_f32 v56, s62, v56
    v_exp_f32_e64 v121, v121 clamp
    v_max_f32 v57, s62, v57
    v_exp_f32_e64 v122, v122 clamp
    v_max_f32 v58, s62, v58
    v_exp_f32_e64 v123, v123 clamp
    v_max_f32 v59, s62, v59
    v_pk_add_f32 v[44:45], v[44:45], v[108:109]
    v_pk_add_f32 v[46:47], v[46:47], v[110:111]
    v_pk_add_f32 v[48:49], v[48:49], v[112:113]
    v_pk_add_f32 v[50:51], v[50:51], v[114:115]
    v_pk_add_f32 v[52:53], v[52:53], v[116:117]
    buffer_load_dwordx4 v0, s[44:47], s54 offen offset:3072 sc1 lds
    v_pk_add_f32 v[54:55], v[54:55], v[118:119]
    v_pk_add_f32 v[56:57], v[56:57], v[120:121]
    v_pk_add_f32 v[58:59], v[58:59], v[122:123]
    v_cvt_pk_bf16_f32 v84, v44, v45
    v_cvt_pk_bf16_f32 v85, v46, v47
    v_cvt_pk_bf16_f32 v86, v48, v49
    v_cvt_pk_bf16_f32 v87, v50, v51
    v_cvt_pk_bf16_f32 v88, v52, v53
    v_cvt_pk_bf16_f32 v89, v54, v55
    v_cvt_pk_bf16_f32 v90, v56, v57
    v_cvt_pk_bf16_f32 v91, v58, v59
    v_pk_add_f32 v[116:117], v[60:61], s[62:63]
    v_pk_add_f32 v[118:119], v[62:63], s[62:63]
    v_pk_add_f32 v[120:121], v[64:65], s[62:63]
    v_pk_add_f32 v[122:123], v[66:67], s[62:63]
    v_pk_fma_f32 v[108:109], v[116:117], s[60:61], v[36:37] op_sel:[0,0,1] op_sel_hi:[1,1,1]
    v_pk_fma_f32 v[110:111], v[118:119], s[60:61], v[36:37] op_sel:[0,0,1] op_sel_hi:[1,1,1]
    v_pk_fma_f32 v[112:113], v[120:121], s[60:61], v[36:37] op_sel:[0,0,1] op_sel_hi:[1,1,1]
    v_pk_fma_f32 v[114:115], v[122:123], s[60:61], v[36:37] op_sel:[0,0,1] op_sel_hi:[1,1,1]
    v_exp_f32_e64 v108, v108 clamp
    v_max_f32 v116, s62, v116
    v_exp_f32_e64 v109, v109 clamp
    v_max_f32 v117, s62, v117
    v_exp_f32_e64 v110, v110 clamp
    v_max_f32 v118, s62, v118
    v_exp_f32_e64 v111, v111 clamp
    v_max_f32 v119, s62, v119
    v_exp_f32_e64 v112, v112 clamp
    v_max_f32 v120, s62, v120
    v_exp_f32_e64 v113, v113 clamp
    buffer_load_dwordx4 a[160:163], v0, s[4:7], s22 offen offset:0 sc1
    v_max_f32 v121, s62, v121
    v_exp_f32_e64 v114, v114 clamp
    v_max_f32 v122, s62, v122
    v_exp_f32_e64 v115, v115 clamp
    v_max_f32 v123, s62, v123
    v_pk_add_f32 v[116:117], v[116:117], v[108:109]
    v_pk_add_f32 v[118:119], v[118:119], v[110:111]
    v_pk_add_f32 v[120:121], v[120:121], v[112:113]
    v_pk_add_f32 v[122:123], v[122:123], v[114:115]
    s_mov_b32 s92, 0xff00ff
    s_mov_b32 s93, 0xff00ff
    v_mfma_f32_16x16x32_bf16 v[44:47], v[84:87], v[96:99], 0
    v_mfma_f32_16x16x32_bf16 v[48:51], v[88:91], v[96:99], 0
    v_mfma_f32_16x16x32_bf16 v[52:55], v[88:91], v[100:103], 0
    v_cvt_pk_bf16_f32 v92, v116, v117
    v_cvt_pk_bf16_f32 v93, v118, v119
    v_cvt_pk_bf16_f32 v94, v120, v121
    v_cvt_pk_bf16_f32 v95, v122, v123
    v_cvt_pk_bf16_f32 v124, v60, v61
    v_cvt_pk_bf16_f32 v125, v62, v63
    v_cvt_pk_bf16_f32 v126, v64, v65
    v_cvt_pk_bf16_f32 v127, v66, v67
    v_cndmask_b32 v124, v124, v32, s[92:93]
    v_cndmask_b32 v125, v125, v32, s[92:93]
    v_cndmask_b32 v126, v126, v32, s[92:93]
    v_cndmask_b32 v127, v127, v32, s[92:93]
    v_mfma_f32_16x16x32_bf16 v[56:59], v[92:95], v[96:99], 0
    v_mfma_f32_16x16x32_bf16 v[68:71], v[92:95], v[100:103], 0
    v_mfma_f32_16x16x32_bf16 v[72:75], v[92:95], v[124:127], 0
    v_mfma_f32_16x16x32_bf16 v[76:79], v[84:87], v[124:127], 0
    v_mfma_f32_16x16x32_bf16 v[80:83], v[88:91], v[124:127], 0
    buffer_load_dwordx4 a[164:167], v0, s[4:7], s22 offen offset:1024 sc1
    buffer_load_dwordx4 a[168:171], v0, s[4:7], s22 offen offset:2048 sc1
    buffer_load_dwordx4 a[172:175], v0, s[4:7], s22 offen offset:3072 sc1
    s_mov_b32 s92, 0x800080
    s_mov_b32 s93, 0x800080
    s_mov_b32 exec_lo, 0xfff0fff
    s_mov_b32 exec_hi, 0xfff0fff
    ds_write_b128 v17, v[44:47] offset:1280
    s_mov_b32 exec_lo, 0xf0000fff
    s_mov_b32 exec_hi, 0xf000f000
    ds_write_b128 v17, v[48:51] offset:1344
    s_mov_b32 exec_lo, 0xffff0000
    s_mov_b32 exec_hi, 0xffffffff
    ds_write_b128 v17, v[52:55] offset:2624
    s_mov_b32 exec_lo, 0xffffffff
    s_mov_b32 exec_hi, 0x0
    ds_write_b128 v17, v[68:71] offset:2688
    s_mov_b64 exec, -1
    v_cndmask_b32 v56, v56, v72, s[92:93]
    v_cndmask_b32 v57, v57, v73, s[92:93]
    v_cndmask_b32 v58, v58, v74, s[92:93]
    v_cndmask_b32 v59, v59, v75, s[92:93]
    s_mov_b32 exec_lo, 0xf080f080
    s_mov_b32 exec_hi, 0x0
    ds_write_b128 v106, v[56:59] offset:1408
    s_mov_b32 exec_lo, 0xff80ff80
    s_mov_b32 exec_hi, 0xff80ff80
    ds_write_b128 v104, v[76:79] offset:0
    s_mov_b32 exec_lo, 0x80ff80
    s_mov_b32 exec_hi, 0x800080
    ds_write_b128 v105, v[80:83] offset:64
    s_mov_b64 exec, -1
    v_lshrrev_b32 v60, 2, v29
    v_add_u32 v41, 16384, v60
    s_waitcnt lgkmcnt(0)
    s_barrier
    ds_read_b32 v44, v41 offset:0
    ds_read_b32 v45, v41 offset:3360
    ds_read_b32 v46, v41 offset:6720
    ds_read_b32 v47, v41 offset:10080
    ds_read_b32 v48, v41 offset:1024
    ds_read_b32 v49, v41 offset:4384
    ds_read_b32 v50, v41 offset:7744
    ds_read_b32 v51, v41 offset:11104
    ds_read_b32 v52, v41 offset:2048
    ds_read_b32 v53, v41 offset:5408
    ds_read_b32 v54, v41 offset:8768
    ds_read_b32 v55, v41 offset:12128
    ds_read_b32 v56, v41 offset:3072
    ds_read_b32 v57, v41 offset:6432
    ds_read_b32 v58, v41 offset:9792
    ds_read_b32 v59, v41 offset:13152
    s_waitcnt lgkmcnt(12)
    v_pk_add_f32 v[44:45], v[44:45], v[46:47]
    v_add_f32 v44, v44, v45
    buffer_atomic_add_f32 v44, v60, s[4:7], s38 offen offset:0
    s_waitcnt lgkmcnt(8)
    v_pk_add_f32 v[48:49], v[48:49], v[50:51]
    v_add_f32 v48, v48, v49
    buffer_atomic_add_f32 v48, v60, s[4:7], s38 offen offset:1024
    s_waitcnt lgkmcnt(4)
    v_pk_add_f32 v[52:53], v[52:53], v[54:55]
    v_add_f32 v52, v52, v53
    buffer_atomic_add_f32 v52, v60, s[4:7], s38 offen offset:2048
    s_waitcnt lgkmcnt(0)
    v_pk_add_f32 v[56:57], v[56:57], v[58:59]
    v_add_f32 v56, v56, v57
    v_cmp_gt_u32 vcc, 288, v60
    v_or_b32 v61, 0x40000000, v60
    s_nop 0
    v_cndmask_b32 v60, v61, v60, vcc
    buffer_atomic_add_f32 v56, v60, s[4:7], s38 offen offset:3072
    ds_read_b128 v[124:127], v2 offset:36864
    ds_read_b128 v[128:131], v2 offset:37888
    ds_read_b128 v[108:111], v2 offset:38912
    ds_read_b128 v[112:115], v2 offset:39936
    ds_read_b128 v[116:119], v2 offset:40960
    ds_read_b128 v[120:123], v2 offset:41984
    s_waitcnt lgkmcnt(3)
    v_mfma_f32_16x16x32_bf16 v[84:87], v[124:127], a[0:3], 0
    s_add_u32 s54, s20, 147456
    s_add_u32 m0, s73, 0
    s_nop 0
    buffer_load_dwordx4 v0, s[44:47], s54 offen offset:0 sc1 lds
    v_mfma_f32_16x16x32_bf16 v[88:91], v[124:127], a[4:7], 0
    ds_read_b128 v[124:127], v2 offset:43008
    v_mfma_f32_16x16x32_bf16 v[92:95], v[128:131], a[0:3], 0
    v_mfma_f32_16x16x32_bf16 v[96:99], v[128:131], a[4:7], 0
    ds_read_b128 v[128:131], v2 offset:44032
    v_mfma_f32_16x16x32_bf16 v[100:103], v[108:111], a[0:3], 0
    buffer_load_dwordx4 v0, s[44:47], s54 offen offset:1024 sc1 lds
    v_mfma_f32_16x16x32_bf16 v[104:107], v[108:111], a[4:7], 0
    ds_read_b128 v[108:111], v2 offset:45056
    s_waitcnt lgkmcnt(3)
    v_mfma_f32_16x16x32_bf16 v[84:87], v[112:115], a[8:11], v[84:87]
    v_mfma_f32_16x16x32_bf16 v[88:91], v[112:115], a[12:15], v[88:91]
    ds_read_b128 v[112:115], v2 offset:46080
    v_mfma_f32_16x16x32_bf16 v[92:95], v[116:119], a[8:11], v[92:95]
    v_mfma_f32_16x16x32_bf16 v[96:99], v[116:119], a[12:15], v[96:99]
    ds_read_b128 v[116:119], v2 offset:47104
    v_mfma_f32_16x16x32_bf16 v[100:103], v[120:123], a[8:11], v[100:103]
    buffer_load_dwordx4 v0, s[44:47], s54 offen offset:2048 sc1 lds
    v_mfma_f32_16x16x32_bf16 v[104:107], v[120:123], a[12:15], v[104:107]
    ds_read_b128 v[120:123], v2 offset:48128
    s_waitcnt lgkmcnt(3)
    v_mfma_f32_16x16x32_bf16 v[84:87], v[124:127], a[16:19], v[84:87]
    v_mfma_f32_16x16x32_bf16 v[88:91], v[124:127], a[20:23], v[88:91]
    ds_read_b128 v[124:127], v2 offset:49152
    v_mfma_f32_16x16x32_bf16 v[92:95], v[128:131], a[16:19], v[92:95]
    buffer_load_dwordx4 v0, s[44:47], s54 offen offset:3072 sc1 lds
    v_mfma_f32_16x16x32_bf16 v[96:99], v[128:131], a[20:23], v[96:99]
    ds_read_b128 v[128:131], v2 offset:50176
    v_mfma_f32_16x16x32_bf16 v[100:103], v[108:111], a[16:19], v[100:103]
    v_mfma_f32_16x16x32_bf16 v[104:107], v[108:111], a[20:23], v[104:107]
    ds_read_b128 v[108:111], v2 offset:51200
    s_waitcnt lgkmcnt(3)
    v_mfma_f32_16x16x32_bf16 v[84:87], v[112:115], a[24:27], v[84:87]
    v_mfma_f32_16x16x32_bf16 v[88:91], v[112:115], a[28:31], v[88:91]
    ds_read_b128 v[112:115], v2 offset:52224
    v_mfma_f32_16x16x32_bf16 v[92:95], v[116:119], a[24:27], v[92:95]
    s_add_u32 s53, s22, 4096
    buffer_load_dwordx4 a[176:179], v0, s[4:7], s53 offen offset:0 sc1
    v_mfma_f32_16x16x32_bf16 v[96:99], v[116:119], a[28:31], v[96:99]
    ds_read_b128 v[116:119], v2 offset:53248
    v_mfma_f32_16x16x32_bf16 v[100:103], v[120:123], a[24:27], v[100:103]
    v_mfma_f32_16x16x32_bf16 v[104:107], v[120:123], a[28:31], v[104:107]
    ds_read_b128 v[120:123], v2 offset:54272
    s_waitcnt lgkmcnt(3)
    v_mfma_f32_16x16x32_bf16 v[84:87], v[124:127], a[32:35], v[84:87]
    buffer_load_dwordx4 a[180:183], v0, s[4:7], s53 offen offset:1024 sc1
    v_mfma_f32_16x16x32_bf16 v[88:91], v[124:127], a[36:39], v[88:91]
    ds_read_b128 v[124:127], v2 offset:55296
    v_mfma_f32_16x16x32_bf16 v[92:95], v[128:131], a[32:35], v[92:95]
    v_mfma_f32_16x16x32_bf16 v[96:99], v[128:131], a[36:39], v[96:99]
    ds_read_b128 v[128:131], v2 offset:56320
    v_mfma_f32_16x16x32_bf16 v[100:103], v[108:111], a[32:35], v[100:103]
    v_mfma_f32_16x16x32_bf16 v[104:107], v[108:111], a[36:39], v[104:107]
    ds_read_b128 v[108:111], v2 offset:57344
    s_waitcnt lgkmcnt(3)
    v_mfma_f32_16x16x32_bf16 v[84:87], v[112:115], a[40:43], v[84:87]
    buffer_load_dwordx4 a[184:187], v0, s[4:7], s53 offen offset:2048 sc1
    v_mfma_f32_16x16x32_bf16 v[88:91], v[112:115], a[44:47], v[88:91]
    ds_read_b128 v[112:115], v2 offset:58368
    v_mfma_f32_16x16x32_bf16 v[92:95], v[116:119], a[40:43], v[92:95]
    v_mfma_f32_16x16x32_bf16 v[96:99], v[116:119], a[44:47], v[96:99]
    ds_read_b128 v[116:119], v2 offset:59392
    v_mfma_f32_16x16x32_bf16 v[100:103], v[120:123], a[40:43], v[100:103]
    v_mfma_f32_16x16x32_bf16 v[104:107], v[120:123], a[44:47], v[104:107]
    ds_read_b128 v[120:123], v2 offset:60416
    s_waitcnt lgkmcnt(3)
    v_mfma_f32_16x16x32_bf16 v[84:87], v[124:127], a[48:51], v[84:87]
    buffer_load_dwordx4 a[188:191], v0, s[4:7], s53 offen offset:3072 sc1
    v_mfma_f32_16x16x32_bf16 v[88:91], v[124:127], a[52:55], v[88:91]
    ds_read_b128 v[124:127], v2 offset:61440
    v_mfma_f32_16x16x32_bf16 v[92:95], v[128:131], a[48:51], v[92:95]
    v_mfma_f32_16x16x32_bf16 v[96:99], v[128:131], a[52:55], v[96:99]
    ds_read_b128 v[128:131], v2 offset:62464
    v_mfma_f32_16x16x32_bf16 v[100:103], v[108:111], a[48:51], v[100:103]
    s_waitcnt vmcnt(8)
    s_barrier
    s_cmp_lg_u32 s14, 0
    s_cbranch_scc1 interleave_layers__linear_attn_block__geglu_ffn__prompt_kernel_cf32
    v_mov_b32 v41, s75
    s_mov_b32 exec_lo, 0xffff
    s_mov_b32 exec_hi, 0x0
    buffer_store_dword v41, v39, s[4:7], s42 offen sc1
    s_mov_b64 exec, -1
interleave_layers__linear_attn_block__geglu_ffn__prompt_kernel_cf32:
    v_mfma_f32_16x16x32_bf16 v[104:107], v[108:111], a[52:55], v[104:107]
    ds_read_b128 v[108:111], v2 offset:63488
    s_waitcnt lgkmcnt(3)
    v_mfma_f32_16x16x32_bf16 v[84:87], v[112:115], a[56:59], v[84:87]
    s_add_u32 s53, s22, 8192
    buffer_load_dwordx4 a[192:195], v0, s[4:7], s53 offen offset:0 sc1
    v_mfma_f32_16x16x32_bf16 v[88:91], v[112:115], a[60:63], v[88:91]
    ds_read_b128 v[112:115], v2 offset:64512
    v_mfma_f32_16x16x32_bf16 v[92:95], v[116:119], a[56:59], v[92:95]
    v_mfma_f32_16x16x32_bf16 v[96:99], v[116:119], a[60:63], v[96:99]
    ds_read_b128 v[116:119], v3 offset:0
    v_mfma_f32_16x16x32_bf16 v[100:103], v[120:123], a[56:59], v[100:103]
    buffer_load_dwordx4 a[196:199], v0, s[4:7], s53 offen offset:1024 sc1
    v_mfma_f32_16x16x32_bf16 v[104:107], v[120:123], a[60:63], v[104:107]
    ds_read_b128 v[120:123], v3 offset:1024
    s_waitcnt lgkmcnt(3)
    v_mfma_f32_16x16x32_bf16 v[84:87], v[124:127], a[64:67], v[84:87]
    v_mfma_f32_16x16x32_bf16 v[88:91], v[124:127], a[68:71], v[88:91]
    ds_read_b128 v[124:127], v3 offset:2048
    v_mfma_f32_16x16x32_bf16 v[92:95], v[128:131], a[64:67], v[92:95]
    v_mfma_f32_16x16x32_bf16 v[96:99], v[128:131], a[68:71], v[96:99]
    ds_read_b128 v[128:131], v3 offset:3072
    v_mfma_f32_16x16x32_bf16 v[100:103], v[108:111], a[64:67], v[100:103]
    buffer_load_dwordx4 a[200:203], v0, s[4:7], s53 offen offset:2048 sc1
    v_mfma_f32_16x16x32_bf16 v[104:107], v[108:111], a[68:71], v[104:107]
    ds_read_b128 v[108:111], v3 offset:4096
    s_waitcnt lgkmcnt(3)
    v_mfma_f32_16x16x32_bf16 v[84:87], v[112:115], a[72:75], v[84:87]
    v_mfma_f32_16x16x32_bf16 v[88:91], v[112:115], a[76:79], v[88:91]
    ds_read_b128 v[112:115], v3 offset:5120
    v_mfma_f32_16x16x32_bf16 v[92:95], v[116:119], a[72:75], v[92:95]
    v_mfma_f32_16x16x32_bf16 v[96:99], v[116:119], a[76:79], v[96:99]
    ds_read_b128 v[116:119], v3 offset:6144
    v_mfma_f32_16x16x32_bf16 v[100:103], v[120:123], a[72:75], v[100:103]
    buffer_load_dwordx4 a[204:207], v0, s[4:7], s53 offen offset:3072 sc1
    v_mfma_f32_16x16x32_bf16 v[104:107], v[120:123], a[76:79], v[104:107]
    ds_read_b128 v[120:123], v3 offset:7168
    s_waitcnt lgkmcnt(3)
    v_mfma_f32_16x16x32_bf16 v[84:87], v[124:127], a[80:83], v[84:87]
    v_mfma_f32_16x16x32_bf16 v[88:91], v[124:127], a[84:87], v[88:91]
    ds_read_b128 v[124:127], v3 offset:8192
    v_mfma_f32_16x16x32_bf16 v[92:95], v[128:131], a[80:83], v[92:95]
    v_mfma_f32_16x16x32_bf16 v[96:99], v[128:131], a[84:87], v[96:99]
    ds_read_b128 v[128:131], v3 offset:9216
    v_mfma_f32_16x16x32_bf16 v[100:103], v[108:111], a[80:83], v[100:103]
    s_add_u32 s53, s22, 12288
    buffer_load_dwordx4 a[208:211], v0, s[4:7], s53 offen offset:0 sc1
    v_mfma_f32_16x16x32_bf16 v[104:107], v[108:111], a[84:87], v[104:107]
    ds_read_b128 v[108:111], v3 offset:10240
    s_waitcnt lgkmcnt(3)
    v_mfma_f32_16x16x32_bf16 v[84:87], v[112:115], a[88:91], v[84:87]
    v_mfma_f32_16x16x32_bf16 v[88:91], v[112:115], a[92:95], v[88:91]
    ds_read_b128 v[112:115], v3 offset:11264
    v_mfma_f32_16x16x32_bf16 v[92:95], v[116:119], a[88:91], v[92:95]
    buffer_load_dwordx4 a[212:215], v0, s[4:7], s53 offen offset:1024 sc1
    v_mfma_f32_16x16x32_bf16 v[96:99], v[116:119], a[92:95], v[96:99]
    ds_read_b128 v[116:119], v3 offset:12288
    v_mfma_f32_16x16x32_bf16 v[100:103], v[120:123], a[88:91], v[100:103]
    v_mfma_f32_16x16x32_bf16 v[104:107], v[120:123], a[92:95], v[104:107]
    ds_read_b128 v[120:123], v3 offset:13312
    s_waitcnt lgkmcnt(3)
    v_mfma_f32_16x16x32_bf16 v[84:87], v[124:127], a[96:99], v[84:87]
    v_mfma_f32_16x16x32_bf16 v[88:91], v[124:127], a[100:103], v[88:91]
    ds_read_b128 v[124:127], v3 offset:14336
    v_mfma_f32_16x16x32_bf16 v[92:95], v[128:131], a[96:99], v[92:95]
    buffer_load_dwordx4 a[216:219], v0, s[4:7], s53 offen offset:2048 sc1
    v_mfma_f32_16x16x32_bf16 v[96:99], v[128:131], a[100:103], v[96:99]
    ds_read_b128 v[128:131], v3 offset:15360
    v_mfma_f32_16x16x32_bf16 v[100:103], v[108:111], a[96:99], v[100:103]
    v_mfma_f32_16x16x32_bf16 v[104:107], v[108:111], a[100:103], v[104:107]
    s_waitcnt vmcnt(11)
    s_barrier
    ds_read_b128 v[108:111], v0 offset:0
    s_waitcnt lgkmcnt(3)
    v_mfma_f32_16x16x32_bf16 v[84:87], v[112:115], a[104:107], v[84:87]
    v_mfma_f32_16x16x32_bf16 v[88:91], v[112:115], a[108:111], v[88:91]
    ds_read_b128 v[112:115], v0 offset:1024
    v_mfma_f32_16x16x32_bf16 v[92:95], v[116:119], a[104:107], v[92:95]
    buffer_load_dwordx4 a[220:223], v0, s[4:7], s53 offen offset:3072 sc1
    v_mfma_f32_16x16x32_bf16 v[96:99], v[116:119], a[108:111], v[96:99]
    ds_read_b128 v[116:119], v0 offset:2048
    v_mfma_f32_16x16x32_bf16 v[100:103], v[120:123], a[104:107], v[100:103]
    v_mfma_f32_16x16x32_bf16 v[104:107], v[120:123], a[108:111], v[104:107]
    ds_read_b128 v[120:123], v0 offset:3072
    s_waitcnt lgkmcnt(3)
    v_mfma_f32_16x16x32_bf16 v[84:87], v[124:127], a[112:115], v[84:87]
    v_mfma_f32_16x16x32_bf16 v[88:91], v[124:127], a[116:119], v[88:91]
    ds_read_b128 v[124:127], v0 offset:4096
    v_mfma_f32_16x16x32_bf16 v[92:95], v[128:131], a[112:115], v[92:95]
    s_add_u32 s53, s22, 16384
    buffer_load_dwordx4 a[224:227], v0, s[4:7], s53 offen offset:0 sc1
    v_mfma_f32_16x16x32_bf16 v[96:99], v[128:131], a[116:119], v[96:99]
    ds_read_b128 v[128:131], v0 offset:5120
    v_mfma_f32_16x16x32_bf16 v[100:103], v[108:111], a[112:115], v[100:103]
    v_mfma_f32_16x16x32_bf16 v[104:107], v[108:111], a[116:119], v[104:107]
    ds_read_b128 v[108:111], v0 offset:6144
    s_waitcnt lgkmcnt(3)
    v_mfma_f32_16x16x32_bf16 v[84:87], v[112:115], a[120:123], v[84:87]
    buffer_load_dwordx4 a[228:231], v0, s[4:7], s53 offen offset:1024 sc1
    v_mfma_f32_16x16x32_bf16 v[88:91], v[112:115], a[124:127], v[88:91]
    ds_read_b128 v[112:115], v0 offset:7168
    v_mfma_f32_16x16x32_bf16 v[92:95], v[116:119], a[120:123], v[92:95]
    v_mfma_f32_16x16x32_bf16 v[96:99], v[116:119], a[124:127], v[96:99]
    ds_read_b128 v[116:119], v0 offset:8192
    v_mfma_f32_16x16x32_bf16 v[100:103], v[120:123], a[120:123], v[100:103]
    v_mfma_f32_16x16x32_bf16 v[104:107], v[120:123], a[124:127], v[104:107]
    ds_read_b128 v[120:123], v0 offset:9216
    s_waitcnt lgkmcnt(3)
    v_mfma_f32_16x16x32_bf16 v[84:87], v[124:127], a[128:131], v[84:87]
    buffer_load_dwordx4 a[232:235], v0, s[4:7], s53 offen offset:2048 sc1
    v_mfma_f32_16x16x32_bf16 v[88:91], v[124:127], a[132:135], v[88:91]
    ds_read_b128 v[124:127], v0 offset:10240
    v_mfma_f32_16x16x32_bf16 v[92:95], v[128:131], a[128:131], v[92:95]
    v_mfma_f32_16x16x32_bf16 v[96:99], v[128:131], a[132:135], v[96:99]
    ds_read_b128 v[128:131], v0 offset:11264
    v_mfma_f32_16x16x32_bf16 v[100:103], v[108:111], a[128:131], v[100:103]
    ds_read_b128 v[140:143], v28 offset:320
    v_mfma_f32_16x16x32_bf16 v[104:107], v[108:111], a[132:135], v[104:107]
    ds_read_b128 v[108:111], v0 offset:12288
    s_waitcnt lgkmcnt(4)
    v_mfma_f32_16x16x32_bf16 v[84:87], v[112:115], a[136:139], v[84:87]
    buffer_load_dwordx4 a[236:239], v0, s[4:7], s53 offen offset:3072 sc1
    v_mfma_f32_16x16x32_bf16 v[88:91], v[112:115], a[140:143], v[88:91]
    ds_read_b128 v[112:115], v0 offset:13312
    ds_read_b128 v[144:147], v28 offset:384
    v_mfma_f32_16x16x32_bf16 v[92:95], v[116:119], a[136:139], v[92:95]
    ds_read_b128 v[148:151], v28 offset:448
    v_mfma_f32_16x16x32_bf16 v[96:99], v[116:119], a[140:143], v[96:99]
    ds_read_b128 v[116:119], v0 offset:14336
    v_mfma_f32_16x16x32_bf16 v[100:103], v[120:123], a[136:139], v[100:103]
    v_mfma_f32_16x16x32_bf16 v[104:107], v[120:123], a[140:143], v[104:107]
    ds_read_b128 v[120:123], v0 offset:15360
    s_waitcnt lgkmcnt(5)
    v_mfma_f32_16x16x32_bf16 v[84:87], v[124:127], a[144:147], v[84:87]
    s_add_u32 s53, s22, 20480
    buffer_load_dwordx4 a[240:243], v0, s[4:7], s53 offen offset:0 sc1
    v_mfma_f32_16x16x32_bf16 v[88:91], v[124:127], a[148:151], v[88:91]
    v_mfma_f32_16x16x32_bf16 v[92:95], v[128:131], a[144:147], v[92:95]
    v_mfma_f32_16x16x32_bf16 v[96:99], v[128:131], a[148:151], v[96:99]
    v_mfma_f32_16x16x32_bf16 v[100:103], v[108:111], a[144:147], v[100:103]
    buffer_load_dwordx4 a[244:247], v0, s[4:7], s53 offen offset:1024 sc1
    v_mfma_f32_16x16x32_bf16 v[104:107], v[108:111], a[148:151], v[104:107]
    s_waitcnt lgkmcnt(0)
    v_mfma_f32_16x16x32_bf16 v[84:87], v[112:115], a[152:155], v[84:87]
    v_mfma_f32_16x16x32_bf16 v[88:91], v[112:115], a[156:159], v[88:91]
    v_mfma_f32_16x16x32_bf16 v[92:95], v[116:119], a[152:155], v[92:95]
    v_mfma_f32_16x16x32_bf16 v[96:99], v[116:119], a[156:159], v[96:99]
    v_mfma_f32_16x16x32_bf16 v[100:103], v[120:123], a[152:155], v[100:103]
    v_mfma_f32_16x16x32_bf16 v[104:107], v[120:123], a[156:159], v[104:107]
    s_cmp_eq_u32 s17, 0
    s_cbranch_scc1 interleave_layers__linear_attn_block__geglu_ffn__prompt_kernel_c3x34
interleave_layers__linear_attn_block__geglu_ffn__prompt_kernel_c333:
    s_nop 0
    v_pk_fma_f32 v[84:85], v[140:141], v[132:133], v[84:85] op_sel:[0,1,0] op_sel_hi:[1,1,1]
    buffer_load_dwordx4 a[248:251], v0, s[4:7], s53 offen offset:2048 sc1
    v_pk_fma_f32 v[86:87], v[142:143], v[132:133], v[86:87] op_sel:[0,1,0] op_sel_hi:[1,1,1]
    v_pk_fma_f32 v[88:89], v[140:141], v[136:137], v[88:89] op_sel:[0,1,0] op_sel_hi:[1,1,1]
    v_pk_fma_f32 v[90:91], v[142:143], v[136:137], v[90:91] op_sel:[0,1,0] op_sel_hi:[1,1,1]
    v_pk_fma_f32 v[92:93], v[144:145], v[132:133], v[92:93] op_sel:[0,1,0] op_sel_hi:[1,1,1]
    v_pk_fma_f32 v[94:95], v[146:147], v[132:133], v[94:95] op_sel:[0,1,0] op_sel_hi:[1,1,1]
    v_pk_fma_f32 v[96:97], v[144:145], v[136:137], v[96:97] op_sel:[0,1,0] op_sel_hi:[1,1,1]
    v_pk_fma_f32 v[98:99], v[146:147], v[136:137], v[98:99] op_sel:[0,1,0] op_sel_hi:[1,1,1]
    v_pk_fma_f32 v[100:101], v[148:149], v[132:133], v[100:101] op_sel:[0,1,0] op_sel_hi:[1,1,1]
    v_pk_fma_f32 v[102:103], v[150:151], v[132:133], v[102:103] op_sel:[0,1,0] op_sel_hi:[1,1,1]
    v_pk_fma_f32 v[104:105], v[148:149], v[136:137], v[104:105] op_sel:[0,1,0] op_sel_hi:[1,1,1]
    v_pk_fma_f32 v[106:107], v[150:151], v[136:137], v[106:107] op_sel:[0,1,0] op_sel_hi:[1,1,1]
    v_pk_fma_f32 v[84:85], v[84:85], v[132:133], s[62:63] op_sel_hi:[1,0,1]
    v_pk_fma_f32 v[86:87], v[86:87], v[132:133], s[62:63] op_sel_hi:[1,0,1]
    v_pk_fma_f32 v[88:89], v[88:89], v[136:137], s[62:63] op_sel_hi:[1,0,1]
    v_pk_fma_f32 v[90:91], v[90:91], v[136:137], s[62:63] op_sel_hi:[1,0,1]
    v_pk_fma_f32 v[92:93], v[92:93], v[132:133], s[62:63] op_sel_hi:[1,0,1]
    v_pk_fma_f32 v[94:95], v[94:95], v[132:133], s[62:63] op_sel_hi:[1,0,1]
    v_pk_fma_f32 v[96:97], v[96:97], v[136:137], s[62:63] op_sel_hi:[1,0,1]
    v_pk_fma_f32 v[98:99], v[98:99], v[136:137], s[62:63] op_sel_hi:[1,0,1]
    v_pk_fma_f32 v[100:101], v[100:101], v[132:133], s[62:63] op_sel_hi:[1,0,1]
    buffer_load_dwordx4 a[252:255], v0, s[4:7], s53 offen offset:3072 sc1
    v_pk_fma_f32 v[102:103], v[102:103], v[132:133], s[62:63] op_sel_hi:[1,0,1]
    v_pk_fma_f32 v[104:105], v[104:105], v[136:137], s[62:63] op_sel_hi:[1,0,1]
    v_pk_fma_f32 v[106:107], v[106:107], v[136:137], s[62:63] op_sel_hi:[1,0,1]
    v_pk_fma_f32 v[108:109], v[84:85], s[60:61], v[36:37] op_sel:[0,0,1] op_sel_hi:[1,1,1]
    v_pk_fma_f32 v[110:111], v[86:87], s[60:61], v[36:37] op_sel:[0,0,1] op_sel_hi:[1,1,1]
    v_pk_fma_f32 v[112:113], v[88:89], s[60:61], v[36:37] op_sel:[0,0,1] op_sel_hi:[1,1,1]
    v_pk_fma_f32 v[114:115], v[90:91], s[60:61], v[36:37] op_sel:[0,0,1] op_sel_hi:[1,1,1]
    v_pk_fma_f32 v[116:117], v[92:93], s[60:61], v[36:37] op_sel:[0,0,1] op_sel_hi:[1,1,1]
    v_pk_fma_f32 v[118:119], v[94:95], s[60:61], v[36:37] op_sel:[0,0,1] op_sel_hi:[1,1,1]
    v_pk_fma_f32 v[120:121], v[96:97], s[60:61], v[36:37] op_sel:[0,0,1] op_sel_hi:[1,1,1]
    v_pk_fma_f32 v[122:123], v[98:99], s[60:61], v[36:37] op_sel:[0,0,1] op_sel_hi:[1,1,1]
    v_pk_fma_f32 v[124:125], v[100:101], s[60:61], v[36:37] op_sel:[0,0,1] op_sel_hi:[1,1,1]
    v_pk_fma_f32 v[126:127], v[102:103], s[60:61], v[36:37] op_sel:[0,0,1] op_sel_hi:[1,1,1]
    v_pk_fma_f32 v[128:129], v[104:105], s[60:61], v[36:37] op_sel:[0,0,1] op_sel_hi:[1,1,1]
    v_pk_fma_f32 v[130:131], v[106:107], s[60:61], v[36:37] op_sel:[0,0,1] op_sel_hi:[1,1,1]
    v_exp_f32_e64 v108, v108 clamp
    v_max_f32 v84, s62, v84
    v_exp_f32_e64 v109, v109 clamp
    s_add_u32 s53, s22, 24576
    buffer_load_dwordx4 v[252:255], v0, s[4:7], s53 offen offset:0 sc1
    v_max_f32 v85, s62, v85
    v_exp_f32_e64 v110, v110 clamp
    v_max_f32 v86, s62, v86
    v_exp_f32_e64 v111, v111 clamp
    v_max_f32 v87, s62, v87
    v_exp_f32_e64 v112, v112 clamp
    v_max_f32 v88, s62, v88
    v_exp_f32_e64 v113, v113 clamp
    v_max_f32 v89, s62, v89
    v_exp_f32_e64 v114, v114 clamp
    v_max_f32 v90, s62, v90
    v_exp_f32_e64 v115, v115 clamp
    v_max_f32 v91, s62, v91
    v_exp_f32_e64 v116, v116 clamp
    buffer_load_dword v38, v31, s[4:7], s43 offen sc1
    v_max_f32 v92, s62, v92
    v_exp_f32_e64 v117, v117 clamp
    v_max_f32 v93, s62, v93
    v_exp_f32_e64 v118, v118 clamp
    v_max_f32 v94, s62, v94
    v_exp_f32_e64 v119, v119 clamp
    v_max_f32 v95, s62, v95
    v_exp_f32_e64 v120, v120 clamp
    v_max_f32 v96, s62, v96
    v_exp_f32_e64 v121, v121 clamp
    v_max_f32 v97, s62, v97
    v_exp_f32_e64 v122, v122 clamp
    v_max_f32 v98, s62, v98
    v_exp_f32_e64 v123, v123 clamp
    v_max_f32 v99, s62, v99
    v_exp_f32_e64 v124, v124 clamp
    v_max_f32 v100, s62, v100
    v_exp_f32_e64 v125, v125 clamp
    v_max_f32 v101, s62, v101
    v_exp_f32_e64 v126, v126 clamp
    v_max_f32 v102, s62, v102
    v_exp_f32_e64 v127, v127 clamp
    v_max_f32 v103, s62, v103
    v_exp_f32_e64 v128, v128 clamp
    v_max_f32 v104, s62, v104
    v_exp_f32_e64 v129, v129 clamp
    v_max_f32 v105, s62, v105
    v_exp_f32_e64 v130, v130 clamp
    v_max_f32 v106, s62, v106
    v_exp_f32_e64 v131, v131 clamp
    v_max_f32 v107, s62, v107
    v_pk_add_f32 v[84:85], v[84:85], v[108:109]
    v_pk_add_f32 v[86:87], v[86:87], v[110:111]
    v_pk_add_f32 v[88:89], v[88:89], v[112:113]
    v_pk_add_f32 v[90:91], v[90:91], v[114:115]
    v_pk_add_f32 v[92:93], v[92:93], v[116:117]
    v_pk_add_f32 v[94:95], v[94:95], v[118:119]
    v_pk_add_f32 v[96:97], v[96:97], v[120:121]
    v_pk_add_f32 v[98:99], v[98:99], v[122:123]
    v_pk_add_f32 v[100:101], v[100:101], v[124:125]
    v_pk_add_f32 v[102:103], v[102:103], v[126:127]
    v_pk_add_f32 v[104:105], v[104:105], v[128:129]
    v_pk_add_f32 v[106:107], v[106:107], v[130:131]
    v_cvt_pk_bf16_f32 v44, v84, v85
    v_cvt_pk_bf16_f32 v45, v86, v87
    v_cvt_pk_bf16_f32 v46, v100, v101
    v_cvt_pk_bf16_f32 v47, v102, v103
    v_cvt_pk_bf16_f32 v48, v92, v93
    v_cvt_pk_bf16_f32 v49, v94, v95
    v_cvt_pk_bf16_f32 v50, v100, v101
    v_cvt_pk_bf16_f32 v51, v102, v103
    v_cvt_pk_bf16_f32 v52, v88, v89
    v_cvt_pk_bf16_f32 v53, v90, v91
    v_cvt_pk_bf16_f32 v54, v104, v105
    v_cvt_pk_bf16_f32 v55, v106, v107
    v_cvt_pk_bf16_f32 v56, v96, v97
    v_cvt_pk_bf16_f32 v57, v98, v99
    v_cvt_pk_bf16_f32 v58, v104, v105
    v_cvt_pk_bf16_f32 v59, v106, v107
    s_add_u32 s54, s21, 0
    s_add_u32 m0, s73, 49152
    s_nop 0
    buffer_load_dwordx4 v0, s[4:7], s54 offen offset:0 sc1 lds
    buffer_load_dwordx4 v0, s[4:7], s54 offen offset:1024 sc1 lds
    buffer_load_dwordx4 v0, s[4:7], s54 offen offset:2048 sc1 lds
    buffer_load_dwordx4 v0, s[4:7], s54 offen offset:3072 sc1 lds
    s_waitcnt vmcnt(4)
    v_subrev_u32 v38, s75, v38
    v_cmp_lt_u32 vcc, 3, v38
    s_nop 1
    s_and_b64 vcc, vcc, s[64:65]
    s_cbranch_scc1 interleave_layers__linear_attn_block__geglu_ffn__prompt_kernel_aspin36
interleave_layers__linear_attn_block__geglu_ffn__prompt_kernel_adone35:
    buffer_load_dwordx4 v[60:63], v29, s[4:7], s38 offen sc1
    s_add_u32 s54, s21, 16384
    s_add_u32 m0, s73, 65536
    s_nop 0
    buffer_load_dwordx4 v0, s[4:7], s54 offen offset:0 sc1 lds
    buffer_load_dwordx4 v0, s[4:7], s54 offen offset:1024 sc1 lds
    buffer_load_dwordx4 v0, s[4:7], s54 offen offset:2048 sc1 lds
    buffer_load_dwordx4 v0, s[4:7], s54 offen offset:3072 sc1 lds
    s_waitcnt vmcnt(4)
    s_cmp_lg_u32 s17, 0
    s_cbranch_scc1 interleave_layers__linear_attn_block__geglu_ffn__prompt_kernel_k439
    buffer_load_dwordx4 v[184:187], v0, s[4:7], s23 offen offset:0 sc1
    buffer_load_dwordx4 v[188:191], v0, s[4:7], s23 offen offset:1024 sc1
    buffer_load_dwordx4 v[192:195], v0, s[4:7], s23 offen offset:2048 sc1
    buffer_load_dwordx4 v[196:199], v0, s[4:7], s23 offen offset:3072 sc1
    s_add_u32 s53, s23, 4096
    buffer_load_dwordx4 v[200:203], v0, s[4:7], s53 offen offset:0 sc1
    buffer_load_dwordx4 v[204:207], v0, s[4:7], s53 offen offset:1024 sc1
    buffer_load_dwordx4 v[208:211], v0, s[4:7], s53 offen offset:2048 sc1
    buffer_load_dwordx4 v[212:215], v0, s[4:7], s53 offen offset:3072 sc1
interleave_layers__linear_attn_block__geglu_ffn__prompt_kernel_k439:
    v_cvt_pk_bf16_f32 v60, v60, v61
    v_cvt_pk_bf16_f32 v61, v62, v63
    ds_write_b64 v30, v[60:61]
    s_waitcnt lgkmcnt(0)
    s_barrier
    ds_read_b128 v[84:87], v23
    ds_read_b128 v[88:91], v24
    ds_read_b128 v[64:67], v18
    ds_read_b128 v[68:71], v19
    ds_read_b128 v[72:75], v20
    ds_read_b128 v[76:79], v21
    ds_read_b128 v[80:83], v22
    s_waitcnt lgkmcnt(6)
    v_mfma_f32_16x16x32_bf16 v[104:107], v[84:87], v[44:47], 0
    v_mfma_f32_16x16x32_bf16 v[120:123], v[84:87], v[52:55], 0
    s_waitcnt lgkmcnt(5)
    v_mfma_f32_16x16x32_bf16 v[104:107], v[88:91], v[48:51], v[104:107]
    v_mfma_f32_16x16x32_bf16 v[120:123], v[88:91], v[56:59], v[120:123]
    s_waitcnt lgkmcnt(4)
    v_mfma_f32_16x16x32_bf16 v[92:95], v[64:67], v[44:47], 0
    v_mfma_f32_16x16x32_bf16 v[108:111], v[64:67], v[52:55], 0
    s_waitcnt lgkmcnt(3)
    v_mfma_f32_16x16x32_bf16 v[92:95], v[68:71], v[48:51], v[92:95]
    v_mfma_f32_16x16x32_bf16 v[108:111], v[68:71], v[56:59], v[108:111]
    s_waitcnt lgkmcnt(2)
    v_mfma_f32_16x16x32_bf16 v[96:99], v[72:75], v[44:47], 0
    v_mfma_f32_16x16x32_bf16 v[112:115], v[72:75], v[52:55], 0
    s_waitcnt lgkmcnt(1)
    v_mfma_f32_16x16x32_bf16 v[96:99], v[76:79], v[48:51], v[96:99]
    v_mfma_f32_16x16x32_bf16 v[112:115], v[76:79], v[56:59], v[112:115]
    s_waitcnt lgkmcnt(0)
    v_mfma_f32_16x16x32_bf16 v[100:103], v[80:83], v[48:51], 0
    v_mfma_f32_16x16x32_bf16 v[116:119], v[80:83], v[56:59], 0
    v_pk_add_f32 v[104:105], v[104:105], s[62:63]
    v_pk_add_f32 v[120:121], v[120:121], s[62:63]
    v_rcp_f32 v104, v104
    v_rcp_f32 v105, v105
    v_rcp_f32 v120, v120
    v_rcp_f32 v121, v121
    s_mov_b32 s92, 0
    s_mov_b32 s93, 0xffff0000
    v_cndmask_b32 v106, v104, v105, s[92:93]
    v_cndmask_b32 v122, v120, v121, s[92:93]
    s_mov_b32 s93, -1
    v_cndmask_b32 v107, v104, v105, s[92:93]
    v_cndmask_b32 v123, v120, v121, s[92:93]
    v_pk_mul_f32 v[92:93], v[92:93], v[106:107] op_sel_hi:[1,0]
    v_pk_mul_f32 v[96:97], v[96:97], v[106:107] op_sel:[0,1] op_sel_hi:[1,1]
    v_pk_mul_f32 v[100:101], v[100:101], v[104:105] op_sel:[0,1] op_sel_hi:[1,1]
    v_pk_mul_f32 v[94:95], v[94:95], v[106:107] op_sel_hi:[1,0]
    v_pk_mul_f32 v[98:99], v[98:99], v[106:107] op_sel:[0,1] op_sel_hi:[1,1]
    v_pk_mul_f32 v[102:103], v[102:103], v[104:105] op_sel:[0,1] op_sel_hi:[1,1]
    v_cvt_pk_bf16_f32 v64, v92, v93
    v_cvt_pk_bf16_f32 v65, v94, v95
    v_cvt_pk_bf16_f32 v66, v96, v97
    v_cvt_pk_bf16_f32 v67, v98, v99
    v_cvt_pk_bf16_f32 v68, v100, v101
    v_cvt_pk_bf16_f32 v69, v102, v103
    v_pk_mul_f32 v[108:109], v[108:109], v[122:123] op_sel_hi:[1,0]
    v_pk_mul_f32 v[112:113], v[112:113], v[122:123] op_sel:[0,1] op_sel_hi:[1,1]
    v_pk_mul_f32 v[116:117], v[116:117], v[120:121] op_sel:[0,1] op_sel_hi:[1,1]
    v_pk_mul_f32 v[110:111], v[110:111], v[122:123] op_sel_hi:[1,0]
    v_pk_mul_f32 v[114:115], v[114:115], v[122:123] op_sel:[0,1] op_sel_hi:[1,1]
    v_pk_mul_f32 v[118:119], v[118:119], v[120:121] op_sel:[0,1] op_sel_hi:[1,1]
    v_cvt_pk_bf16_f32 v72, v108, v109
    v_cvt_pk_bf16_f32 v73, v110, v111
    v_cvt_pk_bf16_f32 v74, v112, v113
    v_cvt_pk_bf16_f32 v75, v114, v115
    v_cvt_pk_bf16_f32 v76, v116, v117
    v_cvt_pk_bf16_f32 v77, v118, v119
    s_add_u32 s48, s28, 20480
    s_cmp_eq_u32 s18, 0
    s_cbranch_scc1 interleave_layers__linear_attn_block__geglu_ffn__prompt_kernel_os40_slow
    buffer_store_dwordx4 v[64:67], v0, s[4:7], s28 offen
    buffer_store_dwordx4 v[72:75], v0, s[4:7], s48 offen
    s_mov_b32 exec_hi, 0
    buffer_store_dwordx2 v[68:69], v15, s[4:7], s28 offen offset:1024
    buffer_store_dwordx2 v[76:77], v15, s[4:7], s48 offen offset:1024
interleave_layers__linear_attn_block__geglu_ffn__prompt_kernel_os40_join:
    s_mov_b64 exec, -1
    buffer_load_dword v43, v33, s[4:7], s25 offen sc1
    s_add_u32 s54, s21, 32768
    s_add_u32 m0, s73, 81920
    s_nop 0
    buffer_load_dwordx4 v0, s[4:7], s54 offen offset:0 sc1 lds
    buffer_load_dwordx4 v0, s[4:7], s54 offen offset:1024 sc1 lds
    buffer_load_dwordx4 v0, s[4:7], s54 offen offset:2048 sc1 lds
    buffer_load_dwordx4 v0, s[4:7], s54 offen offset:3072 sc1 lds
    s_add_u32 s19, s19, 1
    v_mov_b32 v41, s19
    v_mov_b32 v42, 0
    s_mov_b64 exec, 1
    s_waitcnt vmcnt(5)
    s_cmp_eq_u32 s18, 0
    s_cbranch_scc1 interleave_layers__linear_attn_block__geglu_ffn__prompt_kernel_fl41_slow
    buffer_store_dword v41, v42, s[4:7], s40 offen
interleave_layers__linear_attn_block__geglu_ffn__prompt_kernel_fl41_join:
    s_mov_b64 exec, -1
    s_cmp_lg_u32 s17, 0
    s_cbranch_scc1 interleave_layers__linear_attn_block__geglu_ffn__prompt_kernel_k442
    s_add_u32 s53, s23, 8192
    buffer_load_dwordx4 v[216:219], v0, s[4:7], s53 offen offset:0 sc1
    buffer_load_dwordx4 v[220:223], v0, s[4:7], s53 offen offset:1024 sc1
    s_add_u32 s53, s23, 12288
    buffer_load_dwordx4 v[224:227], v0, s[4:7], s53 offen offset:3072 sc1
    s_add_u32 s53, s23, 16384
    buffer_load_dwordx4 v[228:231], v0, s[4:7], s53 offen offset:0 sc1
    buffer_load_dwordx4 v[232:235], v0, s[4:7], s53 offen offset:1024 sc1
interleave_layers__linear_attn_block__geglu_ffn__prompt_kernel_k442:
    s_mov_b32 s72, 0x20000
    s_mov_b64 exec, s[68:69]
interleave_layers__linear_attn_block__geglu_ffn__prompt_kernel_poll43:
    buffer_load_dword v41, v31, s[4:7], s41 offen sc1
    s_waitcnt vmcnt(0)
    v_subrev_u32 v42, s19, v41
    v_cmp_lt_u32 vcc, 12, v42
    s_cbranch_vccz interleave_layers__linear_attn_block__geglu_ffn__prompt_kernel_pdone44
    s_sub_u32 s72, s72, 1
    s_cbranch_scc0 interleave_layers__linear_attn_block__geglu_ffn__prompt_kernel_poll43
    s_branch interleave_layers__linear_attn_block__geglu_ffn__prompt_kernel_end
interleave_layers__linear_attn_block__geglu_ffn__prompt_kernel_pdone44:
    s_mov_b64 exec, -1
    buffer_load_dwordx4 a[0:3], v0, s[4:7], s29 offen offset:0 sc1
    buffer_load_dwordx4 a[4:7], v0, s[4:7], s29 offen offset:1024 sc1
    buffer_load_dwordx4 a[8:11], v0, s[4:7], s29 offen offset:2048 sc1
    buffer_load_dwordx4 a[12:15], v0, s[4:7], s29 offen offset:3072 sc1
    s_add_u32 s52, s29, 4096
    buffer_load_dwordx4 a[16:19], v0, s[4:7], s52 offen offset:0 sc1
    s_waitcnt vmcnt(4)
    v_mfma_f32_16x16x32_bf16 v[44:47], a[160:163], a[0:3], 0
    buffer_load_dwordx4 a[20:23], v0, s[4:7], s30 offen offset:0 sc1
    v_mfma_f32_16x16x32_bf16 v[48:51], a[164:167], a[0:3], 0
    s_waitcnt vmcnt(4)
    v_mfma_f32_16x16x32_bf16 v[44:47], a[180:183], a[4:7], v[44:47]
    buffer_load_dwordx4 a[24:27], v0, s[4:7], s30 offen offset:1024 sc1
    v_mfma_f32_16x16x32_bf16 v[48:51], a[184:187], a[4:7], v[48:51]
    s_waitcnt vmcnt(4)
    v_mfma_f32_16x16x32_bf16 v[44:47], a[200:203], a[8:11], v[44:47]
    buffer_load_dwordx4 a[28:31], v0, s[4:7], s30 offen offset:2048 sc1
    v_mfma_f32_16x16x32_bf16 v[48:51], a[204:207], a[8:11], v[48:51]
    v_lshlrev_b32 v124, 16, v4
    s_waitcnt vmcnt(4)
    v_mfma_f32_16x16x32_bf16 v[44:47], a[220:223], a[12:15], v[44:47]
    v_and_b32 v125, 0xffff0000, v4
    buffer_load_dwordx4 a[32:35], v0, s[4:7], s30 offen offset:3072 sc1
    v_mfma_f32_16x16x32_bf16 v[48:51], a[224:227], a[12:15], v[48:51]
    v_lshlrev_b32 v126, 16, v5
    s_waitcnt vmcnt(4)
    v_mfma_f32_16x16x32_bf16 v[44:47], a[240:243], a[16:19], v[44:47]
    v_and_b32 v127, 0xffff0000, v5
    s_add_u32 s52, s30, 4096
    buffer_load_dwordx4 a[36:39], v0, s[4:7], s52 offen offset:0 sc1
    v_mfma_f32_16x16x32_bf16 v[48:51], a[244:247], a[16:19], v[48:51]
    v_lshlrev_b32 v128, 16, v6
    s_waitcnt vmcnt(4)
    v_mfma_f32_16x16x32_bf16 v[64:67], a[160:163], a[20:23], 0
    v_and_b32 v129, 0xffff0000, v6
    buffer_load_dwordx4 a[40:43], v0, s[4:7], s31 offen offset:0 sc1
    v_mfma_f32_16x16x32_bf16 v[68:71], a[164:167], a[20:23], 0
    v_lshlrev_b32 v130, 16, v7
    s_waitcnt vmcnt(4)
    v_mfma_f32_16x16x32_bf16 v[64:67], a[180:183], a[24:27], v[64:67]
    v_add_u32 v150, s56, v0
    v_and_b32 v131, 0xffff0000, v7
    buffer_load_dwordx4 a[44:47], v0, s[4:7], s31 offen offset:1024 sc1
    v_mfma_f32_16x16x32_bf16 v[68:71], a[184:187], a[24:27], v[68:71]
    ds_write_b128 v150, v[44:47] offset:0
    v_lshlrev_b32 v132, 16, v8
    s_waitcnt vmcnt(4)
    v_mfma_f32_16x16x32_bf16 v[64:67], a[200:203], a[28:31], v[64:67]
    v_and_b32 v133, 0xffff0000, v8
    buffer_load_dwordx4 a[48:51], v0, s[4:7], s31 offen offset:2048 sc1
    v_mfma_f32_16x16x32_bf16 v[68:71], a[204:207], a[28:31], v[68:71]
    ds_write_b128 v150, v[48:51] offset:1024
    v_lshlrev_b32 v134, 16, v9
    s_waitcnt vmcnt(4)
    v_mfma_f32_16x16x32_bf16 v[64:67], a[220:223], a[32:35], v[64:67]
    v_and_b32 v135, 0xffff0000, v9
    buffer_load_dwordx4 a[52:55], v0, s[4:7], s31 offen offset:3072 sc1
    v_mfma_f32_16x16x32_bf16 v[68:71], a[224:227], a[32:35], v[68:71]
    v_lshlrev_b32 v136, 16, v10
    s_waitcnt vmcnt(4)
    v_mfma_f32_16x16x32_bf16 v[64:67], a[240:243], a[36:39], v[64:67]
    v_and_b32 v137, 0xffff0000, v10
    s_add_u32 s52, s31, 4096
    buffer_load_dwordx4 a[56:59], v0, s[4:7], s52 offen offset:0 sc1
    v_mfma_f32_16x16x32_bf16 v[68:71], a[244:247], a[36:39], v[68:71]
    v_lshlrev_b32 v138, 16, v11
    s_waitcnt vmcnt(4)
    v_mfma_f32_16x16x32_bf16 v[84:87], a[160:163], a[40:43], 0
    v_and_b32 v139, 0xffff0000, v11
    buffer_load_dwordx4 a[60:63], v0, s[4:7], s32 offen offset:0 sc1
    v_mfma_f32_16x16x32_bf16 v[88:91], a[164:167], a[40:43], 0
    v_lshlrev_b32 v140, 16, v12
    s_waitcnt vmcnt(4)
    v_mfma_f32_16x16x32_bf16 v[84:87], a[180:183], a[44:47], v[84:87]
    v_add_u32 v150, s57, v0
    v_and_b32 v141, 0xffff0000, v12
    buffer_load_dwordx4 a[64:67], v0, s[4:7], s32 offen offset:1024 sc1
    v_mfma_f32_16x16x32_bf16 v[88:91], a[184:187], a[44:47], v[88:91]
    ds_write_b128 v150, v[64:67] offset:0
    v_lshlrev_b32 v142, 16, v13
    s_waitcnt vmcnt(4)
    v_mfma_f32_16x16x32_bf16 v[84:87], a[200:203], a[48:51], v[84:87]
    v_and_b32 v143, 0xffff0000, v13
    buffer_load_dwordx4 a[68:71], v0, s[4:7], s32 offen offset:2048 sc1
    v_mfma_f32_16x16x32_bf16 v[88:91], a[204:207], a[48:51], v[88:91]
    ds_write_b128 v150, v[68:71] offset:1024
    s_waitcnt vmcnt(4)
    v_mfma_f32_16x16x32_bf16 v[84:87], a[220:223], a[52:55], v[84:87]
    buffer_load_dwordx4 a[72:75], v0, s[4:7], s32 offen offset:3072 sc1
    v_mfma_f32_16x16x32_bf16 v[88:91], a[224:227], a[52:55], v[88:91]
    s_waitcnt vmcnt(4)
    v_mfma_f32_16x16x32_bf16 v[84:87], a[240:243], a[56:59], v[84:87]
    s_add_u32 s52, s32, 4096
    buffer_load_dwordx4 a[76:79], v0, s[4:7], s52 offen offset:0 sc1
    v_mfma_f32_16x16x32_bf16 v[88:91], a[244:247], a[56:59], v[88:91]
    s_waitcnt vmcnt(4)
    v_mfma_f32_16x16x32_bf16 v[104:107], a[160:163], a[60:63], 0
    v_mfma_f32_16x16x32_bf16 v[108:111], a[164:167], a[60:63], 0
    s_waitcnt vmcnt(3)
    v_mfma_f32_16x16x32_bf16 v[104:107], a[180:183], a[64:67], v[104:107]
    v_add_u32 v150, s58, v0
    v_mfma_f32_16x16x32_bf16 v[108:111], a[184:187], a[64:67], v[108:111]
    ds_write_b128 v150, v[84:87] offset:0
    s_waitcnt vmcnt(2)
    v_mfma_f32_16x16x32_bf16 v[104:107], a[200:203], a[68:71], v[104:107]
    v_mfma_f32_16x16x32_bf16 v[108:111], a[204:207], a[68:71], v[108:111]
    ds_write_b128 v150, v[88:91] offset:1024
    s_waitcnt vmcnt(1)
    v_mfma_f32_16x16x32_bf16 v[104:107], a[220:223], a[72:75], v[104:107]
    v_mfma_f32_16x16x32_bf16 v[108:111], a[224:227], a[72:75], v[108:111]
    s_waitcnt vmcnt(0)
    v_mfma_f32_16x16x32_bf16 v[104:107], a[240:243], a[76:79], v[104:107]
    s_waitcnt lgkmcnt(0)
    s_barrier
    v_add_u32 v40, s59, v0
    v_mfma_f32_16x16x32_bf16 v[108:111], a[244:247], a[76:79], v[108:111]
    ds_read_b128 v[44:47], v40 offset:0
    ds_read_b128 v[48:51], v40 offset:1024
    v_mfma_f32_16x16x32_bf16 v[52:55], a[168:171], a[0:3], 0
    ds_read_b128 v[64:67], v40 offset:5120
    v_mfma_f32_16x16x32_bf16 v[56:59], a[172:175], a[0:3], 0
    ds_read_b128 v[68:71], v40 offset:6144
    ds_read_b128 v[84:87], v40 offset:10240
    v_mfma_f32_16x16x32_bf16 v[60:63], a[176:179], a[0:3], 0
    ds_read_b128 v[88:91], v40 offset:11264
    v_mfma_f32_16x16x32_bf16 v[52:55], a[188:191], a[4:7], v[52:55]
    v_mfma_f32_16x16x32_bf16 v[56:59], a[192:195], a[4:7], v[56:59]
    v_mfma_f32_16x16x32_bf16 v[60:63], a[196:199], a[4:7], v[60:63]
    v_mfma_f32_16x16x32_bf16 v[52:55], a[208:211], a[8:11], v[52:55]
    s_waitcnt lgkmcnt(5)
    v_pk_add_f32 v[124:125], v[124:125], v[44:45]
    v_mfma_f32_16x16x32_bf16 v[56:59], a[212:215], a[8:11], v[56:59]
    v_pk_add_f32 v[126:127], v[126:127], v[46:47]
    v_mfma_f32_16x16x32_bf16 v[60:63], a[216:219], a[8:11], v[60:63]
    s_waitcnt lgkmcnt(4)
    v_pk_add_f32 v[128:129], v[128:129], v[48:49]
    v_mfma_f32_16x16x32_bf16 v[52:55], a[228:231], a[12:15], v[52:55]
    v_pk_add_f32 v[130:131], v[130:131], v[50:51]
    v_mfma_f32_16x16x32_bf16 v[56:59], a[232:235], a[12:15], v[56:59]
    s_waitcnt lgkmcnt(3)
    v_pk_add_f32 v[124:125], v[124:125], v[64:65]
    v_mfma_f32_16x16x32_bf16 v[60:63], a[236:239], a[12:15], v[60:63]
    v_pk_add_f32 v[126:127], v[126:127], v[66:67]
    v_mfma_f32_16x16x32_bf16 v[52:55], a[248:251], a[16:19], v[52:55]
    s_waitcnt lgkmcnt(2)
    v_pk_add_f32 v[128:129], v[128:129], v[68:69]
    v_mfma_f32_16x16x32_bf16 v[56:59], a[252:255], a[16:19], v[56:59]
    v_pk_add_f32 v[130:131], v[130:131], v[70:71]
    v_mfma_f32_16x16x32_bf16 v[60:63], v[252:255], a[16:19], v[60:63]
    s_waitcnt lgkmcnt(1)
    v_pk_add_f32 v[124:125], v[124:125], v[84:85]
    v_mfma_f32_16x16x32_bf16 v[72:75], a[168:171], a[20:23], 0
    v_pk_add_f32 v[126:127], v[126:127], v[86:87]
    v_mfma_f32_16x16x32_bf16 v[76:79], a[172:175], a[20:23], 0
    s_waitcnt lgkmcnt(0)
    v_pk_add_f32 v[128:129], v[128:129], v[88:89]
    v_mfma_f32_16x16x32_bf16 v[80:83], a[176:179], a[20:23], 0
    v_add_u32 v150, s56, v0
    v_pk_add_f32 v[130:131], v[130:131], v[90:91]
    v_mfma_f32_16x16x32_bf16 v[72:75], a[188:191], a[24:27], v[72:75]
    ds_write_b128 v150, v[52:55] offset:2048
    v_pk_add_f32 v[124:125], v[124:125], v[104:105]
    v_mfma_f32_16x16x32_bf16 v[76:79], a[192:195], a[24:27], v[76:79]
    v_pk_add_f32 v[126:127], v[126:127], v[106:107]
    v_mfma_f32_16x16x32_bf16 v[80:83], a[196:199], a[24:27], v[80:83]
    ds_write_b128 v150, v[56:59] offset:3072
    v_pk_add_f32 v[128:129], v[128:129], v[108:109]
    v_mfma_f32_16x16x32_bf16 v[72:75], a[208:211], a[28:31], v[72:75]
    v_pk_add_f32 v[130:131], v[130:131], v[110:111]
    v_mfma_f32_16x16x32_bf16 v[76:79], a[212:215], a[28:31], v[76:79]
    ds_write_b128 v150, v[60:63] offset:4096
    v_cvt_pk_bf16_f32 v4, v124, v125
    v_mfma_f32_16x16x32_bf16 v[80:83], a[216:219], a[28:31], v[80:83]
    v_cvt_pk_bf16_f32 v5, v126, v127
    v_mfma_f32_16x16x32_bf16 v[72:75], a[228:231], a[32:35], v[72:75]
    v_cvt_pk_bf16_f32 v6, v128, v129
    v_mfma_f32_16x16x32_bf16 v[76:79], a[232:235], a[32:35], v[76:79]
    s_cmp_lg_u32 s17, 0
    s_cbranch_scc1 interleave_layers__linear_attn_block__geglu_ffn__prompt_kernel_k445
    s_add_u32 s53, s23, 16384
    buffer_load_dwordx4 v[236:239], v0, s[4:7], s53 offen offset:2048 sc1
interleave_layers__linear_attn_block__geglu_ffn__prompt_kernel_k445:
    v_cvt_pk_bf16_f32 v7, v130, v131
    v_mfma_f32_16x16x32_bf16 v[80:83], a[236:239], a[32:35], v[80:83]
    s_cmp_eq_u32 s18, 0
    s_cbranch_scc1 interleave_layers__linear_attn_block__geglu_ffn__prompt_kernel_xs46_slow
    buffer_store_dwordx4 v[4:7], v0, s[4:7], s25 offen
interleave_layers__linear_attn_block__geglu_ffn__prompt_kernel_xs46_join:
    v_mfma_f32_16x16x32_bf16 v[72:75], a[248:251], a[36:39], v[72:75]
    v_mfma_f32_16x16x32_bf16 v[76:79], a[252:255], a[36:39], v[76:79]
    v_mfma_f32_16x16x32_bf16 v[80:83], v[252:255], a[36:39], v[80:83]
    v_mfma_f32_16x16x32_bf16 v[92:95], a[168:171], a[40:43], 0
    s_cmp_lg_u32 s17, 0
    s_cbranch_scc1 interleave_layers__linear_attn_block__geglu_ffn__prompt_kernel_k447
    s_add_u32 s53, s23, 16384
    buffer_load_dwordx4 v[240:243], v0, s[4:7], s53 offen offset:3072 sc1
interleave_layers__linear_attn_block__geglu_ffn__prompt_kernel_k447:
    v_mfma_f32_16x16x32_bf16 v[96:99], a[172:175], a[40:43], 0
    v_mfma_f32_16x16x32_bf16 v[100:103], a[176:179], a[40:43], 0
    v_add_u32 v150, s57, v0
    v_mfma_f32_16x16x32_bf16 v[92:95], a[188:191], a[44:47], v[92:95]
    ds_write_b128 v150, v[72:75] offset:2048
    v_mfma_f32_16x16x32_bf16 v[96:99], a[192:195], a[44:47], v[96:99]
    v_mfma_f32_16x16x32_bf16 v[100:103], a[196:199], a[44:47], v[100:103]
    s_add_u32 s54, s21, 49152
    s_add_u32 m0, s73, 98304
    s_nop 0
    buffer_load_dwordx4 v0, s[4:7], s54 offen offset:0 sc1 lds
    ds_write_b128 v150, v[76:79] offset:3072
    v_mfma_f32_16x16x32_bf16 v[92:95], a[208:211], a[48:51], v[92:95]
    buffer_load_dwordx4 v0, s[4:7], s54 offen offset:1024 sc1 lds
    v_mfma_f32_16x16x32_bf16 v[96:99], a[212:215], a[48:51], v[96:99]
    ds_write_b128 v150, v[80:83] offset:4096
    v_mfma_f32_16x16x32_bf16 v[100:103], a[216:219], a[48:51], v[100:103]
    v_mfma_f32_16x16x32_bf16 v[92:95], a[228:231], a[52:55], v[92:95]
    v_mfma_f32_16x16x32_bf16 v[96:99], a[232:235], a[52:55], v[96:99]
    buffer_load_dwordx4 v0, s[4:7], s54 offen offset:2048 sc1 lds
    v_mfma_f32_16x16x32_bf16 v[100:103], a[236:239], a[52:55], v[100:103]
    v_mfma_f32_16x16x32_bf16 v[92:95], a[248:251], a[56:59], v[92:95]
    v_mfma_f32_16x16x32_bf16 v[96:99], a[252:255], a[56:59], v[96:99]
    v_mfma_f32_16x16x32_bf16 v[100:103], v[252:255], a[56:59], v[100:103]
    v_mfma_f32_16x16x32_bf16 v[112:115], a[168:171], a[60:63], 0
    buffer_load_dwordx4 v0, s[4:7], s54 offen offset:3072 sc1 lds
    v_mfma_f32_16x16x32_bf16 v[116:119], a[172:175], a[60:63], 0
    v_mfma_f32_16x16x32_bf16 v[120:123], a[176:179], a[60:63], 0
    v_add_u32 v150, s58, v0
    v_mfma_f32_16x16x32_bf16 v[112:115], a[188:191], a[64:67], v[112:115]
    ds_write_b128 v150, v[92:95] offset:2048
    v_mfma_f32_16x16x32_bf16 v[116:119], a[192:195], a[64:67], v[116:119]
    v_mfma_f32_16x16x32_bf16 v[120:123], a[196:199], a[64:67], v[120:123]
    ds_write_b128 v150, v[96:99] offset:3072
    v_mfma_f32_16x16x32_bf16 v[112:115], a[208:211], a[68:71], v[112:115]
    v_mfma_f32_16x16x32_bf16 v[116:119], a[212:215], a[68:71], v[116:119]
    ds_write_b128 v150, v[100:103] offset:4096
    v_mfma_f32_16x16x32_bf16 v[120:123], a[216:219], a[68:71], v[120:123]
    v_mfma_f32_16x16x32_bf16 v[112:115], a[228:231], a[72:75], v[112:115]
    s_add_u32 s19, s19, 1
    v_mov_b32 v41, s19
    v_mov_b32 v42, 0
    s_mov_b64 exec, 1
    s_waitcnt vmcnt(4)
    s_cmp_eq_u32 s18, 0
    s_cbranch_scc1 interleave_layers__linear_attn_block__geglu_ffn__prompt_kernel_fl48_slow
    buffer_store_dword v41, v42, s[4:7], s40 offen
interleave_layers__linear_attn_block__geglu_ffn__prompt_kernel_fl48_join:
    s_mov_b64 exec, -1
    v_mfma_f32_16x16x32_bf16 v[116:119], a[232:235], a[72:75], v[116:119]
    s_waitcnt lgkmcnt(0)
    s_barrier
    v_add_u32 v40, s59, v0
    v_mfma_f32_16x16x32_bf16 v[120:123], a[236:239], a[72:75], v[120:123]
    ds_read_b128 v[52:55], v40 offset:2048
    ds_read_b128 v[56:59], v40 offset:3072
    v_mfma_f32_16x16x32_bf16 v[112:115], a[248:251], a[76:79], v[112:115]
    ds_read_b128 v[60:63], v40 offset:4096
    v_mfma_f32_16x16x32_bf16 v[116:119], a[252:255], a[76:79], v[116:119]
    ds_read_b128 v[72:75], v40 offset:7168
    ds_read_b128 v[76:79], v40 offset:8192
    v_mfma_f32_16x16x32_bf16 v[120:123], v[252:255], a[76:79], v[120:123]
    ds_read_b128 v[80:83], v40 offset:9216
    ds_read_b128 v[92:95], v40 offset:12288
    ds_read_b128 v[96:99], v40 offset:13312
    ds_read_b128 v[100:103], v40 offset:14336
    buffer_load_dword v38, v31, s[4:7], s41 offen sc1
    s_waitcnt lgkmcnt(6)
    v_pk_add_f32 v[132:133], v[132:133], v[52:53]
    v_pk_add_f32 v[134:135], v[134:135], v[54:55]
    v_pk_add_f32 v[136:137], v[136:137], v[56:57]
    v_pk_add_f32 v[138:139], v[138:139], v[58:59]
    v_pk_add_f32 v[140:141], v[140:141], v[60:61]
    v_pk_add_f32 v[142:143], v[142:143], v[62:63]
    s_waitcnt lgkmcnt(3)
    v_pk_add_f32 v[132:133], v[132:133], v[72:73]
    v_pk_add_f32 v[134:135], v[134:135], v[74:75]
    v_pk_add_f32 v[136:137], v[136:137], v[76:77]
    v_pk_add_f32 v[138:139], v[138:139], v[78:79]
    v_pk_add_f32 v[140:141], v[140:141], v[80:81]
    v_pk_add_f32 v[142:143], v[142:143], v[82:83]
    s_waitcnt lgkmcnt(0)
    v_pk_add_f32 v[132:133], v[132:133], v[92:93]
    v_pk_add_f32 v[134:135], v[134:135], v[94:95]
    v_pk_add_f32 v[136:137], v[136:137], v[96:97]
    v_pk_add_f32 v[138:139], v[138:139], v[98:99]
    v_pk_add_f32 v[140:141], v[140:141], v[100:101]
    v_pk_add_f32 v[142:143], v[142:143], v[102:103]
    v_pk_add_f32 v[132:133], v[132:133], v[112:113]
    v_pk_add_f32 v[134:135], v[134:135], v[114:115]
    v_pk_add_f32 v[136:137], v[136:137], v[116:117]
    v_pk_add_f32 v[138:139], v[138:139], v[118:119]
    v_pk_add_f32 v[140:141], v[140:141], v[120:121]
    v_pk_add_f32 v[142:143], v[142:143], v[122:123]
    v_cvt_pk_bf16_f32 v8, v132, v133
    v_cvt_pk_bf16_f32 v9, v134, v135
    v_cvt_pk_bf16_f32 v10, v136, v137
    v_cvt_pk_bf16_f32 v11, v138, v139
    v_cvt_pk_bf16_f32 v12, v140, v141
    v_cvt_pk_bf16_f32 v13, v142, v143
    s_cmp_eq_u32 s18, 0
    s_cbranch_scc1 interleave_layers__linear_attn_block__geglu_ffn__prompt_kernel_xs49_slow
    buffer_store_dwordx4 v[8:11], v0, s[4:7], s66 offen
    buffer_store_dwordx2 v[12:13], v15, s[4:7], s66 offen offset:1024
interleave_layers__linear_attn_block__geglu_ffn__prompt_kernel_xs49_join:
    s_waitcnt vmcnt(2)
    v_subrev_u32 v38, s19, v38
    v_cmp_lt_u32 vcc, 12, v38
    s_nop 1
    s_and_b64 vcc, vcc, s[70:71]
    s_cbranch_scc1 interleave_layers__linear_attn_block__geglu_ffn__prompt_kernel_aspin51
interleave_layers__linear_attn_block__geglu_ffn__prompt_kernel_adone50:
    buffer_load_dwordx4 a[0:3], v0, s[4:7], s24 offen offset:0 sc1
    buffer_load_dwordx4 a[4:7], v14, s[4:7], s24 offen offset:0 sc1
    buffer_load_dwordx4 a[8:11], v0, s[4:7], s24 offen offset:1024 sc1
    buffer_load_dwordx4 a[12:15], v14, s[4:7], s24 offen offset:1024 sc1
    buffer_load_dwordx4 a[16:19], v0, s[4:7], s24 offen offset:2048 sc1
    buffer_load_dwordx4 a[20:23], v14, s[4:7], s24 offen offset:2048 sc1
    v_mov_b32 v144, 0
    v_mov_b32 v145, 0
    v_mov_b32 v146, 0
    v_mov_b32 v147, 0
    v_dot2c_f32_bf16 v144, v4, v32
    v_dot2c_f32_bf16 v145, v4, v4
    v_dot2c_f32_bf16 v146, v5, v32
    v_dot2c_f32_bf16 v147, v5, v5
    v_dot2c_f32_bf16 v144, v6, v32
    v_dot2c_f32_bf16 v145, v6, v6
    v_dot2c_f32_bf16 v146, v7, v32
    v_dot2c_f32_bf16 v147, v7, v7
    v_dot2c_f32_bf16 v144, v8, v32
    v_dot2c_f32_bf16 v145, v8, v8
    v_dot2c_f32_bf16 v146, v9, v32
    v_dot2c_f32_bf16 v147, v9, v9
    v_dot2c_f32_bf16 v144, v10, v32
    v_dot2c_f32_bf16 v145, v10, v10
    v_dot2c_f32_bf16 v146, v11, v32
    v_dot2c_f32_bf16 v147, v11, v11
    v_dot2c_f32_bf16 v144, v12, v32
    v_dot2c_f32_bf16 v145, v12, v12
    v_dot2c_f32_bf16 v146, v13, v32
    v_dot2c_f32_bf16 v147, v13, v13
    s_nop 2
    v_pk_add_f32 v[144:145], v[144:145], v[146:147]
    v_mov_b32 v146, v144
    v_mov_b32 v147, v145
    s_nop 0
    v_permlane16_swap_b32 v144, v146
    v_permlane16_swap_b32 v145, v147
    v_pk_add_f32 v[144:145], v[144:145], v[146:147]
    v_mov_b32 v146, v144
    v_mov_b32 v147, v145
    s_nop 0
    v_permlane32_swap_b32 v144, v146
    v_permlane32_swap_b32 v145, v147
    v_pk_add_f32 v[144:145], v[144:145], v[146:147]
    s_mov_b64 exec, 0xffff
    s_cmp_eq_u32 s18, 0
    s_cbranch_scc1 interleave_layers__linear_attn_block__geglu_ffn__prompt_kernel_ss54_slow
    buffer_store_dwordx2 v[144:145], v0, s[4:7], s27 offen
interleave_layers__linear_attn_block__geglu_ffn__prompt_kernel_ss54_join:
    s_mov_b64 exec, -1
    s_cmp_eq_u32 s17, 0
    s_cselect_b32 s46, 268435456, 0
    s_add_u32 s50, s24, 0
    ds_read_b128 v[44:47], v0 offset:49152
    ds_read_b128 v[48:51], v0 offset:50176
    ds_read_b128 v[52:55], v0 offset:51200
    ds_read_b128 v[56:59], v0 offset:52224
    ds_read_b128 v[60:63], v0 offset:53248
    ds_read_b128 v[64:67], v0 offset:54272
    s_add_u32 s51, s33, 49152
    s_waitcnt vmcnt(5) lgkmcnt(3)
    v_mfma_f32_16x16x32_bf16 v[104:107], v[44:47], a[0:3], 0
    s_add_u32 s54, s21, 65536
    s_add_u32 m0, s73, 114688
    s_nop 0
    buffer_load_dwordx4 v0, s[4:7], s54 offen offset:0 sc1 lds
    v_mfma_f32_16x16x32_bf16 v[108:111], v[44:47], a[4:7], 0
    ds_read_b128 v[44:47], v0 offset:55296
    buffer_load_dwordx4 a[24:27], v0, s[4:7], s24 offen offset:3072 sc1
    v_mfma_f32_16x16x32_bf16 v[112:115], v[48:51], a[0:3], 0
    v_mfma_f32_16x16x32_bf16 v[116:119], v[48:51], a[4:7], 0
    ds_read_b128 v[48:51], v0 offset:56320
    v_mfma_f32_16x16x32_bf16 v[120:123], v[52:55], a[0:3], 0
    v_mfma_f32_16x16x32_bf16 v[124:127], v[52:55], a[4:7], 0
    ds_read_b128 v[52:55], v0 offset:57344
    s_waitcnt lgkmcnt(3)
    v_mfma_f32_16x16x32_bf16 v[128:131], v[56:59], a[0:3], 0
    buffer_load_dwordx4 a[28:31], v14, s[4:7], s24 offen offset:3072 sc1
    v_mfma_f32_16x16x32_bf16 v[132:135], v[56:59], a[4:7], 0
    ds_read_b128 v[56:59], v0 offset:58368
    v_mfma_f32_16x16x32_bf16 v[136:139], v[60:63], a[0:3], 0
    buffer_load_dwordx4 v0, s[4:7], s54 offen offset:1024 sc1 lds
    v_mfma_f32_16x16x32_bf16 v[140:143], v[60:63], a[4:7], 0
    ds_read_b128 v[60:63], v0 offset:59392
    v_mfma_f32_16x16x32_bf16 v[144:147], v[64:67], a[0:3], 0
    v_mfma_f32_16x16x32_bf16 v[148:151], v[64:67], a[4:7], 0
    ds_read_b128 v[64:67], v0 offset:60416
    s_waitcnt lgkmcnt(3)
    v_mfma_f32_16x16x32_bf16 v[152:155], v[44:47], a[0:3], 0
    v_mfma_f32_16x16x32_bf16 v[156:159], v[44:47], a[4:7], 0
    ds_read_b128 v[44:47], v0 offset:61440
    v_mfma_f32_16x16x32_bf16 v[160:163], v[48:51], a[0:3], 0
    s_add_u32 s52, s24, 4096
    buffer_load_dwordx4 a[32:35], v0, s[4:7], s52 offen offset:0 sc1
    v_mfma_f32_16x16x32_bf16 v[164:167], v[48:51], a[4:7], 0
    ds_read_b128 v[48:51], v0 offset:62464
    s_waitcnt vmcnt(8)
    v_mfma_f32_16x16x32_bf16 v[104:107], v[52:55], a[8:11], v[104:107]
    buffer_load_dwordx4 v0, s[4:7], s54 offen offset:2048 sc1 lds
    v_mfma_f32_16x16x32_bf16 v[108:111], v[52:55], a[12:15], v[108:111]
    ds_read_b128 v[52:55], v0 offset:63488
    s_waitcnt lgkmcnt(3)
    v_mfma_f32_16x16x32_bf16 v[112:115], v[56:59], a[8:11], v[112:115]
    v_mfma_f32_16x16x32_bf16 v[116:119], v[56:59], a[12:15], v[116:119]
    ds_read_b128 v[56:59], v0 offset:64512
    v_mfma_f32_16x16x32_bf16 v[120:123], v[60:63], a[8:11], v[120:123]
    s_add_u32 s19, s19, 1
    v_mov_b32 v41, s19
    v_mov_b32 v42, 0
    s_mov_b64 exec, 1
    s_waitcnt vmcnt(6)
    s_cmp_eq_u32 s18, 0
    s_cbranch_scc1 interleave_layers__linear_attn_block__geglu_ffn__prompt_kernel_fl55_slow
    buffer_store_dword v41, v42, s[4:7], s40 offen
interleave_layers__linear_attn_block__geglu_ffn__prompt_kernel_fl55_join:
    s_mov_b64 exec, -1
    v_mfma_f32_16x16x32_bf16 v[124:127], v[60:63], a[12:15], v[124:127]
    ds_read_b128 v[60:63], v2 offset:0
    v_mfma_f32_16x16x32_bf16 v[128:131], v[64:67], a[8:11], v[128:131]
    buffer_load_dwordx4 a[36:39], v14, s[4:7], s52 offen offset:0 sc1
    v_mfma_f32_16x16x32_bf16 v[132:135], v[64:67], a[12:15], v[132:135]
    ds_read_b128 v[64:67], v2 offset:1024
    s_waitcnt lgkmcnt(3)
    v_mfma_f32_16x16x32_bf16 v[136:139], v[44:47], a[8:11], v[136:139]
    buffer_load_dwordx4 v0, s[4:7], s54 offen offset:3072 sc1 lds
    v_mfma_f32_16x16x32_bf16 v[140:143], v[44:47], a[12:15], v[140:143]
    ds_read_b128 v[44:47], v2 offset:2048
    v_mfma_f32_16x16x32_bf16 v[144:147], v[48:51], a[8:11], v[144:147]
    v_mfma_f32_16x16x32_bf16 v[148:151], v[48:51], a[12:15], v[148:151]
    ds_read_b128 v[48:51], v2 offset:3072
    v_mfma_f32_16x16x32_bf16 v[152:155], v[52:55], a[8:11], v[152:155]
    v_mfma_f32_16x16x32_bf16 v[156:159], v[52:55], a[12:15], v[156:159]
    ds_read_b128 v[52:55], v2 offset:4096
    s_waitcnt lgkmcnt(3)
    v_mfma_f32_16x16x32_bf16 v[160:163], v[56:59], a[8:11], v[160:163]
    buffer_load_dwordx4 a[40:43], v0, s[4:7], s52 offen offset:1024 sc1
    v_mfma_f32_16x16x32_bf16 v[164:167], v[56:59], a[12:15], v[164:167]
    ds_read_b128 v[56:59], v2 offset:5120
    v_mfma_f32_16x16x32_bf16 v[104:107], v[60:63], a[16:19], v[104:107]
    s_barrier
    s_add_u32 s54, s21, 81920
    s_add_u32 m0, s73, 131072
    s_nop 0
    buffer_load_dwordx4 v0, s[4:7], s54 offen offset:0 sc1 lds
    v_mfma_f32_16x16x32_bf16 v[108:111], v[60:63], a[20:23], v[108:111]
    ds_read_b128 v[60:63], v2 offset:6144
    v_mfma_f32_16x16x32_bf16 v[112:115], v[64:67], a[16:19], v[112:115]
    v_mfma_f32_16x16x32_bf16 v[116:119], v[64:67], a[20:23], v[116:119]
    ds_read_b128 v[64:67], v2 offset:7168
    s_waitcnt lgkmcnt(3)
    v_mfma_f32_16x16x32_bf16 v[120:123], v[44:47], a[16:19], v[120:123]
    v_mfma_f32_16x16x32_bf16 v[124:127], v[44:47], a[20:23], v[124:127]
    ds_read_b128 v[44:47], v2 offset:8192
    v_mfma_f32_16x16x32_bf16 v[128:131], v[48:51], a[16:19], v[128:131]
    buffer_load_dwordx4 a[44:47], v14, s[4:7], s52 offen offset:1024 sc1
    v_mfma_f32_16x16x32_bf16 v[132:135], v[48:51], a[20:23], v[132:135]
    ds_read_b128 v[48:51], v2 offset:9216
    v_mfma_f32_16x16x32_bf16 v[136:139], v[52:55], a[16:19], v[136:139]
    buffer_load_dwordx4 v0, s[4:7], s54 offen offset:1024 sc1 lds
    v_mfma_f32_16x16x32_bf16 v[140:143], v[52:55], a[20:23], v[140:143]
    ds_read_b128 v[52:55], v2 offset:10240
    s_waitcnt lgkmcnt(3)
    v_mfma_f32_16x16x32_bf16 v[144:147], v[56:59], a[16:19], v[144:147]
    v_mfma_f32_16x16x32_bf16 v[148:151], v[56:59], a[20:23], v[148:151]
    ds_read_b128 v[56:59], v2 offset:11264
    v_mfma_f32_16x16x32_bf16 v[152:155], v[60:63], a[16:19], v[152:155]
    buffer_load_dwordx4 a[48:51], v0, s[4:7], s52 offen offset:2048 sc1
    v_mfma_f32_16x16x32_bf16 v[156:159], v[60:63], a[20:23], v[156:159]
    ds_read_b128 v[60:63], v2 offset:12288
    v_mfma_f32_16x16x32_bf16 v[160:163], v[64:67], a[16:19], v[160:163]
    v_mfma_f32_16x16x32_bf16 v[164:167], v[64:67], a[20:23], v[164:167]
    ds_read_b128 v[64:67], v2 offset:13312
    s_waitcnt vmcnt(11) lgkmcnt(3)
    v_mfma_f32_16x16x32_bf16 v[104:107], v[44:47], a[24:27], v[104:107]
    buffer_load_dwordx4 v0, s[4:7], s54 offen offset:2048 sc1 lds
    v_mfma_f32_16x16x32_bf16 v[108:111], v[44:47], a[28:31], v[108:111]
    ds_read_b128 v[44:47], v2 offset:14336
    v_mfma_f32_16x16x32_bf16 v[112:115], v[48:51], a[24:27], v[112:115]
    v_mfma_f32_16x16x32_bf16 v[116:119], v[48:51], a[28:31], v[116:119]
    ds_read_b128 v[48:51], v2 offset:15360
    v_mfma_f32_16x16x32_bf16 v[120:123], v[52:55], a[24:27], v[120:123]
    buffer_load_dwordx4 a[52:55], v14, s[4:7], s52 offen offset:2048 sc1
    v_mfma_f32_16x16x32_bf16 v[124:127], v[52:55], a[28:31], v[124:127]
    ds_read_b128 v[52:55], v2 offset:16384
    s_waitcnt lgkmcnt(3)
    v_mfma_f32_16x16x32_bf16 v[128:131], v[56:59], a[24:27], v[128:131]
    v_mfma_f32_16x16x32_bf16 v[132:135], v[56:59], a[28:31], v[132:135]
    ds_read_b128 v[56:59], v2 offset:17408
    v_mfma_f32_16x16x32_bf16 v[136:139], v[60:63], a[24:27], v[136:139]
    buffer_load_dwordx4 v0, s[4:7], s54 offen offset:3072 sc1 lds
    v_mfma_f32_16x16x32_bf16 v[140:143], v[60:63], a[28:31], v[140:143]
    ds_read_b128 v[60:63], v2 offset:18432
    v_mfma_f32_16x16x32_bf16 v[144:147], v[64:67], a[24:27], v[144:147]
    v_mfma_f32_16x16x32_bf16 v[148:151], v[64:67], a[28:31], v[148:151]
    ds_read_b128 v[64:67], v2 offset:19456
    s_waitcnt lgkmcnt(3)
    v_mfma_f32_16x16x32_bf16 v[152:155], v[44:47], a[24:27], v[152:155]
    buffer_load_dword v38, v31, s[4:7], s41 offen sc1
    v_mfma_f32_16x16x32_bf16 v[156:159], v[44:47], a[28:31], v[156:159]
    ds_read_b128 v[44:47], v2 offset:20480
    buffer_load_dwordx4 a[56:59], v0, s[4:7], s52 offen offset:3072 sc1
    v_mfma_f32_16x16x32_bf16 v[160:163], v[48:51], a[24:27], v[160:163]
    v_mfma_f32_16x16x32_bf16 v[164:167], v[48:51], a[28:31], v[164:167]
    ds_read_b128 v[48:51], v2 offset:21504
    s_waitcnt vmcnt(11)
    v_mfma_f32_16x16x32_bf16 v[104:107], v[52:55], a[32:35], v[104:107]
    s_add_u32 s54, s21, 98304
    s_add_u32 m0, s73, 0
    s_nop 0
    buffer_load_dwordx4 v0, s[4:7], s54 offen offset:0 sc1 lds
    v_mfma_f32_16x16x32_bf16 v[108:111], v[52:55], a[36:39], v[108:111]
    ds_read_b128 v[52:55], v2 offset:22528
    s_waitcnt lgkmcnt(3)
    v_mfma_f32_16x16x32_bf16 v[112:115], v[56:59], a[32:35], v[112:115]
    v_mfma_f32_16x16x32_bf16 v[116:119], v[56:59], a[36:39], v[116:119]
    ds_read_b128 v[56:59], v2 offset:23552
    v_mfma_f32_16x16x32_bf16 v[120:123], v[60:63], a[32:35], v[120:123]
    buffer_load_dwordx4 a[60:63], v14, s[4:7], s52 offen offset:3072 sc1
    v_mfma_f32_16x16x32_bf16 v[124:127], v[60:63], a[36:39], v[124:127]
    ds_read_b128 v[60:63], v2 offset:24576
    v_mfma_f32_16x16x32_bf16 v[128:131], v[64:67], a[32:35], v[128:131]
    v_mfma_f32_16x16x32_bf16 v[132:135], v[64:67], a[36:39], v[132:135]
    ds_read_b128 v[64:67], v2 offset:25600
    s_waitcnt lgkmcnt(3)
    v_mfma_f32_16x16x32_bf16 v[136:139], v[44:47], a[32:35], v[136:139]
    buffer_load_dwordx4 v0, s[4:7], s54 offen offset:1024 sc1 lds
    v_mfma_f32_16x16x32_bf16 v[140:143], v[44:47], a[36:39], v[140:143]
    ds_read_b128 v[44:47], v2 offset:26624
    v_mfma_f32_16x16x32_bf16 v[144:147], v[48:51], a[32:35], v[144:147]
    v_mfma_f32_16x16x32_bf16 v[148:151], v[48:51], a[36:39], v[148:151]
    ds_read_b128 v[48:51], v2 offset:27648
    v_mfma_f32_16x16x32_bf16 v[152:155], v[52:55], a[32:35], v[152:155]
    v_mfma_f32_16x16x32_bf16 v[156:159], v[52:55], a[36:39], v[156:159]
    ds_read_b128 v[52:55], v2 offset:28672
    s_waitcnt lgkmcnt(3)
    v_mfma_f32_16x16x32_bf16 v[160:163], v[56:59], a[32:35], v[160:163]
    v_mfma_f32_16x16x32_bf16 v[164:167], v[56:59], a[36:39], v[164:167]
    ds_read_b128 v[56:59], v2 offset:29696
    s_waitcnt vmcnt(10)
    v_mfma_f32_16x16x32_bf16 v[104:107], v[60:63], a[40:43], v[104:107]
    buffer_load_dwordx4 v0, s[4:7], s54 offen offset:2048 sc1 lds
    s_waitcnt vmcnt(5)
    v_subrev_u32 v38, s19, v38
    v_cmp_lt_u32 vcc, 12, v38
    s_nop 1
    s_and_b64 vcc, vcc, s[70:71]
    s_cbranch_scc1 interleave_layers__linear_attn_block__geglu_ffn__prompt_kernel_aspin57
interleave_layers__linear_attn_block__geglu_ffn__prompt_kernel_adone56:
    v_mfma_f32_16x16x32_bf16 v[108:111], v[60:63], a[44:47], v[108:111]
    ds_read_b128 v[60:63], v2 offset:30720
    s_add_u32 s52, s24, 8192
    buffer_load_dwordx4 a[64:67], v0, s[4:7], s52 offen offset:0 sc1
    v_mfma_f32_16x16x32_bf16 v[112:115], v[64:67], a[40:43], v[112:115]
    buffer_load_dwordx4 a[68:71], v14, s[4:7], s52 offen offset:0 sc1
    v_mfma_f32_16x16x32_bf16 v[116:119], v[64:67], a[44:47], v[116:119]
    ds_read_b128 v[64:67], v2 offset:31744
    s_waitcnt lgkmcnt(3)
    v_mfma_f32_16x16x32_bf16 v[120:123], v[44:47], a[40:43], v[120:123]
    v_mfma_f32_16x16x32_bf16 v[124:127], v[44:47], a[44:47], v[124:127]
    ds_read_b128 v[44:47], v2 offset:32768
    v_mfma_f32_16x16x32_bf16 v[128:131], v[48:51], a[40:43], v[128:131]
    v_mfma_f32_16x16x32_bf16 v[132:135], v[48:51], a[44:47], v[132:135]
    ds_read_b128 v[48:51], v2 offset:33792
    v_mfma_f32_16x16x32_bf16 v[136:139], v[52:55], a[40:43], v[136:139]
    buffer_load_dwordx4 v0, s[4:7], s54 offen offset:3072 sc1 lds
    v_mfma_f32_16x16x32_bf16 v[140:143], v[52:55], a[44:47], v[140:143]
    ds_read_b128 v[52:55], v2 offset:34816
    buffer_load_dwordx4 a[72:75], v0, s[4:7], s52 offen offset:1024 sc1
    s_waitcnt lgkmcnt(3)
    v_mfma_f32_16x16x32_bf16 v[144:147], v[56:59], a[40:43], v[144:147]
    v_mfma_f32_16x16x32_bf16 v[148:151], v[56:59], a[44:47], v[148:151]
    ds_read_b128 v[56:59], v2 offset:35840
    v_mfma_f32_16x16x32_bf16 v[152:155], v[60:63], a[40:43], v[152:155]
    buffer_load_dwordx4 v[68:71], v16, s[4:7], s26 offen offset:0 sc1
    buffer_load_dwordx4 v[72:75], v16, s[4:7], s26 offen offset:256 sc1
    v_mfma_f32_16x16x32_bf16 v[156:159], v[60:63], a[44:47], v[156:159]
    ds_read_b128 v[60:63], v2 offset:36864
    v_mfma_f32_16x16x32_bf16 v[160:163], v[64:67], a[40:43], v[160:163]
    v_mfma_f32_16x16x32_bf16 v[164:167], v[64:67], a[44:47], v[164:167]
    ds_read_b128 v[64:67], v2 offset:37888
    s_waitcnt lgkmcnt(3)
    v_mfma_f32_16x16x32_bf16 v[104:107], v[44:47], a[48:51], v[104:107]
    s_add_u32 s54, s21, 114688
    s_add_u32 m0, s73, 16384
    s_nop 0
    buffer_load_dwordx4 v0, s[4:7], s54 offen offset:0 sc1 lds
    v_mfma_f32_16x16x32_bf16 v[108:111], v[44:47], a[52:55], v[108:111]
    ds_read_b128 v[44:47], v2 offset:38912
    buffer_load_dwordx4 a[76:79], v14, s[4:7], s52 offen offset:1024 sc1
    v_mfma_f32_16x16x32_bf16 v[112:115], v[48:51], a[48:51], v[112:115]
    v_mfma_f32_16x16x32_bf16 v[116:119], v[48:51], a[52:55], v[116:119]
    ds_read_b128 v[48:51], v2 offset:39936
    v_mfma_f32_16x16x32_bf16 v[120:123], v[52:55], a[48:51], v[120:123]
    v_mfma_f32_16x16x32_bf16 v[124:127], v[52:55], a[52:55], v[124:127]
    ds_read_b128 v[52:55], v2 offset:40960
    s_waitcnt lgkmcnt(3)
    v_mfma_f32_16x16x32_bf16 v[128:131], v[56:59], a[48:51], v[128:131]
    v_mfma_f32_16x16x32_bf16 v[132:135], v[56:59], a[52:55], v[132:135]
    ds_read_b128 v[56:59], v2 offset:41984
    v_mfma_f32_16x16x32_bf16 v[136:139], v[60:63], a[48:51], v[136:139]
    buffer_load_dwordx4 v0, s[4:7], s54 offen offset:1024 sc1 lds
    v_mfma_f32_16x16x32_bf16 v[140:143], v[60:63], a[52:55], v[140:143]
    ds_read_b128 v[60:63], v2 offset:43008
    buffer_load_dwordx4 a[80:83], v0, s[4:7], s52 offen offset:2048 sc1
    v_mfma_f32_16x16x32_bf16 v[144:147], v[64:67], a[48:51], v[144:147]
    v_mfma_f32_16x16x32_bf16 v[148:151], v[64:67], a[52:55], v[148:151]
    ds_read_b128 v[64:67], v2 offset:44032
    s_waitcnt lgkmcnt(3)
    v_mfma_f32_16x16x32_bf16 v[152:155], v[44:47], a[48:51], v[152:155]
    v_mfma_f32_16x16x32_bf16 v[156:159], v[44:47], a[52:55], v[156:159]
    ds_read_b128 v[44:47], v2 offset:45056
    v_mfma_f32_16x16x32_bf16 v[160:163], v[48:51], a[48:51], v[160:163]
    v_mfma_f32_16x16x32_bf16 v[164:167], v[48:51], a[52:55], v[164:167]
    ds_read_b128 v[48:51], v2 offset:46080
    s_waitcnt vmcnt(12)
    v_mfma_f32_16x16x32_bf16 v[104:107], v[52:55], a[56:59], v[104:107]
    buffer_load_dwordx4 v0, s[4:7], s54 offen offset:2048 sc1 lds
    v_mfma_f32_16x16x32_bf16 v[108:111], v[52:55], a[60:63], v[108:111]
    ds_read_b128 v[52:55], v2 offset:47104
    buffer_load_dwordx4 a[84:87], v14, s[4:7], s52 offen offset:2048 sc1
    s_waitcnt lgkmcnt(3)
    v_mfma_f32_16x16x32_bf16 v[112:115], v[56:59], a[56:59], v[112:115]
    v_mfma_f32_16x16x32_bf16 v[116:119], v[56:59], a[60:63], v[116:119]
    ds_read_b128 v[56:59], v2 offset:48128
    v_mfma_f32_16x16x32_bf16 v[120:123], v[60:63], a[56:59], v[120:123]
    v_mfma_f32_16x16x32_bf16 v[124:127], v[60:63], a[60:63], v[124:127]
    s_barrier
    ds_read_b128 v[60:63], v2 offset:49152
    v_mfma_f32_16x16x32_bf16 v[128:131], v[64:67], a[56:59], v[128:131]
    v_mfma_f32_16x16x32_bf16 v[132:135], v[64:67], a[60:63], v[132:135]
    ds_read_b128 v[64:67], v2 offset:50176
    s_waitcnt lgkmcnt(3)
    v_mfma_f32_16x16x32_bf16 v[136:139], v[44:47], a[56:59], v[136:139]
    buffer_load_dwordx4 v0, s[4:7], s54 offen offset:3072 sc1 lds
    buffer_load_dwordx4 a[88:91], v0, s[4:7], s52 offen offset:3072 sc1
    v_mfma_f32_16x16x32_bf16 v[140:143], v[44:47], a[60:63], v[140:143]
    ds_read_b128 v[44:47], v2 offset:51200
    s_waitcnt vmcnt(8)
    v_mfma_f32_16x16x32_bf16 v[144:147], v[48:51], a[56:59], v[144:147]
    v_pk_add_f32 v[68:69], v[68:69], v[70:71]
    v_mfma_f32_16x16x32_bf16 v[148:151], v[48:51], a[60:63], v[148:151]
    ds_read_b128 v[48:51], v2 offset:52224
    v_mfma_f32_16x16x32_bf16 v[152:155], v[52:55], a[56:59], v[152:155]
    v_pk_add_f32 v[72:73], v[72:73], v[74:75]
    v_mfma_f32_16x16x32_bf16 v[156:159], v[52:55], a[60:63], v[156:159]
    ds_read_b128 v[52:55], v2 offset:53248
    s_waitcnt lgkmcnt(3)
    v_mfma_f32_16x16x32_bf16 v[160:163], v[56:59], a[56:59], v[160:163]
    buffer_load_dwordx4 a[92:95], v14, s[4:7], s52 offen offset:3072 sc1
    v_mfma_f32_16x16x32_bf16 v[164:167], v[56:59], a[60:63], v[164:167]
    ds_read_b128 v[56:59], v2 offset:54272
    v_mov_b32 v70, v68
    v_mfma_f32_16x16x32_bf16 v[104:107], v[60:63], a[64:67], v[104:107]
    s_add_u32 s54, s21, 131072
    s_add_u32 m0, s73, 32768
    s_nop 0
    buffer_load_dwordx4 v0, s[4:7], s54 offen offset:0 sc1 lds
    v_mfma_f32_16x16x32_bf16 v[108:111], v[60:63], a[68:71], v[108:111]
    ds_read_b128 v[60:63], v2 offset:55296
    v_mov_b32 v71, v69
    v_mfma_f32_16x16x32_bf16 v[112:115], v[64:67], a[64:67], v[112:115]
    v_mov_b32 v74, v72
    v_mfma_f32_16x16x32_bf16 v[116:119], v[64:67], a[68:71], v[116:119]
    ds_read_b128 v[64:67], v2 offset:56320
    s_waitcnt lgkmcnt(3)
    v_mfma_f32_16x16x32_bf16 v[120:123], v[44:47], a[64:67], v[120:123]
    v_mov_b32 v75, v73
    v_mfma_f32_16x16x32_bf16 v[124:127], v[44:47], a[68:71], v[124:127]
    ds_read_b128 v[44:47], v2 offset:57344
    v_mfma_f32_16x16x32_bf16 v[128:131], v[48:51], a[64:67], v[128:131]
    s_add_u32 s52, s24, 12288
    buffer_load_dwordx4 a[96:99], v0, s[4:7], s52 offen offset:0 sc1
    v_mfma_f32_16x16x32_bf16 v[132:135], v[48:51], a[68:71], v[132:135]
    ds_read_b128 v[48:51], v2 offset:58368
    v_permlane16_swap_b32 v68, v70
    v_mfma_f32_16x16x32_bf16 v[136:139], v[52:55], a[64:67], v[136:139]
    buffer_load_dwordx4 v0, s[4:7], s54 offen offset:1024 sc1 lds
    v_mfma_f32_16x16x32_bf16 v[140:143], v[52:55], a[68:71], v[140:143]
    ds_read_b128 v[52:55], v2 offset:59392
    v_permlane16_swap_b32 v69, v71
    s_waitcnt lgkmcnt(3)
    v_mfma_f32_16x16x32_bf16 v[144:147], v[56:59], a[64:67], v[144:147]
    v_permlane16_swap_b32 v72, v74
    v_mfma_f32_16x16x32_bf16 v[148:151], v[56:59], a[68:71], v[148:151]
    ds_read_b128 v[56:59], v2 offset:60416
    v_mfma_f32_16x16x32_bf16 v[152:155], v[60:63], a[64:67], v[152:155]
    v_permlane16_swap_b32 v73, v75
    v_mfma_f32_16x16x32_bf16 v[156:159], v[60:63], a[68:71], v[156:159]
    ds_read_b128 v[60:63], v2 offset:61440
    v_mfma_f32_16x16x32_bf16 v[160:163], v[64:67], a[64:67], v[160:163]
    buffer_load_dwordx4 a[100:103], v14, s[4:7], s52 offen offset:0 sc1
    v_mfma_f32_16x16x32_bf16 v[164:167], v[64:67], a[68:71], v[164:167]
    ds_read_b128 v[64:67], v2 offset:62464
    v_add_f32 v68, v68, v70
    s_waitcnt vmcnt(11) lgkmcnt(3)
    v_mfma_f32_16x16x32_bf16 v[104:107], v[44:47], a[72:75], v[104:107]
    buffer_load_dwordx4 v0, s[4:7], s54 offen offset:2048 sc1 lds
    v_mfma_f32_16x16x32_bf16 v[108:111], v[44:47], a[76:79], v[108:111]
    ds_read_b128 v[44:47], v2 offset:63488
    v_add_f32 v69, v69, v71
    v_mfma_f32_16x16x32_bf16 v[112:115], v[48:51], a[72:75], v[112:115]
    v_add_f32 v72, v72, v74
    v_mfma_f32_16x16x32_bf16 v[116:119], v[48:51], a[76:79], v[116:119]
    ds_read_b128 v[48:51], v2 offset:64512
    v_mfma_f32_16x16x32_bf16 v[120:123], v[52:55], a[72:75], v[120:123]
    v_add_f32 v73, v73, v75
    v_mfma_f32_16x16x32_bf16 v[124:127], v[52:55], a[76:79], v[124:127]
    ds_read_b128 v[52:55], v3 offset:0
    s_waitcnt lgkmcnt(3)
    v_mfma_f32_16x16x32_bf16 v[128:131], v[56:59], a[72:75], v[128:131]
    buffer_load_dwordx4 a[104:107], v0, s[4:7], s52 offen offset:1024 sc1
    v_mfma_f32_16x16x32_bf16 v[132:135], v[56:59], a[76:79], v[132:135]
    ds_read_b128 v[56:59], v3 offset:1024
    v_mov_b32 v70, v68
    v_mfma_f32_16x16x32_bf16 v[136:139], v[60:63], a[72:75], v[136:139]
    buffer_load_dwordx4 v0, s[4:7], s54 offen offset:3072 sc1 lds
    v_mfma_f32_16x16x32_bf16 v[140:143], v[60:63], a[76:79], v[140:143]
    ds_read_b128 v[60:63], v3 offset:2048
    v_mov_b32 v71, v69
    v_mfma_f32_16x16x32_bf16 v[144:147], v[64:67], a[72:75], v[144:147]
    v_mov_b32 v74, v72
    v_mfma_f32_16x16x32_bf16 v[148:151], v[64:67], a[76:79], v[148:151]
    ds_read_b128 v[64:67], v3 offset:3072
    s_waitcnt lgkmcnt(3)
    v_mfma_f32_16x16x32_bf16 v[152:155], v[44:47], a[72:75], v[152:155]
    v_mov_b32 v75, v73
    v_mfma_f32_16x16x32_bf16 v[156:159], v[44:47], a[76:79], v[156:159]
    ds_read_b128 v[44:47], v3 offset:4096
    v_mfma_f32_16x16x32_bf16 v[160:163], v[48:51], a[72:75], v[160:163]
    buffer_load_dwordx4 a[108:111], v14, s[4:7], s52 offen offset:1024 sc1
    v_mfma_f32_16x16x32_bf16 v[164:167], v[48:51], a[76:79], v[164:167]
    ds_read_b128 v[48:51], v3 offset:5120
    v_permlane32_swap_b32 v68, v70
    s_waitcnt vmcnt(11)
    v_mfma_f32_16x16x32_bf16 v[104:107], v[52:55], a[80:83], v[104:107]
    s_add_u32 s54, s21, 147456
    s_add_u32 m0, s73, 49152
    s_nop 0
    buffer_load_dwordx4 v0, s[4:7], s54 offen offset:0 sc1 lds
    v_mfma_f32_16x16x32_bf16 v[108:111], v[52:55], a[84:87], v[108:111]
    ds_read_b128 v[52:55], v3 offset:6144
    v_permlane32_swap_b32 v69, v71
    s_waitcnt lgkmcnt(3)
    v_mfma_f32_16x16x32_bf16 v[112:115], v[56:59], a[80:83], v[112:115]
    v_permlane32_swap_b32 v72, v74
    v_mfma_f32_16x16x32_bf16 v[116:119], v[56:59], a[84:87], v[116:119]
    ds_read_b128 v[56:59], v3 offset:7168
    v_mfma_f32_16x16x32_bf16 v[120:123], v[60:63], a[80:83], v[120:123]
    buffer_load_dwordx4 a[112:115], v0, s[4:7], s52 offen offset:2048 sc1
    v_mfma_f32_16x16x32_bf16 v[124:127], v[60:63], a[84:87], v[124:127]
    ds_read_b128 v[60:63], v3 offset:8192
    v_permlane32_swap_b32 v73, v75
    v_mfma_f32_16x16x32_bf16 v[128:131], v[64:67], a[80:83], v[128:131]
    v_add_f32 v68, v68, v70
    v_mfma_f32_16x16x32_bf16 v[132:135], v[64:67], a[84:87], v[132:135]
    ds_read_b128 v[64:67], v3 offset:9216
    s_waitcnt lgkmcnt(3)
    v_mfma_f32_16x16x32_bf16 v[136:139], v[44:47], a[80:83], v[136:139]
    buffer_load_dwordx4 v0, s[4:7], s54 offen offset:1024 sc1 lds
    v_mfma_f32_16x16x32_bf16 v[140:143], v[44:47], a[84:87], v[140:143]
    ds_read_b128 v[44:47], v3 offset:10240
    v_add_f32 v69, v69, v71
    v_mfma_f32_16x16x32_bf16 v[144:147], v[48:51], a[80:83], v[144:147]
    v_add_f32 v72, v72, v74
    v_mfma_f32_16x16x32_bf16 v[148:151], v[48:51], a[84:87], v[148:151]
    ds_read_b128 v[48:51], v3 offset:11264
    v_mfma_f32_16x16x32_bf16 v[152:155], v[52:55], a[80:83], v[152:155]
    buffer_load_dwordx4 a[116:119], v14, s[4:7], s52 offen offset:2048 sc1
    v_mfma_f32_16x16x32_bf16 v[156:159], v[52:55], a[84:87], v[156:159]
    ds_read_b128 v[52:55], v3 offset:12288
    v_add_f32 v73, v73, v75
    s_waitcnt lgkmcnt(3)
    v_mfma_f32_16x16x32_bf16 v[160:163], v[56:59], a[80:83], v[160:163]
    v_mul_f32 v71, 0x3acccccd, v69
    v_mfma_f32_16x16x32_bf16 v[164:167], v[56:59], a[84:87], v[164:167]
    ds_read_b128 v[56:59], v3 offset:13312
    s_waitcnt vmcnt(12)
    v_mfma_f32_16x16x32_bf16 v[104:107], v[60:63], a[88:91], v[104:107]
    buffer_load_dwordx4 v0, s[4:7], s54 offen offset:2048 sc1 lds
    v_mfma_f32_16x16x32_bf16 v[108:111], v[60:63], a[92:95], v[108:111]
    ds_read_b128 v[60:63], v3 offset:14336
    v_mul_f32 v69, 0xbacccccd, v68
    v_mfma_f32_16x16x32_bf16 v[112:115], v[64:67], a[88:91], v[112:115]
    v_mul_f32 v75, 0x3acccccd, v73
    v_mfma_f32_16x16x32_bf16 v[116:119], v[64:67], a[92:95], v[116:119]
    ds_read_b128 v[64:67], v3 offset:15360
    s_waitcnt lgkmcnt(3)
    v_mfma_f32_16x16x32_bf16 v[120:123], v[44:47], a[88:91], v[120:123]
    buffer_load_dwordx4 a[120:123], v0, s[4:7], s52 offen offset:3072 sc1
    v_mfma_f32_16x16x32_bf16 v[124:127], v[44:47], a[92:95], v[124:127]
    ds_read_b128 v[44:47], v0 offset:0
    v_mul_f32 v73, 0xbacccccd, v72
    v_mfma_f32_16x16x32_bf16 v[128:131], v[48:51], a[88:91], v[128:131]
    v_fma_f32 v71, -v69, v69, v71
    v_mfma_f32_16x16x32_bf16 v[132:135], v[48:51], a[92:95], v[132:135]
    s_barrier
    ds_read_b128 v[48:51], v0 offset:1024
    v_mfma_f32_16x16x32_bf16 v[136:139], v[52:55], a[88:91], v[136:139]
    buffer_load_dwordx4 v0, s[4:7], s54 offen offset:3072 sc1 lds
    v_mfma_f32_16x16x32_bf16 v[140:143], v[52:55], a[92:95], v[140:143]
    ds_read_b128 v[52:55], v0 offset:2048
    v_fma_f32 v75, -v73, v73, v75
    s_waitcnt lgkmcnt(3)
    v_mfma_f32_16x16x32_bf16 v[144:147], v[56:59], a[88:91], v[144:147]
    v_max_f32 v71, 0, v71
    v_mfma_f32_16x16x32_bf16 v[148:151], v[56:59], a[92:95], v[148:151]
    ds_read_b128 v[56:59], v0 offset:3072
    v_mfma_f32_16x16x32_bf16 v[152:155], v[60:63], a[88:91], v[152:155]
    buffer_load_dwordx4 a[124:127], v14, s[4:7], s52 offen offset:3072 sc1
    v_mfma_f32_16x16x32_bf16 v[156:159], v[60:63], a[92:95], v[156:159]
    ds_read_b128 v[60:63], v0 offset:4096
    v_max_f32 v75, 0, v75
    v_mfma_f32_16x16x32_bf16 v[160:163], v[64:67], a[88:91], v[160:163]
    v_add_f32 v71, 0x3727c5ac, v71
    v_mfma_f32_16x16x32_bf16 v[164:167], v[64:67], a[92:95], v[164:167]
    ds_read_b128 v[64:67], v0 offset:5120
    s_waitcnt vmcnt(12) lgkmcnt(3)
    v_mfma_f32_16x16x32_bf16 v[104:107], v[44:47], a[96:99], v[104:107]
    s_add_u32 s54, s21, 163840
    s_add_u32 m0, s73, 65536
    s_nop 0
    buffer_load_dwordx4 v0, s[4:7], s54 offen offset:0 sc1 lds
    s_cmp_lg_u32 s17, 0
    s_cbranch_scc1 interleave_layers__linear_attn_block__geglu_ffn__prompt_kernel_k460
    s_add_u32 s53, s23, 20480
    buffer_load_dwordx4 v[244:247], v0, s[4:7], s53 offen offset:0 sc1
interleave_layers__linear_attn_block__geglu_ffn__prompt_kernel_k460:
    v_mfma_f32_16x16x32_bf16 v[108:111], v[44:47], a[100:103], v[108:111]
    ds_read_b128 v[44:47], v0 offset:6144
    v_add_f32 v75, 0x3727c5ac, v75
    v_mfma_f32_16x16x32_bf16 v[112:115], v[48:51], a[96:99], v[112:115]
    v_rsq_f32 v68, v71
    v_mfma_f32_16x16x32_bf16 v[116:119], v[48:51], a[100:103], v[116:119]
    ds_read_b128 v[48:51], v0 offset:7168
    v_mfma_f32_16x16x32_bf16 v[120:123], v[52:55], a[96:99], v[120:123]
    s_add_u32 s52, s24, 16384
    buffer_load_dwordx4 a[128:131], v0, s[4:7], s52 offen offset:0 sc1
    v_mfma_f32_16x16x32_bf16 v[124:127], v[52:55], a[100:103], v[124:127]
    ds_read_b128 v[52:55], v0 offset:8192
    v_rsq_f32 v72, v75
    s_waitcnt lgkmcnt(3)
    v_mfma_f32_16x16x32_bf16 v[128:131], v[56:59], a[96:99], v[128:131]
    v_mov_b32 v70, v71
    v_mfma_f32_16x16x32_bf16 v[132:135], v[56:59], a[100:103], v[132:135]
    ds_read_b128 v[56:59], v0 offset:9216
    v_mfma_f32_16x16x32_bf16 v[136:139], v[60:63], a[96:99], v[136:139]
    buffer_load_dwordx4 v0, s[4:7], s54 offen offset:1024 sc1 lds
    v_mfma_f32_16x16x32_bf16 v[140:143], v[60:63], a[100:103], v[140:143]
    ds_read_b128 v[60:63], v0 offset:10240
    v_mul_f32 v71, 0xc0135761, v68
    v_mfma_f32_16x16x32_bf16 v[144:147], v[64:67], a[96:99], v[144:147]
    buffer_load_dwordx4 a[132:135], v14, s[4:7], s52 offen offset:0 sc1
    v_mfma_f32_16x16x32_bf16 v[148:151], v[64:67], a[100:103], v[148:151]
    ds_read_b128 v[64:67], v0 offset:11264
    v_mov_b32 v74, v75
    s_waitcnt lgkmcnt(3)
    v_mfma_f32_16x16x32_bf16 v[152:155], v[44:47], a[96:99], v[152:155]
    v_mul_f32 v75, 0xc0135761, v72
    v_mfma_f32_16x16x32_bf16 v[156:159], v[44:47], a[100:103], v[156:159]
    ds_read_b128 v[44:47], v0 offset:12288
    v_mfma_f32_16x16x32_bf16 v[160:163], v[48:51], a[96:99], v[160:163]
    v_mul_f32 v68, v68, v68
    v_mfma_f32_16x16x32_bf16 v[164:167], v[48:51], a[100:103], v[164:167]
    ds_read_b128 v[48:51], v0 offset:13312
    s_waitcnt vmcnt(12)
    v_mfma_f32_16x16x32_bf16 v[104:107], v[52:55], a[104:107], v[104:107]
    buffer_load_dwordx4 v0, s[4:7], s54 offen offset:2048 sc1 lds
    v_mfma_f32_16x16x32_bf16 v[108:111], v[52:55], a[108:111], v[108:111]
    ds_read_b128 v[52:55], v0 offset:14336
    v_mul_f32 v72, v72, v72
    s_waitcnt lgkmcnt(3)
    v_mfma_f32_16x16x32_bf16 v[112:115], v[56:59], a[104:107], v[112:115]
    buffer_load_dwordx4 a[136:139], v0, s[4:7], s52 offen offset:1024 sc1
    v_mfma_f32_16x16x32_bf16 v[116:119], v[56:59], a[108:111], v[116:119]
    ds_read_b128 v[56:59], v0 offset:15360
    v_mul_f32 v68, v68, v71
    v_mfma_f32_16x16x32_bf16 v[120:123], v[60:63], a[104:107], v[120:123]
    v_mul_f32 v72, v72, v75
    v_mfma_f32_16x16x32_bf16 v[124:127], v[60:63], a[108:111], v[124:127]
    ds_read_b128 v[60:63], v0 offset:16384
    v_mfma_f32_16x16x32_bf16 v[128:131], v[64:67], a[104:107], v[128:131]
    v_mul_f32 v68, 0x3d372713, v68
    v_mfma_f32_16x16x32_bf16 v[132:135], v[64:67], a[108:111], v[132:135]
    ds_read_b128 v[64:67], v0 offset:17408
    s_waitcnt lgkmcnt(3)
    v_mfma_f32_16x16x32_bf16 v[136:139], v[44:47], a[104:107], v[136:139]
    buffer_load_dwordx4 v0, s[4:7], s54 offen offset:3072 sc1 lds
    v_mfma_f32_16x16x32_bf16 v[140:143], v[44:47], a[108:111], v[140:143]
    ds_read_b128 v[44:47], v0 offset:18432
    v_mul_f32 v72, 0x3d372713, v72
    v_mfma_f32_16x16x32_bf16 v[144:147], v[48:51], a[104:107], v[144:147]
    buffer_load_dwordx4 a[140:143], v14, s[4:7], s52 offen offset:1024 sc1
    v_mfma_f32_16x16x32_bf16 v[148:151], v[48:51], a[108:111], v[148:151]
    ds_read_b128 v[48:51], v0 offset:19456
    v_mfma_f32_16x16x32_bf16 v[152:155], v[52:55], a[104:107], v[152:155]
    v_mfma_f32_16x16x32_bf16 v[156:159], v[52:55], a[108:111], v[156:159]
    ds_read_b128 v[52:55], v0 offset:20480
    s_waitcnt lgkmcnt(3)
    v_mfma_f32_16x16x32_bf16 v[160:163], v[56:59], a[104:107], v[160:163]
    v_mfma_f32_16x16x32_bf16 v[164:167], v[56:59], a[108:111], v[164:167]
    ds_read_b128 v[56:59], v0 offset:21504
    s_waitcnt vmcnt(12)
    v_mfma_f32_16x16x32_bf16 v[104:107], v[60:63], a[112:115], v[104:107]
    s_add_u32 s54, s21, 180224
    s_add_u32 m0, s73, 81920
    s_nop 0
    buffer_load_dwordx4 v0, s[4:7], s54 offen offset:0 sc1 lds
    v_mfma_f32_16x16x32_bf16 v[108:111], v[60:63], a[116:119], v[108:111]
    ds_read_b128 v[60:63], v0 offset:22528
    v_mfma_f32_16x16x32_bf16 v[112:115], v[64:67], a[112:115], v[112:115]
    buffer_load_dwordx4 a[144:147], v0, s[4:7], s52 offen offset:2048 sc1
    v_mfma_f32_16x16x32_bf16 v[116:119], v[64:67], a[116:119], v[116:119]
    ds_read_b128 v[64:67], v0 offset:23552
    s_waitcnt lgkmcnt(3)
    v_mfma_f32_16x16x32_bf16 v[120:123], v[44:47], a[112:115], v[120:123]
    v_mfma_f32_16x16x32_bf16 v[124:127], v[44:47], a[116:119], v[124:127]
    ds_read_b128 v[44:47], v0 offset:24576
    v_mfma_f32_16x16x32_bf16 v[128:131], v[48:51], a[112:115], v[128:131]
    v_mfma_f32_16x16x32_bf16 v[132:135], v[48:51], a[116:119], v[132:135]
    ds_read_b128 v[48:51], v0 offset:25600
    v_mfma_f32_16x16x32_bf16 v[136:139], v[52:55], a[112:115], v[136:139]
    buffer_load_dwordx4 v0, s[4:7], s54 offen offset:1024 sc1 lds
    v_mfma_f32_16x16x32_bf16 v[140:143], v[52:55], a[116:119], v[140:143]
    ds_read_b128 v[52:55], v0 offset:26624
    s_waitcnt lgkmcnt(3)
    v_mfma_f32_16x16x32_bf16 v[144:147], v[56:59], a[112:115], v[144:147]
    buffer_load_dwordx4 a[148:151], v14, s[4:7], s52 offen offset:2048 sc1
    v_mfma_f32_16x16x32_bf16 v[148:151], v[56:59], a[116:119], v[148:151]
    ds_read_b128 v[56:59], v0 offset:27648
    v_mfma_f32_16x16x32_bf16 v[152:155], v[60:63], a[112:115], v[152:155]
    v_mfma_f32_16x16x32_bf16 v[156:159], v[60:63], a[116:119], v[156:159]
    ds_read_b128 v[60:63], v0 offset:28672
    v_mfma_f32_16x16x32_bf16 v[160:163], v[64:67], a[112:115], v[160:163]
    v_mfma_f32_16x16x32_bf16 v[164:167], v[64:67], a[116:119], v[164:167]
    ds_read_b128 v[64:67], v0 offset:29696
    s_waitcnt vmcnt(12) lgkmcnt(3)
    v_mfma_f32_16x16x32_bf16 v[104:107], v[44:47], a[120:123], v[104:107]
    buffer_load_dwordx4 v0, s[4:7], s54 offen offset:2048 sc1 lds
    v_mfma_f32_16x16x32_bf16 v[108:111], v[44:47], a[124:127], v[108:111]
    ds_read_b128 v[44:47], v0 offset:30720
    buffer_load_dwordx4 a[152:155], v0, s[4:7], s52 offen offset:3072 sc1
    v_mfma_f32_16x16x32_bf16 v[112:115], v[48:51], a[120:123], v[112:115]
    v_mfma_f32_16x16x32_bf16 v[116:119], v[48:51], a[124:127], v[116:119]
    ds_read_b128 v[48:51], v0 offset:31744
    v_mfma_f32_16x16x32_bf16 v[120:123], v[52:55], a[120:123], v[120:123]
    v_mfma_f32_16x16x32_bf16 v[124:127], v[52:55], a[124:127], v[124:127]
    s_barrier
    ds_read_b128 v[52:55], v0 offset:32768
    s_waitcnt lgkmcnt(3)
    v_mfma_f32_16x16x32_bf16 v[128:131], v[56:59], a[120:123], v[128:131]
    v_mfma_f32_16x16x32_bf16 v[132:135], v[56:59], a[124:127], v[132:135]
    ds_read_b128 v[56:59], v0 offset:33792
    v_mfma_f32_16x16x32_bf16 v[136:139], v[60:63], a[120:123], v[136:139]
    buffer_load_dwordx4 v0, s[4:7], s54 offen offset:3072 sc1 lds
    v_mfma_f32_16x16x32_bf16 v[140:143], v[60:63], a[124:127], v[140:143]
    ds_read_b128 v[60:63], v0 offset:34816
    buffer_load_dwordx4 a[156:159], v14, s[4:7], s52 offen offset:3072 sc1
    v_mfma_f32_16x16x32_bf16 v[144:147], v[64:67], a[120:123], v[144:147]
    v_mfma_f32_16x16x32_bf16 v[148:151], v[64:67], a[124:127], v[148:151]
    ds_read_b128 v[64:67], v0 offset:35840
    s_waitcnt lgkmcnt(3)
    v_mfma_f32_16x16x32_bf16 v[152:155], v[44:47], a[120:123], v[152:155]
    v_mfma_f32_16x16x32_bf16 v[156:159], v[44:47], a[124:127], v[156:159]
    ds_read_b128 v[44:47], v0 offset:36864
    v_mfma_f32_16x16x32_bf16 v[160:163], v[48:51], a[120:123], v[160:163]
    v_mfma_f32_16x16x32_bf16 v[164:167], v[48:51], a[124:127], v[164:167]
    ds_read_b128 v[48:51], v0 offset:37888
    s_waitcnt vmcnt(12)
    v_mfma_f32_16x16x32_bf16 v[104:107], v[52:55], a[128:131], v[104:107]
    s_add_u32 s54, s21, 196608
    s_add_u32 m0, s73, 98304
    s_nop 0
    buffer_load_dwordx4 v0, s[4:7], s54 offen offset:0 sc1 lds
    v_mfma_f32_16x16x32_bf16 v[108:111], v[52:55], a[132:135], v[108:111]
    ds_read_b128 v[52:55], v0 offset:38912
    s_waitcnt lgkmcnt(3)
    v_mfma_f32_16x16x32_bf16 v[112:115], v[56:59], a[128:131], v[112:115]
    v_mfma_f32_16x16x32_bf16 v[116:119], v[56:59], a[132:135], v[116:119]
    ds_read_b128 v[56:59], v0 offset:39936
    v_mfma_f32_16x16x32_bf16 v[120:123], v[60:63], a[128:131], v[120:123]
    v_mfma_f32_16x16x32_bf16 v[124:127], v[60:63], a[132:135], v[124:127]
    ds_read_b128 v[60:63], v0 offset:40960
    v_mfma_f32_16x16x32_bf16 v[128:131], v[64:67], a[128:131], v[128:131]
    v_mfma_f32_16x16x32_bf16 v[132:135], v[64:67], a[132:135], v[132:135]
    ds_read_b128 v[64:67], v0 offset:41984
    s_waitcnt lgkmcnt(3)
    v_mfma_f32_16x16x32_bf16 v[136:139], v[44:47], a[128:131], v[136:139]
    buffer_load_dwordx4 v0, s[4:7], s54 offen offset:1024 sc1 lds
    v_mfma_f32_16x16x32_bf16 v[140:143], v[44:47], a[132:135], v[140:143]
    ds_read_b128 v[44:47], v0 offset:43008
    v_mfma_f32_16x16x32_bf16 v[144:147], v[48:51], a[128:131], v[144:147]
    v_mfma_f32_16x16x32_bf16 v[148:151], v[48:51], a[132:135], v[148:151]
    ds_read_b128 v[48:51], v0 offset:44032
    v_mfma_f32_16x16x32_bf16 v[152:155], v[52:55], a[128:131], v[152:155]
    v_mfma_f32_16x16x32_bf16 v[156:159], v[52:55], a[132:135], v[156:159]
    ds_read_b128 v[52:55], v0 offset:45056
    s_waitcnt lgkmcnt(3)
    v_mfma_f32_16x16x32_bf16 v[160:163], v[56:59], a[128:131], v[160:163]
    v_mfma_f32_16x16x32_bf16 v[164:167], v[56:59], a[132:135], v[164:167]
    ds_read_b128 v[56:59], v0 offset:46080
    s_waitcnt vmcnt(10)
    v_mfma_f32_16x16x32_bf16 v[104:107], v[60:63], a[136:139], v[104:107]
    buffer_load_dwordx4 v0, s[4:7], s54 offen offset:2048 sc1 lds
    v_mfma_f32_16x16x32_bf16 v[108:111], v[60:63], a[140:143], v[108:111]
    ds_read_b128 v[60:63], v0 offset:47104
    v_mfma_f32_16x16x32_bf16 v[112:115], v[64:67], a[136:139], v[112:115]
    v_mfma_f32_16x16x32_bf16 v[116:119], v[64:67], a[140:143], v[116:119]
    ds_read_b128 v[64:67], v0 offset:48128
    s_waitcnt lgkmcnt(3)
    v_mfma_f32_16x16x32_bf16 v[120:123], v[44:47], a[136:139], v[120:123]
    v_mfma_f32_16x16x32_bf16 v[124:127], v[44:47], a[140:143], v[124:127]
    ds_read_b128 v[44:47], v0 offset:49152
    v_mfma_f32_16x16x32_bf16 v[128:131], v[48:51], a[136:139], v[128:131]
    v_mfma_f32_16x16x32_bf16 v[132:135], v[48:51], a[140:143], v[132:135]
    ds_read_b128 v[48:51], v0 offset:50176
    v_mfma_f32_16x16x32_bf16 v[136:139], v[52:55], a[136:139], v[136:139]
    buffer_load_dwordx4 v0, s[4:7], s54 offen offset:3072 sc1 lds
    v_mfma_f32_16x16x32_bf16 v[140:143], v[52:55], a[140:143], v[140:143]
    ds_read_b128 v[52:55], v0 offset:51200
    ds_read_b128 v[76:79], v28 offset:512
    s_waitcnt lgkmcnt(4)
    v_mfma_f32_16x16x32_bf16 v[144:147], v[56:59], a[136:139], v[144:147]
    ds_read_b128 v[80:83], v28 offset:576
    v_mfma_f32_16x16x32_bf16 v[148:151], v[56:59], a[140:143], v[148:151]
    ds_read_b128 v[56:59], v0 offset:52224
    v_mfma_f32_16x16x32_bf16 v[152:155], v[60:63], a[136:139], v[152:155]
    ds_read_b128 v[84:87], v28 offset:640
    v_mfma_f32_16x16x32_bf16 v[156:159], v[60:63], a[140:143], v[156:159]
    ds_read_b128 v[60:63], v0 offset:53248
    v_mfma_f32_16x16x32_bf16 v[160:163], v[64:67], a[136:139], v[160:163]
    ds_read_b128 v[88:91], v28 offset:704
    v_mfma_f32_16x16x32_bf16 v[164:167], v[64:67], a[140:143], v[164:167]
    ds_read_b128 v[64:67], v0 offset:54272
    s_waitcnt vmcnt(8) lgkmcnt(7)
    v_mfma_f32_16x16x32_bf16 v[104:107], v[44:47], a[144:147], v[104:107]
    s_add_u32 s54, s21, 212992
    s_add_u32 m0, s73, 114688
    s_nop 0
    buffer_load_dwordx4 v0, s[4:7], s54 offen offset:0 sc1 lds
    v_mfma_f32_16x16x32_bf16 v[108:111], v[44:47], a[148:151], v[108:111]
    ds_read_b128 v[44:47], v0 offset:55296
    v_mfma_f32_16x16x32_bf16 v[112:115], v[48:51], a[144:147], v[112:115]
    v_mfma_f32_16x16x32_bf16 v[116:119], v[48:51], a[148:151], v[116:119]
    ds_read_b128 v[48:51], v0 offset:56320
    v_mfma_f32_16x16x32_bf16 v[120:123], v[52:55], a[144:147], v[120:123]
    v_mfma_f32_16x16x32_bf16 v[124:127], v[52:55], a[148:151], v[124:127]
    ds_read_b128 v[52:55], v0 offset:57344
    s_waitcnt lgkmcnt(3)
    v_mfma_f32_16x16x32_bf16 v[128:131], v[56:59], a[144:147], v[128:131]
    v_mfma_f32_16x16x32_bf16 v[132:135], v[56:59], a[148:151], v[132:135]
    ds_read_b128 v[56:59], v0 offset:58368
    v_mfma_f32_16x16x32_bf16 v[136:139], v[60:63], a[144:147], v[136:139]
    buffer_load_dwordx4 v0, s[4:7], s54 offen offset:1024 sc1 lds
    v_mfma_f32_16x16x32_bf16 v[140:143], v[60:63], a[148:151], v[140:143]
    ds_read_b128 v[60:63], v0 offset:59392
    v_mfma_f32_16x16x32_bf16 v[144:147], v[64:67], a[144:147], v[144:147]
    v_mfma_f32_16x16x32_bf16 v[148:151], v[64:67], a[148:151], v[148:151]
    ds_read_b128 v[64:67], v0 offset:60416
    s_waitcnt lgkmcnt(3)
    v_mfma_f32_16x16x32_bf16 v[152:155], v[44:47], a[144:147], v[152:155]
    v_mfma_f32_16x16x32_bf16 v[156:159], v[44:47], a[148:151], v[156:159]
    ds_read_b128 v[44:47], v0 offset:61440
    v_mfma_f32_16x16x32_bf16 v[160:163], v[48:51], a[144:147], v[160:163]
    v_mfma_f32_16x16x32_bf16 v[164:167], v[48:51], a[148:151], v[164:167]
    ds_read_b128 v[48:51], v0 offset:62464
    s_waitcnt vmcnt(6)
    v_mfma_f32_16x16x32_bf16 v[104:107], v[52:55], a[152:155], v[104:107]
    buffer_load_dwordx4 v0, s[4:7], s54 offen offset:2048 sc1 lds
    v_mfma_f32_16x16x32_bf16 v[108:111], v[52:55], a[156:159], v[108:111]
    ds_read_b128 v[52:55], v0 offset:63488
    s_waitcnt lgkmcnt(3)
    v_mfma_f32_16x16x32_bf16 v[112:115], v[56:59], a[152:155], v[112:115]
    v_mfma_f32_16x16x32_bf16 v[116:119], v[56:59], a[156:159], v[116:119]
    ds_read_b128 v[56:59], v0 offset:64512
    v_mfma_f32_16x16x32_bf16 v[120:123], v[60:63], a[152:155], v[120:123]
    v_mfma_f32_16x16x32_bf16 v[124:127], v[60:63], a[156:159], v[124:127]
    s_barrier
    ds_read_b128 v[60:63], v2 offset:0
    v_mfma_f32_16x16x32_bf16 v[128:131], v[64:67], a[152:155], v[128:131]
    v_mfma_f32_16x16x32_bf16 v[132:135], v[64:67], a[156:159], v[132:135]
    ds_read_b128 v[64:67], v2 offset:1024
    s_waitcnt lgkmcnt(3)
    v_mfma_f32_16x16x32_bf16 v[136:139], v[44:47], a[152:155], v[136:139]
    buffer_load_dwordx4 v0, s[4:7], s54 offen offset:3072 sc1 lds
    v_mfma_f32_16x16x32_bf16 v[140:143], v[44:47], a[156:159], v[140:143]
    ds_read_b128 v[44:47], v2 offset:2048
    v_mfma_f32_16x16x32_bf16 v[144:147], v[48:51], a[152:155], v[144:147]
    v_mfma_f32_16x16x32_bf16 v[148:151], v[48:51], a[156:159], v[148:151]
    ds_read_b128 v[48:51], v2 offset:3072
    v_mfma_f32_16x16x32_bf16 v[152:155], v[52:55], a[152:155], v[152:155]
    v_mfma_f32_16x16x32_bf16 v[156:159], v[52:55], a[156:159], v[156:159]
    ds_read_b128 v[52:55], v2 offset:4096
    s_waitcnt lgkmcnt(5)
    v_mfma_f32_16x16x32_bf16 v[160:163], v[56:59], a[152:155], v[160:163]
    v_mfma_f32_16x16x32_bf16 v[164:167], v[56:59], a[156:159], v[164:167]
    ds_read_b128 v[56:59], v2 offset:5120
    v_pk_fma_f32 v[104:105], v[76:77], v[68:69], v[104:105] op_sel:[0,1,0] op_sel_hi:[1,1,1]
    s_add_u32 s54, s21, 229376
    s_add_u32 m0, s73, 131072
    s_nop 0
    buffer_load_dwordx4 v0, s[4:7], s54 offen offset:0 sc1 lds
    v_pk_fma_f32 v[106:107], v[78:79], v[68:69], v[106:107] op_sel:[0,1,0] op_sel_hi:[1,1,1]
    v_pk_fma_f32 v[112:113], v[80:81], v[68:69], v[112:113] op_sel:[0,1,0] op_sel_hi:[1,1,1]
    v_pk_fma_f32 v[114:115], v[82:83], v[68:69], v[114:115] op_sel:[0,1,0] op_sel_hi:[1,1,1]
    v_pk_mul_f32 v[92:93], v[104:105], v[104:105]
    v_pk_mul_f32 v[94:95], v[106:107], v[106:107]
    v_pk_mul_f32 v[96:97], v[112:113], v[112:113]
    v_pk_mul_f32 v[98:99], v[114:115], v[114:115]
    v_pk_fma_f32 v[92:93], v[92:93], v[68:69], v[70:71] op_sel:[0,0,1] op_sel_hi:[1,0,1]
    v_pk_fma_f32 v[94:95], v[94:95], v[68:69], v[70:71] op_sel:[0,0,1] op_sel_hi:[1,0,1]
    v_pk_fma_f32 v[96:97], v[96:97], v[68:69], v[70:71] op_sel:[0,0,1] op_sel_hi:[1,0,1]
    v_pk_fma_f32 v[98:99], v[98:99], v[68:69], v[70:71] op_sel:[0,0,1] op_sel_hi:[1,0,1]
    v_pk_mul_f32 v[92:93], v[92:93], v[104:105]
    v_pk_mul_f32 v[94:95], v[94:95], v[106:107]
    v_pk_mul_f32 v[96:97], v[96:97], v[112:113]
    v_pk_mul_f32 v[98:99], v[98:99], v[114:115]
    v_exp_f32 v92, v92
    v_exp_f32 v93, v93
    v_pk_fma_f32 v[120:121], v[84:85], v[68:69], v[120:121] op_sel:[0,1,0] op_sel_hi:[1,1,1]
    buffer_load_dwordx4 v0, s[4:7], s54 offen offset:1024 sc1 lds
    v_exp_f32 v94, v94
    v_exp_f32 v95, v95
    v_pk_fma_f32 v[122:123], v[86:87], v[68:69], v[122:123] op_sel:[0,1,0] op_sel_hi:[1,1,1]
    v_exp_f32 v96, v96
    v_exp_f32 v97, v97
    v_pk_fma_f32 v[128:129], v[88:89], v[68:69], v[128:129] op_sel:[0,1,0] op_sel_hi:[1,1,1]
    v_exp_f32 v98, v98
    v_exp_f32 v99, v99
    v_pk_fma_f32 v[130:131], v[90:91], v[68:69], v[130:131] op_sel:[0,1,0] op_sel_hi:[1,1,1]
    v_pk_fma_f32 v[92:93], v[92:93], v[70:71], v[70:71] op_sel_hi:[1,0,0]
    v_pk_fma_f32 v[94:95], v[94:95], v[70:71], v[70:71] op_sel_hi:[1,0,0]
    v_pk_fma_f32 v[96:97], v[96:97], v[70:71], v[70:71] op_sel_hi:[1,0,0]
    v_pk_fma_f32 v[98:99], v[98:99], v[70:71], v[70:71] op_sel_hi:[1,0,0]
    v_rcp_f32 v92, v92
    buffer_load_dwordx4 v0, s[4:7], s54 offen offset:2048 sc1 lds
    v_rcp_f32 v93, v93
    v_pk_mul_f32 v[120:121], v[120:121], v[104:105]
    v_rcp_f32 v94, v94
    v_rcp_f32 v95, v95
    v_pk_mul_f32 v[122:123], v[122:123], v[106:107]
    v_rcp_f32 v96, v96
    v_rcp_f32 v97, v97
    v_pk_mul_f32 v[128:129], v[128:129], v[112:113]
    v_rcp_f32 v98, v98
    v_rcp_f32 v99, v99
    v_pk_mul_f32 v[130:131], v[130:131], v[114:115]
    v_pk_mul_f32 v[120:121], v[120:121], v[92:93]
    v_pk_mul_f32 v[122:123], v[122:123], v[94:95]
    buffer_load_dwordx4 v0, s[4:7], s54 offen offset:3072 sc1 lds
    v_pk_mul_f32 v[128:129], v[128:129], v[96:97]
    v_pk_mul_f32 v[130:131], v[130:131], v[98:99]
    v_cvt_pk_bf16_f32 v100, v120, v121
    v_cvt_pk_bf16_f32 v101, v122, v123
    v_cvt_pk_bf16_f32 v102, v128, v129
    v_cvt_pk_bf16_f32 v103, v130, v131
    buffer_store_dwordx4 v[100:103], v0, s[4:7], s33 offen offset:0 sc1
    v_pk_fma_f32 v[108:109], v[76:77], v[72:73], v[108:109] op_sel:[0,1,0] op_sel_hi:[1,1,1]
    v_pk_fma_f32 v[110:111], v[78:79], v[72:73], v[110:111] op_sel:[0,1,0] op_sel_hi:[1,1,1]
    v_pk_fma_f32 v[116:117], v[80:81], v[72:73], v[116:117] op_sel:[0,1,0] op_sel_hi:[1,1,1]
    v_pk_fma_f32 v[118:119], v[82:83], v[72:73], v[118:119] op_sel:[0,1,0] op_sel_hi:[1,1,1]
    v_pk_mul_f32 v[92:93], v[108:109], v[108:109]
    v_pk_mul_f32 v[94:95], v[110:111], v[110:111]
    v_pk_mul_f32 v[96:97], v[116:117], v[116:117]
    v_pk_mul_f32 v[98:99], v[118:119], v[118:119]
    v_pk_fma_f32 v[92:93], v[92:93], v[72:73], v[74:75] op_sel:[0,0,1] op_sel_hi:[1,0,1]
    v_pk_fma_f32 v[94:95], v[94:95], v[72:73], v[74:75] op_sel:[0,0,1] op_sel_hi:[1,0,1]
    v_pk_fma_f32 v[96:97], v[96:97], v[72:73], v[74:75] op_sel:[0,0,1] op_sel_hi:[1,0,1]
    v_pk_fma_f32 v[98:99], v[98:99], v[72:73], v[74:75] op_sel:[0,0,1] op_sel_hi:[1,0,1]
    v_pk_mul_f32 v[92:93], v[92:93], v[108:109]
    v_pk_mul_f32 v[94:95], v[94:95], v[110:111]
    s_cmp_lg_u32 s17, 0
    s_cbranch_scc1 interleave_layers__linear_attn_block__geglu_ffn__prompt_kernel_k461
    s_add_u32 s53, s23, 20480
    buffer_load_dwordx4 v[248:251], v0, s[4:7], s53 offen offset:1024 sc1
interleave_layers__linear_attn_block__geglu_ffn__prompt_kernel_k461:
    v_pk_mul_f32 v[96:97], v[96:97], v[116:117]
    v_pk_mul_f32 v[98:99], v[98:99], v[118:119]
    v_exp_f32 v92, v92
    v_exp_f32 v93, v93
    v_pk_fma_f32 v[124:125], v[84:85], v[72:73], v[124:125] op_sel:[0,1,0] op_sel_hi:[1,1,1]
    v_exp_f32 v94, v94
    v_exp_f32 v95, v95
    v_pk_fma_f32 v[126:127], v[86:87], v[72:73], v[126:127] op_sel:[0,1,0] op_sel_hi:[1,1,1]
    v_exp_f32 v96, v96
    v_exp_f32 v97, v97
    v_pk_fma_f32 v[132:133], v[88:89], v[72:73], v[132:133] op_sel:[0,1,0] op_sel_hi:[1,1,1]
    v_exp_f32 v98, v98
    v_exp_f32 v99, v99
    s_cmp_lg_u32 s17, 0
    s_cbranch_scc1 interleave_layers__linear_attn_block__geglu_ffn__prompt_kernel_k462
    s_add_u32 s53, s23, 20480
    buffer_load_dwordx4 v[180:183], v0, s[4:7], s53 offen offset:2048 sc1
interleave_layers__linear_attn_block__geglu_ffn__prompt_kernel_k462:
    v_pk_fma_f32 v[134:135], v[90:91], v[72:73], v[134:135] op_sel:[0,1,0] op_sel_hi:[1,1,1]
    ds_read_b128 v[76:79], v28 offset:768
    ds_read_b128 v[80:83], v28 offset:832
    ds_read_b128 v[84:87], v28 offset:896
    ds_read_b128 v[88:91], v28 offset:960
    v_pk_fma_f32 v[92:93], v[92:93], v[74:75], v[74:75] op_sel_hi:[1,0,0]
    v_pk_fma_f32 v[94:95], v[94:95], v[74:75], v[74:75] op_sel_hi:[1,0,0]
    v_pk_fma_f32 v[96:97], v[96:97], v[74:75], v[74:75] op_sel_hi:[1,0,0]
    v_pk_fma_f32 v[98:99], v[98:99], v[74:75], v[74:75] op_sel_hi:[1,0,0]
    v_rcp_f32 v92, v92
    v_rcp_f32 v93, v93
    v_pk_mul_f32 v[124:125], v[124:125], v[108:109]
    v_rcp_f32 v94, v94
    v_rcp_f32 v95, v95
    v_pk_mul_f32 v[126:127], v[126:127], v[110:111]
    v_rcp_f32 v96, v96
    v_rcp_f32 v97, v97
    v_pk_mul_f32 v[132:133], v[132:133], v[116:117]
    s_cmp_lg_u32 s17, 0
    s_cbranch_scc1 interleave_layers__linear_attn_block__geglu_ffn__prompt_kernel_k463
    s_add_u32 s53, s23, 20480
    buffer_load_dwordx4 v[176:179], v0, s[4:7], s53 offen offset:3072 sc1
interleave_layers__linear_attn_block__geglu_ffn__prompt_kernel_k463:
    v_rcp_f32 v98, v98
    v_rcp_f32 v99, v99
    v_pk_mul_f32 v[134:135], v[134:135], v[118:119]
    v_pk_mul_f32 v[124:125], v[124:125], v[92:93]
    v_pk_mul_f32 v[126:127], v[126:127], v[94:95]
    v_pk_mul_f32 v[132:133], v[132:133], v[96:97]
    v_pk_mul_f32 v[134:135], v[134:135], v[98:99]
    v_cvt_pk_bf16_f32 v100, v124, v125
    v_cvt_pk_bf16_f32 v101, v126, v127
    v_cvt_pk_bf16_f32 v102, v132, v133
    v_cvt_pk_bf16_f32 v103, v134, v135
    buffer_store_dwordx4 v[100:103], v0, s[4:7], s51 offen offset:0 sc1
    s_waitcnt lgkmcnt(0)
    v_pk_fma_f32 v[136:137], v[76:77], v[68:69], v[136:137] op_sel:[0,1,0] op_sel_hi:[1,1,1]
    v_pk_fma_f32 v[138:139], v[78:79], v[68:69], v[138:139] op_sel:[0,1,0] op_sel_hi:[1,1,1]
    v_pk_fma_f32 v[144:145], v[80:81], v[68:69], v[144:145] op_sel:[0,1,0] op_sel_hi:[1,1,1]
    v_pk_fma_f32 v[146:147], v[82:83], v[68:69], v[146:147] op_sel:[0,1,0] op_sel_hi:[1,1,1]
    v_pk_mul_f32 v[92:93], v[136:137], v[136:137]
    v_pk_mul_f32 v[94:95], v[138:139], v[138:139]
    v_pk_mul_f32 v[96:97], v[144:145], v[144:145]
    s_cmp_lg_u32 s17, 0
    s_cbranch_scc1 interleave_layers__linear_attn_block__geglu_ffn__prompt_kernel_k464
    s_add_u32 s53, s23, 24576
    buffer_load_dwordx4 v[172:175], v0, s[4:7], s53 offen offset:0 sc1
interleave_layers__linear_attn_block__geglu_ffn__prompt_kernel_k464:
    v_pk_mul_f32 v[98:99], v[146:147], v[146:147]
    v_pk_fma_f32 v[92:93], v[92:93], v[68:69], v[70:71] op_sel:[0,0,1] op_sel_hi:[1,0,1]
    v_pk_fma_f32 v[94:95], v[94:95], v[68:69], v[70:71] op_sel:[0,0,1] op_sel_hi:[1,0,1]
    v_pk_fma_f32 v[96:97], v[96:97], v[68:69], v[70:71] op_sel:[0,0,1] op_sel_hi:[1,0,1]
    v_pk_fma_f32 v[98:99], v[98:99], v[68:69], v[70:71] op_sel:[0,0,1] op_sel_hi:[1,0,1]
    v_pk_mul_f32 v[92:93], v[92:93], v[136:137]
    v_pk_mul_f32 v[94:95], v[94:95], v[138:139]
    v_pk_mul_f32 v[96:97], v[96:97], v[144:145]
    v_pk_mul_f32 v[98:99], v[98:99], v[146:147]
    v_exp_f32 v92, v92
    v_exp_f32 v93, v93
    v_pk_fma_f32 v[152:153], v[84:85], v[68:69], v[152:153] op_sel:[0,1,0] op_sel_hi:[1,1,1]
    v_exp_f32 v94, v94
    v_exp_f32 v95, v95
    v_pk_fma_f32 v[154:155], v[86:87], v[68:69], v[154:155] op_sel:[0,1,0] op_sel_hi:[1,1,1]
    v_exp_f32 v96, v96
    s_cmp_lg_u32 s17, 0
    s_cbranch_scc1 interleave_layers__linear_attn_block__geglu_ffn__prompt_kernel_k465
    s_add_u32 s53, s23, 28672
    buffer_load_dwordx4 v[168:171], v0, s[4:7], s53 offen offset:2048 sc1
interleave_layers__linear_attn_block__geglu_ffn__prompt_kernel_k465:
    v_exp_f32 v97, v97
    v_pk_fma_f32 v[160:161], v[88:89], v[68:69], v[160:161] op_sel:[0,1,0] op_sel_hi:[1,1,1]
    v_exp_f32 v98, v98
    v_exp_f32 v99, v99
    v_pk_fma_f32 v[162:163], v[90:91], v[68:69], v[162:163] op_sel:[0,1,0] op_sel_hi:[1,1,1]
    v_pk_fma_f32 v[92:93], v[92:93], v[70:71], v[70:71] op_sel_hi:[1,0,0]
    v_pk_fma_f32 v[94:95], v[94:95], v[70:71], v[70:71] op_sel_hi:[1,0,0]
    v_pk_fma_f32 v[96:97], v[96:97], v[70:71], v[70:71] op_sel_hi:[1,0,0]
    v_pk_fma_f32 v[98:99], v[98:99], v[70:71], v[70:71] op_sel_hi:[1,0,0]
    v_rcp_f32 v92, v92
    v_rcp_f32 v93, v93
    v_pk_mul_f32 v[152:153], v[152:153], v[136:137]
    v_rcp_f32 v94, v94
    v_rcp_f32 v95, v95
    s_add_u32 s53, s23, 28672
    buffer_load_dwordx4 v[252:255], v0, s[4:7], s53 offen offset:3072 sc1
    v_pk_mul_f32 v[154:155], v[154:155], v[138:139]
    v_rcp_f32 v96, v96
    v_rcp_f32 v97, v97
    v_pk_mul_f32 v[160:161], v[160:161], v[144:145]
    v_rcp_f32 v98, v98
    v_rcp_f32 v99, v99
    v_pk_mul_f32 v[162:163], v[162:163], v[146:147]
    v_pk_mul_f32 v[152:153], v[152:153], v[92:93]
    v_pk_mul_f32 v[154:155], v[154:155], v[94:95]
    v_pk_mul_f32 v[160:161], v[160:161], v[96:97]
    v_pk_mul_f32 v[162:163], v[162:163], v[98:99]
    v_cvt_pk_bf16_f32 v100, v152, v153
    v_cvt_pk_bf16_f32 v101, v154, v155
    v_cvt_pk_bf16_f32 v102, v160, v161
    v_cvt_pk_bf16_f32 v103, v162, v163
    buffer_store_dwordx4 v[100:103], v0, s[4:7], s33 offen offset:1024 sc1
    v_pk_fma_f32 v[140:141], v[76:77], v[72:73], v[140:141] op_sel:[0,1,0] op_sel_hi:[1,1,1]
    s_add_u32 s53, s23, 32768
    buffer_load_dwordx4 a[160:163], v0, s[4:7], s53 offen offset:0 sc1
    v_pk_fma_f32 v[142:143], v[78:79], v[72:73], v[142:143] op_sel:[0,1,0] op_sel_hi:[1,1,1]
    v_pk_fma_f32 v[148:149], v[80:81], v[72:73], v[148:149] op_sel:[0,1,0] op_sel_hi:[1,1,1]
    v_pk_fma_f32 v[150:151], v[82:83], v[72:73], v[150:151] op_sel:[0,1,0] op_sel_hi:[1,1,1]
    v_pk_mul_f32 v[92:93], v[140:141], v[140:141]
    v_pk_mul_f32 v[94:95], v[142:143], v[142:143]
    v_pk_mul_f32 v[96:97], v[148:149], v[148:149]
    v_pk_mul_f32 v[98:99], v[150:151], v[150:151]
    v_pk_fma_f32 v[92:93], v[92:93], v[72:73], v[74:75] op_sel:[0,0,1] op_sel_hi:[1,0,1]
    v_pk_fma_f32 v[94:95], v[94:95], v[72:73], v[74:75] op_sel:[0,0,1] op_sel_hi:[1,0,1]
    v_pk_fma_f32 v[96:97], v[96:97], v[72:73], v[74:75] op_sel:[0,0,1] op_sel_hi:[1,0,1]
    v_pk_fma_f32 v[98:99], v[98:99], v[72:73], v[74:75] op_sel:[0,0,1] op_sel_hi:[1,0,1]
    v_pk_mul_f32 v[92:93], v[92:93], v[140:141]
    v_pk_mul_f32 v[94:95], v[94:95], v[142:143]
    v_pk_mul_f32 v[96:97], v[96:97], v[148:149]
    v_pk_mul_f32 v[98:99], v[98:99], v[150:151]
    v_exp_f32 v92, v92
    v_exp_f32 v93, v93
    v_pk_fma_f32 v[156:157], v[84:85], v[72:73], v[156:157] op_sel:[0,1,0] op_sel_hi:[1,1,1]
    buffer_load_dwordx4 a[164:167], v0, s[4:7], s53 offen offset:1024 sc1
    v_exp_f32 v94, v94
    v_exp_f32 v95, v95
    v_pk_fma_f32 v[158:159], v[86:87], v[72:73], v[158:159] op_sel:[0,1,0] op_sel_hi:[1,1,1]
    v_exp_f32 v96, v96
    v_exp_f32 v97, v97
    v_pk_fma_f32 v[164:165], v[88:89], v[72:73], v[164:165] op_sel:[0,1,0] op_sel_hi:[1,1,1]
    v_exp_f32 v98, v98
    v_exp_f32 v99, v99
    v_pk_fma_f32 v[166:167], v[90:91], v[72:73], v[166:167] op_sel:[0,1,0] op_sel_hi:[1,1,1]
    ds_read_b128 v[76:79], v28 offset:1024
    ds_read_b128 v[80:83], v28 offset:1088
    ds_read_b128 v[84:87], v28 offset:1152
    ds_read_b128 v[88:91], v28 offset:1216
    v_pk_fma_f32 v[92:93], v[92:93], v[74:75], v[74:75] op_sel_hi:[1,0,0]
    v_pk_fma_f32 v[94:95], v[94:95], v[74:75], v[74:75] op_sel_hi:[1,0,0]
    v_pk_fma_f32 v[96:97], v[96:97], v[74:75], v[74:75] op_sel_hi:[1,0,0]
    v_pk_fma_f32 v[98:99], v[98:99], v[74:75], v[74:75] op_sel_hi:[1,0,0]
    v_rcp_f32 v92, v92
    buffer_load_dwordx4 a[168:171], v0, s[4:7], s53 offen offset:2048 sc1
    v_rcp_f32 v93, v93
    v_pk_mul_f32 v[156:157], v[156:157], v[140:141]
    v_rcp_f32 v94, v94
    v_rcp_f32 v95, v95
    v_pk_mul_f32 v[158:159], v[158:159], v[142:143]
    v_rcp_f32 v96, v96
    v_rcp_f32 v97, v97
    v_pk_mul_f32 v[164:165], v[164:165], v[148:149]
    v_rcp_f32 v98, v98
    v_rcp_f32 v99, v99
    v_pk_mul_f32 v[166:167], v[166:167], v[150:151]
    v_pk_mul_f32 v[156:157], v[156:157], v[92:93]
    v_pk_mul_f32 v[158:159], v[158:159], v[94:95]
    v_pk_mul_f32 v[164:165], v[164:165], v[96:97]
    v_pk_mul_f32 v[166:167], v[166:167], v[98:99]
    v_cvt_pk_bf16_f32 v100, v156, v157
    v_cvt_pk_bf16_f32 v101, v158, v159
    v_cvt_pk_bf16_f32 v102, v164, v165
    v_cvt_pk_bf16_f32 v103, v166, v167
    buffer_store_dwordx4 v[100:103], v0, s[4:7], s51 offen offset:1024 sc1
    v_mfma_f32_16x16x32_bf16 v[104:107], v[60:63], a[0:3], 0
    v_mfma_f32_16x16x32_bf16 v[108:111], v[60:63], a[4:7], 0
    ds_read_b128 v[60:63], v2 offset:6144
    v_mfma_f32_16x16x32_bf16 v[112:115], v[64:67], a[0:3], 0
    v_mfma_f32_16x16x32_bf16 v[116:119], v[64:67], a[4:7], 0
    ds_read_b128 v[64:67], v2 offset:7168
    v_mfma_f32_16x16x32_bf16 v[120:123], v[44:47], a[0:3], 0
    v_mfma_f32_16x16x32_bf16 v[124:127], v[44:47], a[4:7], 0
    ds_read_b128 v[44:47], v2 offset:8192
    v_mfma_f32_16x16x32_bf16 v[128:131], v[48:51], a[0:3], 0
    buffer_load_dwordx4 a[172:175], v0, s[4:7], s53 offen offset:3072 sc1
    v_mfma_f32_16x16x32_bf16 v[132:135], v[48:51], a[4:7], 0
    ds_read_b128 v[48:51], v2 offset:9216
    v_mfma_f32_16x16x32_bf16 v[104:107], v[52:55], a[8:11], v[104:107]
    v_mfma_f32_16x16x32_bf16 v[108:111], v[52:55], a[12:15], v[108:111]
    ds_read_b128 v[52:55], v2 offset:10240
    v_mfma_f32_16x16x32_bf16 v[112:115], v[56:59], a[8:11], v[112:115]
    s_add_u32 s53, s23, 36864
    buffer_load_dwordx4 a[176:179], v0, s[4:7], s53 offen offset:0 sc1
    v_mfma_f32_16x16x32_bf16 v[116:119], v[56:59], a[12:15], v[116:119]
    ds_read_b128 v[56:59], v2 offset:11264
    s_waitcnt lgkmcnt(3)
    v_mfma_f32_16x16x32_bf16 v[120:123], v[60:63], a[8:11], v[120:123]
    v_mfma_f32_16x16x32_bf16 v[124:127], v[60:63], a[12:15], v[124:127]
    ds_read_b128 v[60:63], v2 offset:12288
    v_mfma_f32_16x16x32_bf16 v[128:131], v[64:67], a[8:11], v[128:131]
    buffer_load_dwordx4 a[180:183], v0, s[4:7], s53 offen offset:1024 sc1
    v_mfma_f32_16x16x32_bf16 v[132:135], v[64:67], a[12:15], v[132:135]
    ds_read_b128 v[64:67], v2 offset:13312
    v_mfma_f32_16x16x32_bf16 v[104:107], v[44:47], a[16:19], v[104:107]
    v_mfma_f32_16x16x32_bf16 v[108:111], v[44:47], a[20:23], v[108:111]
    ds_read_b128 v[44:47], v2 offset:14336
    s_waitcnt lgkmcnt(3)
    v_mfma_f32_16x16x32_bf16 v[112:115], v[48:51], a[16:19], v[112:115]
    buffer_load_dwordx4 a[184:187], v0, s[4:7], s53 offen offset:2048 sc1
    v_mfma_f32_16x16x32_bf16 v[116:119], v[48:51], a[20:23], v[116:119]
    ds_read_b128 v[48:51], v2 offset:15360
    v_mfma_f32_16x16x32_bf16 v[120:123], v[52:55], a[16:19], v[120:123]
    v_mfma_f32_16x16x32_bf16 v[124:127], v[52:55], a[20:23], v[124:127]
    ds_read_b128 v[52:55], v2 offset:16384
    v_mfma_f32_16x16x32_bf16 v[128:131], v[56:59], a[16:19], v[128:131]
    buffer_load_dwordx4 a[188:191], v0, s[4:7], s53 offen offset:3072 sc1
    v_mfma_f32_16x16x32_bf16 v[132:135], v[56:59], a[20:23], v[132:135]
    ds_read_b128 v[56:59], v2 offset:17408
    s_waitcnt lgkmcnt(3)
    v_mfma_f32_16x16x32_bf16 v[104:107], v[60:63], a[24:27], v[104:107]
    v_mfma_f32_16x16x32_bf16 v[108:111], v[60:63], a[28:31], v[108:111]
    ds_read_b128 v[60:63], v2 offset:18432
    v_mfma_f32_16x16x32_bf16 v[112:115], v[64:67], a[24:27], v[112:115]
    s_add_u32 s53, s23, 45056
    buffer_load_dwordx4 a[192:195], v0, s[4:7], s53 offen offset:1024 sc1
    v_mfma_f32_16x16x32_bf16 v[116:119], v[64:67], a[28:31], v[116:119]
    ds_read_b128 v[64:67], v2 offset:19456
    v_mfma_f32_16x16x32_bf16 v[120:123], v[44:47], a[24:27], v[120:123]
    v_mfma_f32_16x16x32_bf16 v[124:127], v[44:47], a[28:31], v[124:127]
    ds_read_b128 v[44:47], v2 offset:20480
    s_waitcnt lgkmcnt(3)
    v_mfma_f32_16x16x32_bf16 v[128:131], v[48:51], a[24:27], v[128:131]
    buffer_load_dwordx4 a[196:199], v0, s[4:7], s53 offen offset:2048 sc1
    v_mfma_f32_16x16x32_bf16 v[132:135], v[48:51], a[28:31], v[132:135]
    ds_read_b128 v[48:51], v2 offset:21504
    v_mfma_f32_16x16x32_bf16 v[104:107], v[52:55], a[32:35], v[104:107]
    v_mfma_f32_16x16x32_bf16 v[108:111], v[52:55], a[36:39], v[108:111]
    ds_read_b128 v[52:55], v2 offset:22528
    v_mfma_f32_16x16x32_bf16 v[112:115], v[56:59], a[32:35], v[112:115]
    buffer_load_dwordx4 a[200:203], v0, s[4:7], s53 offen offset:3072 sc1
    v_mfma_f32_16x16x32_bf16 v[116:119], v[56:59], a[36:39], v[116:119]
    ds_read_b128 v[56:59], v2 offset:23552
    s_waitcnt lgkmcnt(3)
    v_mfma_f32_16x16x32_bf16 v[120:123], v[60:63], a[32:35], v[120:123]
    v_mfma_f32_16x16x32_bf16 v[124:127], v[60:63], a[36:39], v[124:127]
    ds_read_b128 v[60:63], v2 offset:24576
    v_mfma_f32_16x16x32_bf16 v[128:131], v[64:67], a[32:35], v[128:131]
    s_add_u32 s53, s23, 49152
    buffer_load_dwordx4 a[204:207], v0, s[4:7], s53 offen offset:0 sc1
    v_mfma_f32_16x16x32_bf16 v[132:135], v[64:67], a[36:39], v[132:135]
    ds_read_b128 v[64:67], v2 offset:25600
    v_mfma_f32_16x16x32_bf16 v[104:107], v[44:47], a[40:43], v[104:107]
    s_add_u32 s19, s19, 1
    v_mov_b32 v41, s19
    v_mov_b32 v42, 0
    s_mov_b64 exec, 1
    s_waitcnt vmcnt(9)
    s_cmp_eq_u32 s18, 0
    s_cbranch_scc1 interleave_layers__linear_attn_block__geglu_ffn__prompt_kernel_fl66_slow
    buffer_store_dword v41, v42, s[4:7], s40 offen
interleave_layers__linear_attn_block__geglu_ffn__prompt_kernel_fl66_join:
    s_mov_b64 exec, -1
    v_mfma_f32_16x16x32_bf16 v[108:111], v[44:47], a[44:47], v[108:111]
    ds_read_b128 v[44:47], v2 offset:26624
    s_waitcnt lgkmcnt(3)
    v_mfma_f32_16x16x32_bf16 v[112:115], v[48:51], a[40:43], v[112:115]
    buffer_load_dwordx4 a[208:211], v0, s[4:7], s53 offen offset:1024 sc1
    v_mfma_f32_16x16x32_bf16 v[116:119], v[48:51], a[44:47], v[116:119]
    ds_read_b128 v[48:51], v2 offset:27648
    v_mfma_f32_16x16x32_bf16 v[120:123], v[52:55], a[40:43], v[120:123]
    v_mfma_f32_16x16x32_bf16 v[124:127], v[52:55], a[44:47], v[124:127]
    ds_read_b128 v[52:55], v2 offset:28672
    v_mfma_f32_16x16x32_bf16 v[128:131], v[56:59], a[40:43], v[128:131]
    v_mfma_f32_16x16x32_bf16 v[132:135], v[56:59], a[44:47], v[132:135]
    ds_read_b128 v[56:59], v2 offset:29696
    s_waitcnt lgkmcnt(3)
    v_mfma_f32_16x16x32_bf16 v[104:107], v[60:63], a[48:51], v[104:107]
    buffer_load_dwordx4 a[212:215], v0, s[4:7], s53 offen offset:2048 sc1
    v_mfma_f32_16x16x32_bf16 v[108:111], v[60:63], a[52:55], v[108:111]
    ds_read_b128 v[60:63], v2 offset:30720
    v_mfma_f32_16x16x32_bf16 v[112:115], v[64:67], a[48:51], v[112:115]
    v_mfma_f32_16x16x32_bf16 v[116:119], v[64:67], a[52:55], v[116:119]
    ds_read_b128 v[64:67], v2 offset:31744
    v_mfma_f32_16x16x32_bf16 v[120:123], v[44:47], a[48:51], v[120:123]
    buffer_load_dwordx4 a[216:219], v0, s[4:7], s53 offen offset:3072 sc1
    v_mfma_f32_16x16x32_bf16 v[124:127], v[44:47], a[52:55], v[124:127]
    s_barrier
    ds_read_b128 v[44:47], v2 offset:32768
    s_waitcnt lgkmcnt(3)
    v_mfma_f32_16x16x32_bf16 v[128:131], v[48:51], a[48:51], v[128:131]
    v_mfma_f32_16x16x32_bf16 v[132:135], v[48:51], a[52:55], v[132:135]
    ds_read_b128 v[48:51], v2 offset:33792
    v_mfma_f32_16x16x32_bf16 v[104:107], v[52:55], a[56:59], v[104:107]
    s_add_u32 s53, s23, 53248
    buffer_load_dwordx4 a[220:223], v0, s[4:7], s53 offen offset:0 sc1
    v_mfma_f32_16x16x32_bf16 v[108:111], v[52:55], a[60:63], v[108:111]
    ds_read_b128 v[52:55], v2 offset:34816
    v_mfma_f32_16x16x32_bf16 v[112:115], v[56:59], a[56:59], v[112:115]
    v_mfma_f32_16x16x32_bf16 v[116:119], v[56:59], a[60:63], v[116:119]
    ds_read_b128 v[56:59], v2 offset:35840
    s_waitcnt lgkmcnt(3)
    v_mfma_f32_16x16x32_bf16 v[120:123], v[60:63], a[56:59], v[120:123]
    buffer_load_dwordx4 a[224:227], v0, s[4:7], s53 offen offset:1024 sc1
    v_mfma_f32_16x16x32_bf16 v[124:127], v[60:63], a[60:63], v[124:127]
    ds_read_b128 v[60:63], v2 offset:36864
    v_mfma_f32_16x16x32_bf16 v[128:131], v[64:67], a[56:59], v[128:131]
    v_mfma_f32_16x16x32_bf16 v[132:135], v[64:67], a[60:63], v[132:135]
    ds_read_b128 v[64:67], v2 offset:37888
    v_mfma_f32_16x16x32_bf16 v[104:107], v[44:47], a[64:67], v[104:107]
    buffer_load_dwordx4 a[228:231], v0, s[4:7], s53 offen offset:2048 sc1
    v_mfma_f32_16x16x32_bf16 v[108:111], v[44:47], a[68:71], v[108:111]
    ds_read_b128 v[44:47], v2 offset:38912
    s_waitcnt lgkmcnt(3)
    v_mfma_f32_16x16x32_bf16 v[112:115], v[48:51], a[64:67], v[112:115]
    v_mfma_f32_16x16x32_bf16 v[116:119], v[48:51], a[68:71], v[116:119]
    ds_read_b128 v[48:51], v2 offset:39936
    v_mfma_f32_16x16x32_bf16 v[120:123], v[52:55], a[64:67], v[120:123]
    s_add_u32 s53, s23, 8192
    buffer_load_dwordx4 a[232:235], v0, s[4:7], s53 offen offset:2048 sc1
    v_mfma_f32_16x16x32_bf16 v[124:127], v[52:55], a[68:71], v[124:127]
    ds_read_b128 v[52:55], v2 offset:40960
    v_mfma_f32_16x16x32_bf16 v[128:131], v[56:59], a[64:67], v[128:131]
    v_mfma_f32_16x16x32_bf16 v[132:135], v[56:59], a[68:71], v[132:135]
    ds_read_b128 v[56:59], v2 offset:41984
    s_waitcnt lgkmcnt(3)
    v_mfma_f32_16x16x32_bf16 v[104:107], v[60:63], a[72:75], v[104:107]
    buffer_load_dwordx4 a[236:239], v0, s[4:7], s53 offen offset:3072 sc1
    v_mfma_f32_16x16x32_bf16 v[108:111], v[60:63], a[76:79], v[108:111]
    ds_read_b128 v[60:63], v2 offset:43008
    v_mfma_f32_16x16x32_bf16 v[112:115], v[64:67], a[72:75], v[112:115]
    v_mfma_f32_16x16x32_bf16 v[116:119], v[64:67], a[76:79], v[116:119]
    ds_read_b128 v[64:67], v2 offset:44032
    v_mfma_f32_16x16x32_bf16 v[120:123], v[44:47], a[72:75], v[120:123]
    s_add_u32 s53, s23, 12288
    buffer_load_dwordx4 a[240:243], v0, s[4:7], s53 offen offset:0 sc1
    v_mfma_f32_16x16x32_bf16 v[124:127], v[44:47], a[76:79], v[124:127]
    ds_read_b128 v[44:47], v2 offset:45056
    s_waitcnt lgkmcnt(3)
    v_mfma_f32_16x16x32_bf16 v[128:131], v[48:51], a[72:75], v[128:131]
    v_mfma_f32_16x16x32_bf16 v[132:135], v[48:51], a[76:79], v[132:135]
    ds_read_b128 v[48:51], v2 offset:46080
    v_mfma_f32_16x16x32_bf16 v[104:107], v[52:55], a[80:83], v[104:107]
    buffer_load_dwordx4 a[244:247], v0, s[4:7], s53 offen offset:1024 sc1
    v_mfma_f32_16x16x32_bf16 v[108:111], v[52:55], a[84:87], v[108:111]
    ds_read_b128 v[52:55], v2 offset:47104
    v_mfma_f32_16x16x32_bf16 v[112:115], v[56:59], a[80:83], v[112:115]
    v_mfma_f32_16x16x32_bf16 v[116:119], v[56:59], a[84:87], v[116:119]
    ds_read_b128 v[56:59], v2 offset:48128
    s_waitcnt lgkmcnt(3)
    v_mfma_f32_16x16x32_bf16 v[120:123], v[60:63], a[80:83], v[120:123]
    buffer_load_dwordx4 a[248:251], v0, s[4:7], s53 offen offset:2048 sc1
    v_mfma_f32_16x16x32_bf16 v[124:127], v[60:63], a[84:87], v[124:127]
    ds_read_b128 v[60:63], v2 offset:49152
    v_mfma_f32_16x16x32_bf16 v[128:131], v[64:67], a[80:83], v[128:131]
    v_mfma_f32_16x16x32_bf16 v[132:135], v[64:67], a[84:87], v[132:135]
    ds_read_b128 v[64:67], v2 offset:50176
    v_mfma_f32_16x16x32_bf16 v[104:107], v[44:47], a[88:91], v[104:107]
    v_mfma_f32_16x16x32_bf16 v[108:111], v[44:47], a[92:95], v[108:111]
    ds_read_b128 v[44:47], v2 offset:51200
    s_waitcnt lgkmcnt(3)
    v_mfma_f32_16x16x32_bf16 v[112:115], v[48:51], a[88:91], v[112:115]
    s_add_u32 s53, s23, 24576
    buffer_load_dwordx4 a[252:255], v0, s[4:7], s53 offen offset:1024 sc1
    v_mfma_f32_16x16x32_bf16 v[116:119], v[48:51], a[92:95], v[116:119]
    ds_read_b128 v[48:51], v2 offset:52224
    v_mfma_f32_16x16x32_bf16 v[120:123], v[52:55], a[88:91], v[120:123]
    v_mfma_f32_16x16x32_bf16 v[124:127], v[52:55], a[92:95], v[124:127]
    ds_read_b128 v[52:55], v2 offset:53248
    v_mfma_f32_16x16x32_bf16 v[128:131], v[56:59], a[88:91], v[128:131]
    buffer_load_dwordx4 v[152:155], v0, s[4:7], s53 offen offset:2048 sc1
    v_mfma_f32_16x16x32_bf16 v[132:135], v[56:59], a[92:95], v[132:135]
    ds_read_b128 v[56:59], v2 offset:54272
    s_waitcnt lgkmcnt(3)
    v_mfma_f32_16x16x32_bf16 v[104:107], v[60:63], a[96:99], v[104:107]
    v_mfma_f32_16x16x32_bf16 v[108:111], v[60:63], a[100:103], v[108:111]
    ds_read_b128 v[60:63], v2 offset:55296
    v_mfma_f32_16x16x32_bf16 v[112:115], v[64:67], a[96:99], v[112:115]
    buffer_load_dwordx4 v[156:159], v0, s[4:7], s53 offen offset:3072 sc1
    v_mfma_f32_16x16x32_bf16 v[116:119], v[64:67], a[100:103], v[116:119]
    ds_read_b128 v[64:67], v2 offset:56320
    v_mfma_f32_16x16x32_bf16 v[120:123], v[44:47], a[96:99], v[120:123]
    v_mfma_f32_16x16x32_bf16 v[124:127], v[44:47], a[100:103], v[124:127]
    ds_read_b128 v[44:47], v2 offset:57344
    s_waitcnt lgkmcnt(3)
    v_mfma_f32_16x16x32_bf16 v[128:131], v[48:51], a[96:99], v[128:131]
    s_add_u32 s53, s23, 28672
    buffer_load_dwordx4 v[160:163], v0, s[4:7], s53 offen offset:0 sc1
    v_mfma_f32_16x16x32_bf16 v[132:135], v[48:51], a[100:103], v[132:135]
    ds_read_b128 v[48:51], v2 offset:58368
    v_mfma_f32_16x16x32_bf16 v[104:107], v[52:55], a[104:107], v[104:107]
    v_mfma_f32_16x16x32_bf16 v[108:111], v[52:55], a[108:111], v[108:111]
    ds_read_b128 v[52:55], v2 offset:59392
    v_mfma_f32_16x16x32_bf16 v[112:115], v[56:59], a[104:107], v[112:115]
    buffer_load_dwordx4 v[164:167], v0, s[4:7], s53 offen offset:1024 sc1
    v_mfma_f32_16x16x32_bf16 v[116:119], v[56:59], a[108:111], v[116:119]
    ds_read_b128 v[56:59], v2 offset:60416
    s_waitcnt lgkmcnt(3)
    v_mfma_f32_16x16x32_bf16 v[120:123], v[60:63], a[104:107], v[120:123]
    v_mfma_f32_16x16x32_bf16 v[124:127], v[60:63], a[108:111], v[124:127]
    ds_read_b128 v[60:63], v2 offset:61440
    v_mfma_f32_16x16x32_bf16 v[128:131], v[64:67], a[104:107], v[128:131]
    s_add_u32 s53, s23, 40960
    buffer_load_dwordx4 a[0:3], v0, s[4:7], s53 offen offset:0 sc1
    v_mfma_f32_16x16x32_bf16 v[132:135], v[64:67], a[108:111], v[132:135]
    ds_read_b128 v[64:67], v2 offset:62464
    v_mfma_f32_16x16x32_bf16 v[104:107], v[44:47], a[112:115], v[104:107]
    v_mfma_f32_16x16x32_bf16 v[108:111], v[44:47], a[116:119], v[108:111]
    ds_read_b128 v[44:47], v2 offset:63488
    s_waitcnt lgkmcnt(3)
    v_mfma_f32_16x16x32_bf16 v[112:115], v[48:51], a[112:115], v[112:115]
    buffer_load_dwordx4 a[4:7], v0, s[4:7], s53 offen offset:1024 sc1
    v_mfma_f32_16x16x32_bf16 v[116:119], v[48:51], a[116:119], v[116:119]
    ds_read_b128 v[48:51], v2 offset:64512
    v_mfma_f32_16x16x32_bf16 v[120:123], v[52:55], a[112:115], v[120:123]
    v_mfma_f32_16x16x32_bf16 v[124:127], v[52:55], a[116:119], v[124:127]
    ds_read_b128 v[52:55], v3 offset:0
    v_mfma_f32_16x16x32_bf16 v[128:131], v[56:59], a[112:115], v[128:131]
    buffer_load_dwordx4 a[8:11], v0, s[4:7], s53 offen offset:2048 sc1
    v_mfma_f32_16x16x32_bf16 v[132:135], v[56:59], a[116:119], v[132:135]
    ds_read_b128 v[56:59], v3 offset:1024
    s_waitcnt lgkmcnt(3)
    v_mfma_f32_16x16x32_bf16 v[104:107], v[60:63], a[120:123], v[104:107]
    v_mfma_f32_16x16x32_bf16 v[108:111], v[60:63], a[124:127], v[108:111]
    ds_read_b128 v[60:63], v3 offset:2048
    v_mfma_f32_16x16x32_bf16 v[112:115], v[64:67], a[120:123], v[112:115]
    buffer_load_dwordx4 a[12:15], v0, s[4:7], s53 offen offset:3072 sc1
    v_mfma_f32_16x16x32_bf16 v[116:119], v[64:67], a[124:127], v[116:119]
    ds_read_b128 v[64:67], v3 offset:3072
    v_mfma_f32_16x16x32_bf16 v[120:123], v[44:47], a[120:123], v[120:123]
    v_mfma_f32_16x16x32_bf16 v[124:127], v[44:47], a[124:127], v[124:127]
    ds_read_b128 v[44:47], v3 offset:4096
    s_waitcnt lgkmcnt(3)
    v_mfma_f32_16x16x32_bf16 v[128:131], v[48:51], a[120:123], v[128:131]
    s_add_u32 s53, s23, 45056
    buffer_load_dwordx4 a[16:19], v0, s[4:7], s53 offen offset:0 sc1
    v_mfma_f32_16x16x32_bf16 v[132:135], v[48:51], a[124:127], v[132:135]
    ds_read_b128 v[48:51], v3 offset:5120
    v_mfma_f32_16x16x32_bf16 v[104:107], v[52:55], a[128:131], v[104:107]
    buffer_load_dword v38, v31, s[4:7], s41 offen sc1
    v_mfma_f32_16x16x32_bf16 v[108:111], v[52:55], a[132:135], v[108:111]
    ds_read_b128 v[52:55], v3 offset:6144
    v_mfma_f32_16x16x32_bf16 v[112:115], v[56:59], a[128:131], v[112:115]
    v_mfma_f32_16x16x32_bf16 v[116:119], v[56:59], a[132:135], v[116:119]
    ds_read_b128 v[56:59], v3 offset:7168
    s_waitcnt lgkmcnt(3)
    v_mfma_f32_16x16x32_bf16 v[120:123], v[60:63], a[128:131], v[120:123]
    s_add_u32 s53, s23, 53248
    buffer_load_dwordx4 a[20:23], v0, s[4:7], s53 offen offset:3072 sc1
    v_mfma_f32_16x16x32_bf16 v[124:127], v[60:63], a[132:135], v[124:127]
    ds_read_b128 v[60:63], v3 offset:8192
    v_mfma_f32_16x16x32_bf16 v[128:131], v[64:67], a[128:131], v[128:131]
    v_mfma_f32_16x16x32_bf16 v[132:135], v[64:67], a[132:135], v[132:135]
    ds_read_b128 v[64:67], v3 offset:9216
    v_mfma_f32_16x16x32_bf16 v[104:107], v[44:47], a[136:139], v[104:107]
    s_add_u32 s53, s23, 57344
    buffer_load_dwordx4 a[24:27], v0, s[4:7], s53 offen offset:0 sc1
    v_mfma_f32_16x16x32_bf16 v[108:111], v[44:47], a[140:143], v[108:111]
    ds_read_b128 v[44:47], v3 offset:10240
    s_waitcnt lgkmcnt(3)
    v_mfma_f32_16x16x32_bf16 v[112:115], v[48:51], a[136:139], v[112:115]
    v_mfma_f32_16x16x32_bf16 v[116:119], v[48:51], a[140:143], v[116:119]
    ds_read_b128 v[48:51], v3 offset:11264
    v_mfma_f32_16x16x32_bf16 v[120:123], v[52:55], a[136:139], v[120:123]
    buffer_load_dwordx4 a[28:31], v0, s[4:7], s53 offen offset:1024 sc1
    v_mfma_f32_16x16x32_bf16 v[124:127], v[52:55], a[140:143], v[124:127]
    ds_read_b128 v[52:55], v3 offset:12288
    v_mfma_f32_16x16x32_bf16 v[128:131], v[56:59], a[136:139], v[128:131]
    v_mfma_f32_16x16x32_bf16 v[132:135], v[56:59], a[140:143], v[132:135]
    ds_read_b128 v[56:59], v3 offset:13312
    s_waitcnt lgkmcnt(3)
    v_mfma_f32_16x16x32_bf16 v[104:107], v[60:63], a[144:147], v[104:107]
    buffer_load_dwordx4 a[32:35], v0, s[4:7], s53 offen offset:2048 sc1
    v_mfma_f32_16x16x32_bf16 v[108:111], v[60:63], a[148:151], v[108:111]
    ds_read_b128 v[60:63], v3 offset:14336
    v_mfma_f32_16x16x32_bf16 v[112:115], v[64:67], a[144:147], v[112:115]
    v_mfma_f32_16x16x32_bf16 v[116:119], v[64:67], a[148:151], v[116:119]
    ds_read_b128 v[64:67], v3 offset:15360
    v_mfma_f32_16x16x32_bf16 v[120:123], v[44:47], a[144:147], v[120:123]
    buffer_load_dwordx4 a[36:39], v0, s[4:7], s53 offen offset:3072 sc1
    v_mfma_f32_16x16x32_bf16 v[124:127], v[44:47], a[148:151], v[124:127]
    s_waitcnt lgkmcnt(2)
    v_mfma_f32_16x16x32_bf16 v[128:131], v[48:51], a[144:147], v[128:131]
    v_mfma_f32_16x16x32_bf16 v[132:135], v[48:51], a[148:151], v[132:135]
    v_mfma_f32_16x16x32_bf16 v[104:107], v[52:55], a[152:155], v[104:107]
    v_mfma_f32_16x16x32_bf16 v[108:111], v[52:55], a[156:159], v[108:111]
    v_mfma_f32_16x16x32_bf16 v[112:115], v[56:59], a[152:155], v[112:115]
    buffer_load_dword v43, v33, s[4:7], s25 offen sc1
    v_mfma_f32_16x16x32_bf16 v[116:119], v[56:59], a[156:159], v[116:119]
    s_waitcnt lgkmcnt(0)
    v_mfma_f32_16x16x32_bf16 v[120:123], v[60:63], a[152:155], v[120:123]
    v_mfma_f32_16x16x32_bf16 v[124:127], v[60:63], a[156:159], v[124:127]
    v_mfma_f32_16x16x32_bf16 v[128:131], v[64:67], a[152:155], v[128:131]
    v_mfma_f32_16x16x32_bf16 v[132:135], v[64:67], a[156:159], v[132:135]
    s_waitcnt vmcnt(6)
    v_subrev_u32 v38, s19, v38
    v_cmp_lt_u32 vcc, 12, v38
    s_nop 1
    s_and_b64 vcc, vcc, s[68:69]
    s_cbranch_scc1 interleave_layers__linear_attn_block__geglu_ffn__prompt_kernel_aspin68
interleave_layers__linear_attn_block__geglu_ffn__prompt_kernel_adone67:
    v_pk_fma_f32 v[104:105], v[76:77], v[68:69], v[104:105] op_sel:[0,1,0] op_sel_hi:[1,1,1]
    buffer_load_dwordx4 a[40:43], v0, s[4:7], s34 offen offset:0 sc1
    v_pk_fma_f32 v[106:107], v[78:79], v[68:69], v[106:107] op_sel:[0,1,0] op_sel_hi:[1,1,1]
    v_pk_fma_f32 v[112:113], v[80:81], v[68:69], v[112:113] op_sel:[0,1,0] op_sel_hi:[1,1,1]
    v_pk_fma_f32 v[114:115], v[82:83], v[68:69], v[114:115] op_sel:[0,1,0] op_sel_hi:[1,1,1]
    v_pk_mul_f32 v[92:93], v[104:105], v[104:105]
    v_pk_mul_f32 v[94:95], v[106:107], v[106:107]
    v_pk_mul_f32 v[96:97], v[112:113], v[112:113]
    v_pk_mul_f32 v[98:99], v[114:115], v[114:115]
    v_pk_fma_f32 v[92:93], v[92:93], v[68:69], v[70:71] op_sel:[0,0,1] op_sel_hi:[1,0,1]
    v_pk_fma_f32 v[94:95], v[94:95], v[68:69], v[70:71] op_sel:[0,0,1] op_sel_hi:[1,0,1]
    v_pk_fma_f32 v[96:97], v[96:97], v[68:69], v[70:71] op_sel:[0,0,1] op_sel_hi:[1,0,1]
    v_pk_fma_f32 v[98:99], v[98:99], v[68:69], v[70:71] op_sel:[0,0,1] op_sel_hi:[1,0,1]
    v_pk_mul_f32 v[92:93], v[92:93], v[104:105]
    v_pk_mul_f32 v[94:95], v[94:95], v[106:107]
    v_pk_mul_f32 v[96:97], v[96:97], v[112:113]
    v_pk_mul_f32 v[98:99], v[98:99], v[114:115]
    v_exp_f32 v92, v92
    v_exp_f32 v93, v93
    buffer_load_dwordx4 a[44:47], v0, s[4:7], s34 offen offset:1024 sc1
    v_pk_fma_f32 v[120:121], v[84:85], v[68:69], v[120:121] op_sel:[0,1,0] op_sel_hi:[1,1,1]
    v_exp_f32 v94, v94
    v_exp_f32 v95, v95
    v_pk_fma_f32 v[122:123], v[86:87], v[68:69], v[122:123] op_sel:[0,1,0] op_sel_hi:[1,1,1]
    v_exp_f32 v96, v96
    v_exp_f32 v97, v97
    v_pk_fma_f32 v[128:129], v[88:89], v[68:69], v[128:129] op_sel:[0,1,0] op_sel_hi:[1,1,1]
    v_exp_f32 v98, v98
    v_exp_f32 v99, v99
    v_pk_fma_f32 v[130:131], v[90:91], v[68:69], v[130:131] op_sel:[0,1,0] op_sel_hi:[1,1,1]
    v_pk_fma_f32 v[92:93], v[92:93], v[70:71], v[70:71] op_sel_hi:[1,0,0]
    v_pk_fma_f32 v[94:95], v[94:95], v[70:71], v[70:71] op_sel_hi:[1,0,0]
    buffer_load_dwordx4 a[48:51], v0, s[4:7], s34 offen offset:3072 sc1
    v_pk_fma_f32 v[96:97], v[96:97], v[70:71], v[70:71] op_sel_hi:[1,0,0]
    v_pk_fma_f32 v[98:99], v[98:99], v[70:71], v[70:71] op_sel_hi:[1,0,0]
    v_rcp_f32 v92, v92
    v_rcp_f32 v93, v93
    v_pk_mul_f32 v[120:121], v[120:121], v[104:105]
    v_rcp_f32 v94, v94
    v_rcp_f32 v95, v95
    v_pk_mul_f32 v[122:123], v[122:123], v[106:107]
    v_rcp_f32 v96, v96
    v_rcp_f32 v97, v97
    v_pk_mul_f32 v[128:129], v[128:129], v[112:113]
    v_rcp_f32 v98, v98
    s_add_u32 s52, s34, 4096
    buffer_load_dwordx4 a[52:55], v0, s[4:7], s52 offen offset:0 sc1
    v_rcp_f32 v99, v99
    v_pk_mul_f32 v[130:131], v[130:131], v[114:115]
    v_pk_mul_f32 v[120:121], v[120:121], v[92:93]
    v_pk_mul_f32 v[122:123], v[122:123], v[94:95]
    v_pk_mul_f32 v[128:129], v[128:129], v[96:97]
    v_pk_mul_f32 v[130:131], v[130:131], v[98:99]
    v_cvt_pk_bf16_f32 v100, v120, v121
    v_cvt_pk_bf16_f32 v101, v122, v123
    v_cvt_pk_bf16_f32 v102, v128, v129
    v_cvt_pk_bf16_f32 v103, v130, v131
    buffer_store_dwordx4 v[100:103], v0, s[4:7], s33 offen offset:2048 sc1
    v_pk_fma_f32 v[108:109], v[76:77], v[72:73], v[108:109] op_sel:[0,1,0] op_sel_hi:[1,1,1]
    v_pk_fma_f32 v[110:111], v[78:79], v[72:73], v[110:111] op_sel:[0,1,0] op_sel_hi:[1,1,1]
    v_pk_fma_f32 v[116:117], v[80:81], v[72:73], v[116:117] op_sel:[0,1,0] op_sel_hi:[1,1,1]
    v_pk_fma_f32 v[118:119], v[82:83], v[72:73], v[118:119] op_sel:[0,1,0] op_sel_hi:[1,1,1]
    v_pk_mul_f32 v[92:93], v[108:109], v[108:109]
    v_pk_mul_f32 v[94:95], v[110:111], v[110:111]
    v_pk_mul_f32 v[96:97], v[116:117], v[116:117]
    buffer_load_dwordx4 a[56:59], v0, s[4:7], s52 offen offset:2048 sc1
    v_pk_mul_f32 v[98:99], v[118:119], v[118:119]
    v_pk_fma_f32 v[92:93], v[92:93], v[72:73], v[74:75] op_sel:[0,0,1] op_sel_hi:[1,0,1]
    v_pk_fma_f32 v[94:95], v[94:95], v[72:73], v[74:75] op_sel:[0,0,1] op_sel_hi:[1,0,1]
    v_pk_fma_f32 v[96:97], v[96:97], v[72:73], v[74:75] op_sel:[0,0,1] op_sel_hi:[1,0,1]
    v_pk_fma_f32 v[98:99], v[98:99], v[72:73], v[74:75] op_sel:[0,0,1] op_sel_hi:[1,0,1]
    v_pk_mul_f32 v[92:93], v[92:93], v[108:109]
    v_pk_mul_f32 v[94:95], v[94:95], v[110:111]
    v_pk_mul_f32 v[96:97], v[96:97], v[116:117]
    v_pk_mul_f32 v[98:99], v[98:99], v[118:119]
    v_exp_f32 v92, v92
    v_exp_f32 v93, v93
    v_pk_fma_f32 v[124:125], v[84:85], v[72:73], v[124:125] op_sel:[0,1,0] op_sel_hi:[1,1,1]
    v_exp_f32 v94, v94
    v_exp_f32 v95, v95
    buffer_load_dwordx4 a[60:63], v0, s[4:7], s52 offen offset:3072 sc1
    v_pk_fma_f32 v[126:127], v[86:87], v[72:73], v[126:127] op_sel:[0,1,0] op_sel_hi:[1,1,1]
    v_exp_f32 v96, v96
    v_exp_f32 v97, v97
    v_pk_fma_f32 v[132:133], v[88:89], v[72:73], v[132:133] op_sel:[0,1,0] op_sel_hi:[1,1,1]
    v_exp_f32 v98, v98
    v_exp_f32 v99, v99
    v_pk_fma_f32 v[134:135], v[90:91], v[72:73], v[134:135] op_sel:[0,1,0] op_sel_hi:[1,1,1]
    v_pk_fma_f32 v[92:93], v[92:93], v[74:75], v[74:75] op_sel_hi:[1,0,0]
    v_pk_fma_f32 v[94:95], v[94:95], v[74:75], v[74:75] op_sel_hi:[1,0,0]
    v_pk_fma_f32 v[96:97], v[96:97], v[74:75], v[74:75] op_sel_hi:[1,0,0]
    v_pk_fma_f32 v[98:99], v[98:99], v[74:75], v[74:75] op_sel_hi:[1,0,0]
    v_rcp_f32 v92, v92
    v_rcp_f32 v93, v93
    v_pk_mul_f32 v[124:125], v[124:125], v[108:109]
    v_rcp_f32 v94, v94
    v_rcp_f32 v95, v95
    v_pk_mul_f32 v[126:127], v[126:127], v[110:111]
    v_rcp_f32 v96, v96
    v_rcp_f32 v97, v97
    v_pk_mul_f32 v[132:133], v[132:133], v[116:117]
    v_rcp_f32 v98, v98
    v_rcp_f32 v99, v99
    v_pk_mul_f32 v[134:135], v[134:135], v[118:119]
    v_pk_mul_f32 v[124:125], v[124:125], v[92:93]
    v_pk_mul_f32 v[126:127], v[126:127], v[94:95]
    v_pk_mul_f32 v[132:133], v[132:133], v[96:97]
    v_pk_mul_f32 v[134:135], v[134:135], v[98:99]
    v_cvt_pk_bf16_f32 v100, v124, v125
    v_cvt_pk_bf16_f32 v101, v126, v127
    v_cvt_pk_bf16_f32 v102, v132, v133
    v_cvt_pk_bf16_f32 v103, v134, v135
    buffer_store_dwordx4 v[100:103], v0, s[4:7], s51 offen offset:2048 sc1
    s_cmp_lg_u32 s17, 0
    s_cbranch_scc1 interleave_layers__linear_attn_block__geglu_ffn__prompt_kernel_last71
    s_waitcnt vmcnt(9)
    s_waitcnt vmcnt(7)
    v_mfma_f32_16x16x32_bf16 v[44:47], v[184:187], a[40:43], 0
    s_add_u32 s52, s34, 8192
    buffer_load_dwordx4 a[64:67], v0, s[4:7], s52 offen offset:1024 sc1
    v_mfma_f32_16x16x32_bf16 v[48:51], v[188:191], a[40:43], 0
    v_mfma_f32_16x16x32_bf16 v[52:55], v[192:195], a[40:43], 0
    v_mfma_f32_16x16x32_bf16 v[56:59], v[196:199], a[40:43], 0
    v_mfma_f32_16x16x32_bf16 v[60:63], v[200:203], a[40:43], 0
    buffer_load_dwordx4 a[68:71], v0, s[4:7], s52 offen offset:2048 sc1
    s_waitcnt vmcnt(8)
    v_mfma_f32_16x16x32_bf16 v[44:47], v[204:207], a[44:47], v[44:47]
    v_mfma_f32_16x16x32_bf16 v[48:51], v[208:211], a[44:47], v[48:51]
    v_mfma_f32_16x16x32_bf16 v[52:55], v[212:215], a[44:47], v[52:55]
    v_mfma_f32_16x16x32_bf16 v[56:59], v[216:219], a[44:47], v[56:59]
    v_mfma_f32_16x16x32_bf16 v[60:63], v[220:223], a[44:47], v[60:63]
    buffer_load_dwordx4 a[72:75], v0, s[4:7], s35 offen offset:0 sc1
    s_waitcnt vmcnt(8)
    v_mfma_f32_16x16x32_bf16 v[44:47], v[224:227], a[48:51], v[44:47]
    v_mfma_f32_16x16x32_bf16 v[48:51], v[228:231], a[48:51], v[48:51]
    v_mfma_f32_16x16x32_bf16 v[52:55], v[232:235], a[48:51], v[52:55]
    v_mfma_f32_16x16x32_bf16 v[56:59], v[236:239], a[48:51], v[56:59]
    v_mfma_f32_16x16x32_bf16 v[60:63], v[240:243], a[48:51], v[60:63]
    buffer_load_dwordx4 a[76:79], v0, s[4:7], s35 offen offset:1024 sc1
    s_waitcnt vmcnt(8)
    v_mfma_f32_16x16x32_bf16 v[44:47], v[244:247], a[52:55], v[44:47]
    v_mfma_f32_16x16x32_bf16 v[48:51], v[248:251], a[52:55], v[48:51]
    v_mfma_f32_16x16x32_bf16 v[52:55], v[180:183], a[52:55], v[52:55]
    v_mfma_f32_16x16x32_bf16 v[56:59], v[176:179], a[52:55], v[56:59]
    v_mfma_f32_16x16x32_bf16 v[60:63], v[172:175], a[52:55], v[60:63]
    buffer_load_dwordx4 a[80:83], v0, s[4:7], s35 offen offset:3072 sc1
    s_waitcnt vmcnt(7)
    v_mfma_f32_16x16x32_bf16 v[44:47], v[168:171], a[56:59], v[44:47]
    v_mfma_f32_16x16x32_bf16 v[48:51], v[252:255], a[56:59], v[48:51]
    v_mfma_f32_16x16x32_bf16 v[52:55], a[160:163], a[56:59], v[52:55]
    v_mfma_f32_16x16x32_bf16 v[56:59], a[164:167], a[56:59], v[56:59]
    s_add_u32 s52, s35, 4096
    buffer_load_dwordx4 a[84:87], v0, s[4:7], s52 offen offset:0 sc1
    v_mfma_f32_16x16x32_bf16 v[60:63], a[168:171], a[56:59], v[60:63]
    s_waitcnt vmcnt(7)
    v_mfma_f32_16x16x32_bf16 v[44:47], a[172:175], a[60:63], v[44:47]
    v_mfma_f32_16x16x32_bf16 v[48:51], a[176:179], a[60:63], v[48:51]
    v_mfma_f32_16x16x32_bf16 v[52:55], a[180:183], a[60:63], v[52:55]
    v_mfma_f32_16x16x32_bf16 v[56:59], a[184:187], a[60:63], v[56:59]
    buffer_load_dwordx4 a[88:91], v0, s[4:7], s52 offen offset:2048 sc1
    v_mfma_f32_16x16x32_bf16 v[60:63], a[188:191], a[60:63], v[60:63]
    s_waitcnt vmcnt(6)
    v_mfma_f32_16x16x32_bf16 v[44:47], a[192:195], a[64:67], v[44:47]
    s_add_u32 s19, s19, 1
    v_mov_b32 v41, s19
    v_mov_b32 v42, 0
    s_mov_b64 exec, 1
    s_cmp_eq_u32 s18, 0
    s_cbranch_scc1 interleave_layers__linear_attn_block__geglu_ffn__prompt_kernel_fl72_slow
    buffer_store_dword v41, v42, s[4:7], s40 offen
interleave_layers__linear_attn_block__geglu_ffn__prompt_kernel_fl72_join:
    s_mov_b64 exec, -1
    v_mfma_f32_16x16x32_bf16 v[48:51], a[196:199], a[64:67], v[48:51]
    v_mfma_f32_16x16x32_bf16 v[52:55], a[200:203], a[64:67], v[52:55]
    v_mfma_f32_16x16x32_bf16 v[56:59], a[204:207], a[64:67], v[56:59]
    buffer_load_dwordx4 a[92:95], v0, s[4:7], s52 offen offset:3072 sc1
    v_mfma_f32_16x16x32_bf16 v[60:63], a[208:211], a[64:67], v[60:63]
    s_waitcnt vmcnt(7)
    v_mfma_f32_16x16x32_bf16 v[44:47], a[212:215], a[68:71], v[44:47]
    v_mfma_f32_16x16x32_bf16 v[48:51], a[216:219], a[68:71], v[48:51]
    v_mfma_f32_16x16x32_bf16 v[52:55], a[220:223], a[68:71], v[52:55]
    v_mfma_f32_16x16x32_bf16 v[56:59], a[224:227], a[68:71], v[56:59]
    s_add_u32 s52, s35, 8192
    buffer_load_dwordx4 a[96:99], v0, s[4:7], s52 offen offset:1024 sc1
    v_mfma_f32_16x16x32_bf16 v[60:63], a[228:231], a[68:71], v[60:63]
    s_waitcnt vmcnt(7)
    v_mfma_f32_16x16x32_bf16 v[64:67], v[184:187], a[72:75], 0
    v_mfma_f32_16x16x32_bf16 v[68:71], v[188:191], a[72:75], 0
    v_mfma_f32_16x16x32_bf16 v[72:75], v[192:195], a[72:75], 0
    buffer_load_dwordx4 a[100:103], v0, s[4:7], s52 offen offset:2048 sc1
    v_mfma_f32_16x16x32_bf16 v[76:79], v[196:199], a[72:75], 0
    v_mfma_f32_16x16x32_bf16 v[80:83], v[200:203], a[72:75], 0
    s_waitcnt vmcnt(7)
    v_mfma_f32_16x16x32_bf16 v[64:67], v[204:207], a[76:79], v[64:67]
    v_mfma_f32_16x16x32_bf16 v[68:71], v[208:211], a[76:79], v[68:71]
    v_mfma_f32_16x16x32_bf16 v[72:75], v[212:215], a[76:79], v[72:75]
    buffer_load_dwordx4 a[104:107], v0, s[4:7], s36 offen offset:0 sc1
    v_mfma_f32_16x16x32_bf16 v[76:79], v[216:219], a[76:79], v[76:79]
    v_mfma_f32_16x16x32_bf16 v[80:83], v[220:223], a[76:79], v[80:83]
    s_waitcnt vmcnt(7)
    v_mfma_f32_16x16x32_bf16 v[64:67], v[224:227], a[80:83], v[64:67]
    v_mfma_f32_16x16x32_bf16 v[68:71], v[228:231], a[80:83], v[68:71]
    v_mfma_f32_16x16x32_bf16 v[72:75], v[232:235], a[80:83], v[72:75]
    buffer_load_dwordx4 a[108:111], v0, s[4:7], s36 offen offset:1024 sc1
    v_mfma_f32_16x16x32_bf16 v[76:79], v[236:239], a[80:83], v[76:79]
    v_mfma_f32_16x16x32_bf16 v[80:83], v[240:243], a[80:83], v[80:83]
    s_waitcnt vmcnt(7)
    v_mfma_f32_16x16x32_bf16 v[64:67], v[244:247], a[84:87], v[64:67]
    buffer_load_dword v38, v31, s[4:7], s41 offen sc1
    v_mfma_f32_16x16x32_bf16 v[68:71], v[248:251], a[84:87], v[68:71]
    v_mfma_f32_16x16x32_bf16 v[72:75], v[180:183], a[84:87], v[72:75]
    buffer_load_dwordx4 a[112:115], v0, s[4:7], s36 offen offset:3072 sc1
    v_mfma_f32_16x16x32_bf16 v[76:79], v[176:179], a[84:87], v[76:79]
    v_mfma_f32_16x16x32_bf16 v[80:83], v[172:175], a[84:87], v[80:83]
    s_waitcnt vmcnt(8)
    v_mfma_f32_16x16x32_bf16 v[64:67], v[168:171], a[88:91], v[64:67]
    v_lshlrev_b32 v124, 16, v4
    v_mfma_f32_16x16x32_bf16 v[68:71], v[252:255], a[88:91], v[68:71]
    v_and_b32 v125, 0xffff0000, v4
    s_add_u32 s52, s36, 4096
    buffer_load_dwordx4 a[116:119], v0, s[4:7], s52 offen offset:0 sc1
    v_mfma_f32_16x16x32_bf16 v[72:75], a[160:163], a[88:91], v[72:75]
    v_lshlrev_b32 v126, 16, v5
    v_mfma_f32_16x16x32_bf16 v[76:79], a[164:167], a[88:91], v[76:79]
    v_and_b32 v127, 0xffff0000, v5
    v_mfma_f32_16x16x32_bf16 v[80:83], a[168:171], a[88:91], v[80:83]
    v_lshlrev_b32 v128, 16, v6
    s_waitcnt vmcnt(7)
    v_mfma_f32_16x16x32_bf16 v[64:67], a[172:175], a[92:95], v[64:67]
    v_and_b32 v129, 0xffff0000, v6
    v_mfma_f32_16x16x32_bf16 v[68:71], a[176:179], a[92:95], v[68:71]
    v_lshlrev_b32 v130, 16, v7
    buffer_load_dwordx4 a[120:123], v0, s[4:7], s52 offen offset:2048 sc1
    v_mfma_f32_16x16x32_bf16 v[72:75], a[180:183], a[92:95], v[72:75]
    v_and_b32 v131, 0xffff0000, v7
    v_mfma_f32_16x16x32_bf16 v[76:79], a[184:187], a[92:95], v[76:79]
    v_lshlrev_b32 v132, 16, v8
    v_mfma_f32_16x16x32_bf16 v[80:83], a[188:191], a[92:95], v[80:83]
    v_and_b32 v133, 0xffff0000, v8
    s_waitcnt vmcnt(7)
    v_mfma_f32_16x16x32_bf16 v[64:67], a[192:195], a[96:99], v[64:67]
    v_lshlrev_b32 v134, 16, v9
    v_mfma_f32_16x16x32_bf16 v[68:71], a[196:199], a[96:99], v[68:71]
    v_and_b32 v135, 0xffff0000, v9
    buffer_load_dwordx4 a[124:127], v0, s[4:7], s52 offen offset:3072 sc1
    v_mfma_f32_16x16x32_bf16 v[72:75], a[200:203], a[96:99], v[72:75]
    v_lshlrev_b32 v136, 16, v10
    v_mfma_f32_16x16x32_bf16 v[76:79], a[204:207], a[96:99], v[76:79]
    v_and_b32 v137, 0xffff0000, v10
    v_mfma_f32_16x16x32_bf16 v[80:83], a[208:211], a[96:99], v[80:83]
    v_lshlrev_b32 v138, 16, v11
    s_waitcnt vmcnt(7)
    v_mfma_f32_16x16x32_bf16 v[64:67], a[212:215], a[100:103], v[64:67]
    v_and_b32 v139, 0xffff0000, v11
    v_mfma_f32_16x16x32_bf16 v[68:71], a[216:219], a[100:103], v[68:71]
    v_lshlrev_b32 v140, 16, v12
    s_add_u32 s52, s36, 8192
    buffer_load_dwordx4 a[128:131], v0, s[4:7], s52 offen offset:1024 sc1
    v_mfma_f32_16x16x32_bf16 v[72:75], a[220:223], a[100:103], v[72:75]
    v_and_b32 v141, 0xffff0000, v12
    v_mfma_f32_16x16x32_bf16 v[76:79], a[224:227], a[100:103], v[76:79]
    v_lshlrev_b32 v142, 16, v13
    v_mfma_f32_16x16x32_bf16 v[80:83], a[228:231], a[100:103], v[80:83]
    v_and_b32 v143, 0xffff0000, v13
    s_waitcnt vmcnt(7)
    v_mfma_f32_16x16x32_bf16 v[84:87], v[184:187], a[104:107], 0
    buffer_load_dwordx4 a[132:135], v0, s[4:7], s52 offen offset:2048 sc1
    v_mfma_f32_16x16x32_bf16 v[88:91], v[188:191], a[104:107], 0
    v_mfma_f32_16x16x32_bf16 v[92:95], v[192:195], a[104:107], 0
    v_mfma_f32_16x16x32_bf16 v[96:99], v[196:199], a[104:107], 0
    v_mfma_f32_16x16x32_bf16 v[100:103], v[200:203], a[104:107], 0
    s_waitcnt vmcnt(7)
    v_mfma_f32_16x16x32_bf16 v[84:87], v[204:207], a[108:111], v[84:87]
    s_waitcnt vmcnt(6)
    v_subrev_u32 v38, s19, v38
    v_cmp_lt_u32 vcc, 12, v38
    s_nop 1
    s_and_b64 vcc, vcc, s[68:69]
    s_cbranch_scc1 interleave_layers__linear_attn_block__geglu_ffn__prompt_kernel_aspin74
interleave_layers__linear_attn_block__geglu_ffn__prompt_kernel_adone73:
    buffer_load_dwordx4 a[136:139], v0, s[4:7], s34 offen offset:2048 sc1
    s_add_u32 s52, s34, 4096
    buffer_load_dwordx4 a[140:143], v0, s[4:7], s52 offen offset:1024 sc1
    v_mfma_f32_16x16x32_bf16 v[88:91], v[208:211], a[108:111], v[88:91]
    v_mfma_f32_16x16x32_bf16 v[92:95], v[212:215], a[108:111], v[92:95]
    v_mfma_f32_16x16x32_bf16 v[96:99], v[216:219], a[108:111], v[96:99]
    v_mfma_f32_16x16x32_bf16 v[100:103], v[220:223], a[108:111], v[100:103]
    s_add_u32 s52, s34, 8192
    buffer_load_dwordx4 a[144:147], v0, s[4:7], s52 offen offset:0 sc1
    s_waitcnt vmcnt(8)
    v_mfma_f32_16x16x32_bf16 v[84:87], v[224:227], a[112:115], v[84:87]
    v_mfma_f32_16x16x32_bf16 v[88:91], v[228:231], a[112:115], v[88:91]
    v_mfma_f32_16x16x32_bf16 v[92:95], v[232:235], a[112:115], v[92:95]
    v_mfma_f32_16x16x32_bf16 v[96:99], v[236:239], a[112:115], v[96:99]
    v_mfma_f32_16x16x32_bf16 v[100:103], v[240:243], a[112:115], v[100:103]
    buffer_load_dwordx4 a[148:151], v0, s[4:7], s52 offen offset:3072 sc1
    s_waitcnt vmcnt(8)
    v_mfma_f32_16x16x32_bf16 v[84:87], v[244:247], a[116:119], v[84:87]
    v_mfma_f32_16x16x32_bf16 v[88:91], v[248:251], a[116:119], v[88:91]
    v_mfma_f32_16x16x32_bf16 v[92:95], v[180:183], a[116:119], v[92:95]
    v_mfma_f32_16x16x32_bf16 v[96:99], v[176:179], a[116:119], v[96:99]
    v_mfma_f32_16x16x32_bf16 v[100:103], v[172:175], a[116:119], v[100:103]
    buffer_load_dwordx4 a[152:155], v0, s[4:7], s35 offen offset:2048 sc1
    s_waitcnt vmcnt(8)
    v_mfma_f32_16x16x32_bf16 v[84:87], v[168:171], a[120:123], v[84:87]
    v_mfma_f32_16x16x32_bf16 v[88:91], v[252:255], a[120:123], v[88:91]
    v_mfma_f32_16x16x32_bf16 v[92:95], a[160:163], a[120:123], v[92:95]
    v_mfma_f32_16x16x32_bf16 v[96:99], a[164:167], a[120:123], v[96:99]
    v_mfma_f32_16x16x32_bf16 v[100:103], a[168:171], a[120:123], v[100:103]
    s_add_u32 s52, s35, 4096
    buffer_load_dwordx4 a[156:159], v0, s[4:7], s52 offen offset:1024 sc1
    s_waitcnt vmcnt(8)
    v_mfma_f32_16x16x32_bf16 v[84:87], a[172:175], a[124:127], v[84:87]
    v_mfma_f32_16x16x32_bf16 v[88:91], a[176:179], a[124:127], v[88:91]
    v_mfma_f32_16x16x32_bf16 v[92:95], a[180:183], a[124:127], v[92:95]
    v_mfma_f32_16x16x32_bf16 v[96:99], a[184:187], a[124:127], v[96:99]
    s_add_u32 s52, s35, 8192
    buffer_load_dwordx4 a[40:43], v0, s[4:7], s52 offen offset:0 sc1
    v_mfma_f32_16x16x32_bf16 v[100:103], a[188:191], a[124:127], v[100:103]
    s_waitcnt vmcnt(8)
    v_mfma_f32_16x16x32_bf16 v[84:87], a[192:195], a[128:131], v[84:87]
    v_mfma_f32_16x16x32_bf16 v[88:91], a[196:199], a[128:131], v[88:91]
    v_mfma_f32_16x16x32_bf16 v[92:95], a[200:203], a[128:131], v[92:95]
    v_mfma_f32_16x16x32_bf16 v[96:99], a[204:207], a[128:131], v[96:99]
    buffer_load_dwordx4 a[44:47], v0, s[4:7], s52 offen offset:3072 sc1
    v_mfma_f32_16x16x32_bf16 v[100:103], a[208:211], a[128:131], v[100:103]
    s_waitcnt vmcnt(8)
    v_mfma_f32_16x16x32_bf16 v[84:87], a[212:215], a[132:135], v[84:87]
    v_mfma_f32_16x16x32_bf16 v[88:91], a[216:219], a[132:135], v[88:91]
    v_mfma_f32_16x16x32_bf16 v[92:95], a[220:223], a[132:135], v[92:95]
    v_mfma_f32_16x16x32_bf16 v[96:99], a[224:227], a[132:135], v[96:99]
    buffer_load_dwordx4 a[48:51], v0, s[4:7], s36 offen offset:2048 sc1
    v_mfma_f32_16x16x32_bf16 v[100:103], a[228:231], a[132:135], v[100:103]
    s_waitcnt vmcnt(8)
    v_mfma_f32_16x16x32_bf16 v[44:47], a[232:235], a[136:139], v[44:47]
    v_mfma_f32_16x16x32_bf16 v[48:51], a[236:239], a[136:139], v[48:51]
    v_mfma_f32_16x16x32_bf16 v[52:55], a[240:243], a[136:139], v[52:55]
    v_mfma_f32_16x16x32_bf16 v[56:59], a[244:247], a[136:139], v[56:59]
    s_add_u32 s52, s36, 4096
    buffer_load_dwordx4 a[52:55], v0, s[4:7], s52 offen offset:1024 sc1
    v_mfma_f32_16x16x32_bf16 v[60:63], a[248:251], a[136:139], v[60:63]
    s_waitcnt vmcnt(8)
    v_mfma_f32_16x16x32_bf16 v[44:47], a[252:255], a[140:143], v[44:47]
    v_mfma_f32_16x16x32_bf16 v[48:51], v[152:155], a[140:143], v[48:51]
    v_mfma_f32_16x16x32_bf16 v[52:55], v[156:159], a[140:143], v[52:55]
    s_add_u32 s52, s36, 8192
    buffer_load_dwordx4 a[56:59], v0, s[4:7], s52 offen offset:0 sc1
    v_mfma_f32_16x16x32_bf16 v[56:59], v[160:163], a[140:143], v[56:59]
    v_mfma_f32_16x16x32_bf16 v[60:63], v[164:167], a[140:143], v[60:63]
    s_waitcnt vmcnt(8)
    v_mfma_f32_16x16x32_bf16 v[44:47], a[0:3], a[144:147], v[44:47]
    v_mfma_f32_16x16x32_bf16 v[48:51], a[4:7], a[144:147], v[48:51]
    v_mfma_f32_16x16x32_bf16 v[52:55], a[8:11], a[144:147], v[52:55]
    buffer_load_dwordx4 a[60:63], v0, s[4:7], s52 offen offset:3072 sc1
    v_mfma_f32_16x16x32_bf16 v[56:59], a[12:15], a[144:147], v[56:59]
    v_mfma_f32_16x16x32_bf16 v[60:63], a[16:19], a[144:147], v[60:63]
    s_waitcnt vmcnt(8)
    v_mfma_f32_16x16x32_bf16 v[44:47], a[20:23], a[148:151], v[44:47]
    v_mfma_f32_16x16x32_bf16 v[48:51], a[24:27], a[148:151], v[48:51]
    v_mfma_f32_16x16x32_bf16 v[52:55], a[28:31], a[148:151], v[52:55]
    buffer_load_dwordx4 a[64:67], v0, s[4:7], s37 offen offset:0 sc1
    v_mfma_f32_16x16x32_bf16 v[56:59], a[32:35], a[148:151], v[56:59]
    v_mfma_f32_16x16x32_bf16 v[60:63], a[36:39], a[148:151], v[60:63]
    s_waitcnt vmcnt(8)
    v_mfma_f32_16x16x32_bf16 v[64:67], a[232:235], a[152:155], v[64:67]
    v_mfma_f32_16x16x32_bf16 v[68:71], a[236:239], a[152:155], v[68:71]
    v_mfma_f32_16x16x32_bf16 v[72:75], a[240:243], a[152:155], v[72:75]
    buffer_load_dwordx4 a[68:71], v0, s[4:7], s37 offen offset:1024 sc1
    v_mfma_f32_16x16x32_bf16 v[76:79], a[244:247], a[152:155], v[76:79]
    v_add_u32 v150, s86, v0
    v_mfma_f32_16x16x32_bf16 v[80:83], a[248:251], a[152:155], v[80:83]
    s_barrier
    ds_write_b128 v150, v[44:47] offset:0
    s_waitcnt vmcnt(8)
    v_mfma_f32_16x16x32_bf16 v[64:67], a[252:255], a[156:159], v[64:67]
    v_mfma_f32_16x16x32_bf16 v[68:71], v[152:155], a[156:159], v[68:71]
    buffer_load_dwordx4 a[72:75], v0, s[4:7], s37 offen offset:3072 sc1
    v_mfma_f32_16x16x32_bf16 v[72:75], v[156:159], a[156:159], v[72:75]
    ds_write_b128 v150, v[48:51] offset:1024
    v_mfma_f32_16x16x32_bf16 v[76:79], v[160:163], a[156:159], v[76:79]
    v_mfma_f32_16x16x32_bf16 v[80:83], v[164:167], a[156:159], v[80:83]
    s_waitcnt vmcnt(8)
    v_mfma_f32_16x16x32_bf16 v[64:67], a[0:3], a[40:43], v[64:67]
    s_add_u32 s54, s20, 0
    s_add_u32 m0, s73, 0
    s_nop 0
    buffer_load_dwordx4 v0, s[44:47], s54 offen offset:0 sc1 lds
    ds_write_b128 v150, v[52:55] offset:2048
    v_mfma_f32_16x16x32_bf16 v[68:71], a[4:7], a[40:43], v[68:71]
    s_add_u32 s52, s37, 4096
    buffer_load_dwordx4 a[76:79], v0, s[4:7], s52 offen offset:0 sc1
    v_mfma_f32_16x16x32_bf16 v[72:75], a[8:11], a[40:43], v[72:75]
    v_mfma_f32_16x16x32_bf16 v[76:79], a[12:15], a[40:43], v[76:79]
    ds_write_b128 v150, v[56:59] offset:3072
    v_mfma_f32_16x16x32_bf16 v[80:83], a[16:19], a[40:43], v[80:83]
    s_waitcnt vmcnt(9)
    v_mfma_f32_16x16x32_bf16 v[64:67], a[20:23], a[44:47], v[64:67]
    buffer_load_dwordx4 v0, s[44:47], s54 offen offset:1024 sc1 lds
    v_mfma_f32_16x16x32_bf16 v[68:71], a[24:27], a[44:47], v[68:71]
    ds_write_b128 v150, v[60:63] offset:4096
    buffer_load_dwordx4 a[80:83], v0, s[4:7], s52 offen offset:2048 sc1
    v_mfma_f32_16x16x32_bf16 v[72:75], a[28:31], a[44:47], v[72:75]
    v_mfma_f32_16x16x32_bf16 v[76:79], a[32:35], a[44:47], v[76:79]
    v_mfma_f32_16x16x32_bf16 v[80:83], a[36:39], a[44:47], v[80:83]
    s_waitcnt vmcnt(10)
    v_mfma_f32_16x16x32_bf16 v[84:87], a[232:235], a[48:51], v[84:87]
    buffer_load_dwordx4 v0, s[44:47], s54 offen offset:2048 sc1 lds
    v_mfma_f32_16x16x32_bf16 v[88:91], a[236:239], a[48:51], v[88:91]
    buffer_load_dwordx4 a[84:87], v0, s[4:7], s52 offen offset:3072 sc1
    v_mfma_f32_16x16x32_bf16 v[92:95], a[240:243], a[48:51], v[92:95]
    v_mfma_f32_16x16x32_bf16 v[96:99], a[244:247], a[48:51], v[96:99]
    v_add_u32 v150, s87, v0
    v_mfma_f32_16x16x32_bf16 v[100:103], a[248:251], a[48:51], v[100:103]
    ds_write_b128 v150, v[64:67] offset:0
    s_waitcnt vmcnt(11)
    v_mfma_f32_16x16x32_bf16 v[84:87], a[252:255], a[52:55], v[84:87]
    buffer_load_dwordx4 v0, s[44:47], s54 offen offset:3072 sc1 lds
    s_add_u32 s52, s37, 8192
    buffer_load_dwordx4 a[88:91], v0, s[4:7], s52 offen offset:1024 sc1
    v_mfma_f32_16x16x32_bf16 v[88:91], v[152:155], a[52:55], v[88:91]
    v_mfma_f32_16x16x32_bf16 v[92:95], v[156:159], a[52:55], v[92:95]
    ds_write_b128 v150, v[68:71] offset:1024
    v_mfma_f32_16x16x32_bf16 v[96:99], v[160:163], a[52:55], v[96:99]
    v_mfma_f32_16x16x32_bf16 v[100:103], v[164:167], a[52:55], v[100:103]
    s_waitcnt vmcnt(12)
    v_mfma_f32_16x16x32_bf16 v[84:87], a[0:3], a[56:59], v[84:87]
    s_add_u32 s54, s20, 16384
    s_add_u32 m0, s73, 16384
    s_nop 0
    buffer_load_dwordx4 v0, s[44:47], s54 offen offset:0 sc1 lds
    ds_write_b128 v150, v[72:75] offset:2048
    buffer_load_dwordx4 a[92:95], v0, s[4:7], s52 offen offset:2048 sc1
    v_mfma_f32_16x16x32_bf16 v[88:91], a[4:7], a[56:59], v[88:91]
    v_mfma_f32_16x16x32_bf16 v[92:95], a[8:11], a[56:59], v[92:95]
    v_mfma_f32_16x16x32_bf16 v[96:99], a[12:15], a[56:59], v[96:99]
    ds_write_b128 v150, v[76:79] offset:3072
    v_mfma_f32_16x16x32_bf16 v[100:103], a[16:19], a[56:59], v[100:103]
    s_waitcnt vmcnt(13)
    v_mfma_f32_16x16x32_bf16 v[84:87], a[20:23], a[60:63], v[84:87]
    buffer_load_dwordx4 v0, s[44:47], s54 offen offset:1024 sc1 lds
    buffer_load_dwordx4 a[96:99], v0, s[4:7], s37 offen offset:2048 sc1
    v_mfma_f32_16x16x32_bf16 v[88:91], a[24:27], a[60:63], v[88:91]
    ds_write_b128 v150, v[80:83] offset:4096
    v_mfma_f32_16x16x32_bf16 v[92:95], a[28:31], a[60:63], v[92:95]
    v_mfma_f32_16x16x32_bf16 v[96:99], a[32:35], a[60:63], v[96:99]
    v_mfma_f32_16x16x32_bf16 v[100:103], a[36:39], a[60:63], v[100:103]
    s_waitcnt vmcnt(14)
    v_mfma_f32_16x16x32_bf16 v[104:107], v[184:187], a[64:67], 0
    buffer_load_dwordx4 v0, s[44:47], s54 offen offset:2048 sc1 lds
    s_add_u32 s52, s37, 4096
    buffer_load_dwordx4 a[100:103], v0, s[4:7], s52 offen offset:1024 sc1
    v_mfma_f32_16x16x32_bf16 v[108:111], v[188:191], a[64:67], 0
    v_mfma_f32_16x16x32_bf16 v[112:115], v[192:195], a[64:67], 0
    v_mfma_f32_16x16x32_bf16 v[116:119], v[196:199], a[64:67], 0
    v_add_u32 v150, s88, v0
    v_mfma_f32_16x16x32_bf16 v[120:123], v[200:203], a[64:67], 0
    ds_write_b128 v150, v[84:87] offset:0
    s_add_u32 s52, s37, 8192
    buffer_load_dwordx4 a[104:107], v0, s[4:7], s52 offen offset:0 sc1
    s_waitcnt vmcnt(16)
    v_mfma_f32_16x16x32_bf16 v[104:107], v[204:207], a[68:71], v[104:107]
    buffer_load_dwordx4 v0, s[44:47], s54 offen offset:3072 sc1 lds
    v_mfma_f32_16x16x32_bf16 v[108:111], v[208:211], a[68:71], v[108:111]
    v_mfma_f32_16x16x32_bf16 v[112:115], v[212:215], a[68:71], v[112:115]
    ds_write_b128 v150, v[88:91] offset:1024
    v_mfma_f32_16x16x32_bf16 v[116:119], v[216:219], a[68:71], v[116:119]
    v_mfma_f32_16x16x32_bf16 v[120:123], v[220:223], a[68:71], v[120:123]
    buffer_load_dwordx4 a[108:111], v0, s[4:7], s52 offen offset:3072 sc1
    s_waitcnt vmcnt(17)
    v_mfma_f32_16x16x32_bf16 v[104:107], v[224:227], a[72:75], v[104:107]
    s_add_u32 s54, s20, 32768
    s_add_u32 m0, s73, 32768
    s_nop 0
    buffer_load_dwordx4 v0, s[44:47], s54 offen offset:0 sc1 lds
    ds_write_b128 v150, v[92:95] offset:2048
    v_mfma_f32_16x16x32_bf16 v[108:111], v[228:231], a[72:75], v[108:111]
    v_mfma_f32_16x16x32_bf16 v[112:115], v[232:235], a[72:75], v[112:115]
    v_mfma_f32_16x16x32_bf16 v[116:119], v[236:239], a[72:75], v[116:119]
    ds_write_b128 v150, v[96:99] offset:3072
    v_mfma_f32_16x16x32_bf16 v[120:123], v[240:243], a[72:75], v[120:123]
    s_waitcnt vmcnt(16)
    v_mfma_f32_16x16x32_bf16 v[104:107], v[244:247], a[76:79], v[104:107]
    v_mfma_f32_16x16x32_bf16 v[108:111], v[248:251], a[76:79], v[108:111]
    ds_write_b128 v150, v[100:103] offset:4096
    v_mfma_f32_16x16x32_bf16 v[112:115], v[180:183], a[76:79], v[112:115]
    v_mfma_f32_16x16x32_bf16 v[116:119], v[176:179], a[76:79], v[116:119]
    v_mfma_f32_16x16x32_bf16 v[120:123], v[172:175], a[76:79], v[120:123]
    s_waitcnt lgkmcnt(0)
    s_barrier
    v_add_u32 v40, s89, v0
    s_waitcnt vmcnt(14)
    v_mfma_f32_16x16x32_bf16 v[104:107], v[168:171], a[80:83], v[104:107]
    buffer_load_dwordx4 v0, s[44:47], s54 offen offset:1024 sc1 lds
    ds_read_b128 v[44:47], v40 offset:0
    v_mfma_f32_16x16x32_bf16 v[108:111], v[252:255], a[80:83], v[108:111]
    v_mfma_f32_16x16x32_bf16 v[112:115], a[160:163], a[80:83], v[112:115]
    ds_read_b128 v[48:51], v40 offset:1024
    v_mfma_f32_16x16x32_bf16 v[116:119], a[164:167], a[80:83], v[116:119]
    v_mfma_f32_16x16x32_bf16 v[120:123], a[168:171], a[80:83], v[120:123]
    ds_read_b128 v[64:67], v40 offset:5120
    s_waitcnt vmcnt(13)
    v_mfma_f32_16x16x32_bf16 v[104:107], a[172:175], a[84:87], v[104:107]
    buffer_load_dwordx4 v0, s[44:47], s54 offen offset:2048 sc1 lds
    v_mfma_f32_16x16x32_bf16 v[108:111], a[176:179], a[84:87], v[108:111]
    ds_read_b128 v[68:71], v40 offset:6144
    v_mfma_f32_16x16x32_bf16 v[112:115], a[180:183], a[84:87], v[112:115]
    v_mfma_f32_16x16x32_bf16 v[116:119], a[184:187], a[84:87], v[116:119]
    v_mfma_f32_16x16x32_bf16 v[120:123], a[188:191], a[84:87], v[120:123]
    ds_read_b128 v[84:87], v40 offset:10240
    s_waitcnt vmcnt(12)
    v_mfma_f32_16x16x32_bf16 v[104:107], a[192:195], a[88:91], v[104:107]
    buffer_load_dwordx4 v0, s[44:47], s54 offen offset:3072 sc1 lds
    v_mfma_f32_16x16x32_bf16 v[108:111], a[196:199], a[88:91], v[108:111]
    ds_read_b128 v[88:91], v40 offset:11264
    s_waitcnt vmcnt(11)
    v_mfma_f32_16x16x32_bf16 v[104:107], a[212:215], a[92:95], v[104:107]
    v_mfma_f32_16x16x32_bf16 v[108:111], a[216:219], a[92:95], v[108:111]
    ds_read_b128 v[52:55], v40 offset:2048
    s_waitcnt vmcnt(9)
    v_mfma_f32_16x16x32_bf16 v[104:107], a[232:235], a[96:99], v[104:107]
    v_mfma_f32_16x16x32_bf16 v[108:111], a[236:239], a[96:99], v[108:111]
    s_add_u32 s54, s20, 49152
    s_add_u32 m0, s73, 49152
    s_nop 0
    buffer_load_dwordx4 v0, s[44:47], s54 offen offset:0 sc1 lds
    s_waitcnt vmcnt(8)
    v_mfma_f32_16x16x32_bf16 v[104:107], a[252:255], a[100:103], v[104:107]
    ds_read_b128 v[56:59], v40 offset:3072
    s_waitcnt lgkmcnt(7)
    v_pk_add_f32 v[124:125], v[124:125], v[44:45]
    v_mfma_f32_16x16x32_bf16 v[108:111], v[152:155], a[100:103], v[108:111]
    v_pk_add_f32 v[126:127], v[126:127], v[46:47]
    s_waitcnt vmcnt(7)
    v_mfma_f32_16x16x32_bf16 v[104:107], a[0:3], a[104:107], v[104:107]
    ds_read_b128 v[60:63], v40 offset:4096
    s_waitcnt lgkmcnt(7)
    v_pk_add_f32 v[128:129], v[128:129], v[48:49]
    v_mfma_f32_16x16x32_bf16 v[108:111], a[4:7], a[104:107], v[108:111]
    v_pk_add_f32 v[130:131], v[130:131], v[50:51]
    s_waitcnt vmcnt(5)
    v_mfma_f32_16x16x32_bf16 v[104:107], a[20:23], a[108:111], v[104:107]
    buffer_load_dwordx4 v0, s[44:47], s54 offen offset:1024 sc1 lds
    ds_read_b128 v[72:75], v40 offset:7168
    s_waitcnt lgkmcnt(7)
    v_pk_add_f32 v[124:125], v[124:125], v[64:65]
    v_mfma_f32_16x16x32_bf16 v[108:111], a[24:27], a[108:111], v[108:111]
    v_pk_add_f32 v[126:127], v[126:127], v[66:67]
    v_mfma_f32_16x16x32_bf16 v[112:115], a[200:203], a[88:91], v[112:115]
    s_waitcnt lgkmcnt(6)
    v_pk_add_f32 v[128:129], v[128:129], v[68:69]
    v_mfma_f32_16x16x32_bf16 v[116:119], a[204:207], a[88:91], v[116:119]
    ds_read_b128 v[76:79], v40 offset:8192
    v_pk_add_f32 v[130:131], v[130:131], v[70:71]
    v_mfma_f32_16x16x32_bf16 v[120:123], a[208:211], a[88:91], v[120:123]
    s_waitcnt lgkmcnt(6)
    v_pk_add_f32 v[124:125], v[124:125], v[84:85]
    v_mfma_f32_16x16x32_bf16 v[112:115], a[220:223], a[92:95], v[112:115]
    buffer_load_dwordx4 v0, s[44:47], s54 offen offset:2048 sc1 lds
    ds_read_b128 v[80:83], v40 offset:9216
    v_pk_add_f32 v[126:127], v[126:127], v[86:87]
    v_mfma_f32_16x16x32_bf16 v[116:119], a[224:227], a[92:95], v[116:119]
    s_waitcnt lgkmcnt(6)
    v_pk_add_f32 v[128:129], v[128:129], v[88:89]
    v_mfma_f32_16x16x32_bf16 v[120:123], a[228:231], a[92:95], v[120:123]
    ds_read_b128 v[92:95], v40 offset:12288
    v_pk_add_f32 v[130:131], v[130:131], v[90:91]
    v_mfma_f32_16x16x32_bf16 v[112:115], a[240:243], a[96:99], v[112:115]
    v_pk_add_f32 v[124:125], v[124:125], v[104:105]
    v_mfma_f32_16x16x32_bf16 v[116:119], a[244:247], a[96:99], v[116:119]
    ds_read_b128 v[96:99], v40 offset:13312
    v_pk_add_f32 v[126:127], v[126:127], v[106:107]
    v_mfma_f32_16x16x32_bf16 v[120:123], a[248:251], a[96:99], v[120:123]
    buffer_load_dwordx4 v0, s[44:47], s54 offen offset:3072 sc1 lds
    v_pk_add_f32 v[128:129], v[128:129], v[108:109]
    v_mfma_f32_16x16x32_bf16 v[112:115], v[156:159], a[100:103], v[112:115]
    v_pk_add_f32 v[130:131], v[130:131], v[110:111]
    v_mfma_f32_16x16x32_bf16 v[116:119], v[160:163], a[100:103], v[116:119]
    ds_read_b128 v[100:103], v40 offset:14336
    v_cvt_pk_bf16_f32 v4, v124, v125
    v_mfma_f32_16x16x32_bf16 v[120:123], v[164:167], a[100:103], v[120:123]
    v_cvt_pk_bf16_f32 v5, v126, v127
    v_mfma_f32_16x16x32_bf16 v[112:115], a[8:11], a[104:107], v[112:115]
    v_cvt_pk_bf16_f32 v6, v128, v129
    v_mfma_f32_16x16x32_bf16 v[116:119], a[12:15], a[104:107], v[116:119]
    s_add_u32 s54, s20, 65536
    s_add_u32 m0, s73, 65536
    s_nop 0
    buffer_load_dwordx4 v0, s[44:47], s54 offen offset:0 sc1 lds
    v_cvt_pk_bf16_f32 v7, v130, v131
    v_mfma_f32_16x16x32_bf16 v[120:123], a[16:19], a[104:107], v[120:123]
    s_cmp_eq_u32 s18, 0
    s_cbranch_scc1 interleave_layers__linear_attn_block__geglu_ffn__prompt_kernel_xs77_slow
    buffer_store_dwordx4 v[4:7], v0, s[4:7], s25 offen
interleave_layers__linear_attn_block__geglu_ffn__prompt_kernel_xs77_join:
    v_mfma_f32_16x16x32_bf16 v[112:115], a[28:31], a[108:111], v[112:115]
    v_mfma_f32_16x16x32_bf16 v[116:119], a[32:35], a[108:111], v[116:119]
    v_mfma_f32_16x16x32_bf16 v[120:123], a[36:39], a[108:111], v[120:123]
    buffer_load_dwordx4 v0, s[44:47], s54 offen offset:1024 sc1 lds
    buffer_load_dwordx4 v0, s[44:47], s54 offen offset:2048 sc1 lds
    buffer_load_dwordx4 v0, s[44:47], s54 offen offset:3072 sc1 lds
    s_add_u32 s19, s19, 1
    v_mov_b32 v41, s19
    v_mov_b32 v42, 0
    s_mov_b64 exec, 1
    s_waitcnt vmcnt(3)
    s_cmp_eq_u32 s18, 0
    s_cbranch_scc1 interleave_layers__linear_attn_block__geglu_ffn__prompt_kernel_fl78_slow
    buffer_store_dword v41, v42, s[4:7], s40 offen
interleave_layers__linear_attn_block__geglu_ffn__prompt_kernel_fl78_join:
    s_mov_b64 exec, -1
    buffer_load_dword v38, v31, s[4:7], s41 offen sc1
    s_waitcnt lgkmcnt(6)
    v_pk_add_f32 v[132:133], v[132:133], v[52:53]
    v_pk_add_f32 v[134:135], v[134:135], v[54:55]
    v_pk_add_f32 v[136:137], v[136:137], v[56:57]
    v_pk_add_f32 v[138:139], v[138:139], v[58:59]
    v_pk_add_f32 v[140:141], v[140:141], v[60:61]
    v_pk_add_f32 v[142:143], v[142:143], v[62:63]
    s_waitcnt lgkmcnt(3)
    v_pk_add_f32 v[132:133], v[132:133], v[72:73]
    v_pk_add_f32 v[134:135], v[134:135], v[74:75]
    v_pk_add_f32 v[136:137], v[136:137], v[76:77]
    v_pk_add_f32 v[138:139], v[138:139], v[78:79]
    v_pk_add_f32 v[140:141], v[140:141], v[80:81]
    v_pk_add_f32 v[142:143], v[142:143], v[82:83]
    s_waitcnt lgkmcnt(0)
    v_pk_add_f32 v[132:133], v[132:133], v[92:93]
    v_pk_add_f32 v[134:135], v[134:135], v[94:95]
    v_pk_add_f32 v[136:137], v[136:137], v[96:97]
    v_pk_add_f32 v[138:139], v[138:139], v[98:99]
    v_pk_add_f32 v[140:141], v[140:141], v[100:101]
    v_pk_add_f32 v[142:143], v[142:143], v[102:103]
    v_pk_add_f32 v[132:133], v[132:133], v[112:113]
    v_pk_add_f32 v[134:135], v[134:135], v[114:115]
    v_pk_add_f32 v[136:137], v[136:137], v[116:117]
    v_pk_add_f32 v[138:139], v[138:139], v[118:119]
    v_pk_add_f32 v[140:141], v[140:141], v[120:121]
    v_pk_add_f32 v[142:143], v[142:143], v[122:123]
    v_cvt_pk_bf16_f32 v8, v132, v133
    v_cvt_pk_bf16_f32 v9, v134, v135
    v_cvt_pk_bf16_f32 v10, v136, v137
    v_cvt_pk_bf16_f32 v11, v138, v139
    v_cvt_pk_bf16_f32 v12, v140, v141
    v_cvt_pk_bf16_f32 v13, v142, v143
    s_cmp_eq_u32 s18, 0
    s_cbranch_scc1 interleave_layers__linear_attn_block__geglu_ffn__prompt_kernel_xs79_slow
    buffer_store_dwordx4 v[8:11], v0, s[4:7], s66 offen
    buffer_store_dwordx2 v[12:13], v15, s[4:7], s66 offen offset:1024
interleave_layers__linear_attn_block__geglu_ffn__prompt_kernel_xs79_join:
    s_waitcnt vmcnt(2)
    v_subrev_u32 v38, s19, v38
    v_cmp_lt_u32 vcc, 12, v38
    s_nop 1
    s_and_b64 vcc, vcc, s[70:71]
    s_cbranch_scc1 interleave_layers__linear_attn_block__geglu_ffn__prompt_kernel_aspin81
interleave_layers__linear_attn_block__geglu_ffn__prompt_kernel_adone80:
    buffer_load_dwordx4 a[0:3], v0, s[4:7], s24 offen offset:0 sc1
    buffer_load_dwordx4 a[4:7], v14, s[4:7], s24 offen offset:0 sc1
    buffer_load_dwordx4 a[8:11], v0, s[4:7], s24 offen offset:1024 sc1
    buffer_load_dwordx4 a[12:15], v14, s[4:7], s24 offen offset:1024 sc1
    buffer_load_dwordx4 a[16:19], v0, s[4:7], s24 offen offset:2048 sc1
    buffer_load_dwordx4 a[20:23], v14, s[4:7], s24 offen offset:2048 sc1
    v_mov_b32 v144, 0
    v_mov_b32 v145, 0
    v_mov_b32 v146, 0
    v_mov_b32 v147, 0
    v_dot2c_f32_bf16 v144, v4, v32
    v_dot2c_f32_bf16 v145, v4, v4
    v_dot2c_f32_bf16 v146, v5, v32
    v_dot2c_f32_bf16 v147, v5, v5
    v_dot2c_f32_bf16 v144, v6, v32
    v_dot2c_f32_bf16 v145, v6, v6
    v_dot2c_f32_bf16 v146, v7, v32
    v_dot2c_f32_bf16 v147, v7, v7
    v_dot2c_f32_bf16 v144, v8, v32
    v_dot2c_f32_bf16 v145, v8, v8
    v_dot2c_f32_bf16 v146, v9, v32
    v_dot2c_f32_bf16 v147, v9, v9
    v_dot2c_f32_bf16 v144, v10, v32
    v_dot2c_f32_bf16 v145, v10, v10
    v_dot2c_f32_bf16 v146, v11, v32
    v_dot2c_f32_bf16 v147, v11, v11
    v_dot2c_f32_bf16 v144, v12, v32
    v_dot2c_f32_bf16 v145, v12, v12
    v_dot2c_f32_bf16 v146, v13, v32
    v_dot2c_f32_bf16 v147, v13, v13
    s_nop 2
    v_pk_add_f32 v[144:145], v[144:145], v[146:147]
    v_mov_b32 v146, v144
    v_mov_b32 v147, v145
    s_nop 0
    v_permlane16_swap_b32 v144, v146
    v_permlane16_swap_b32 v145, v147
    v_pk_add_f32 v[144:145], v[144:145], v[146:147]
    v_mov_b32 v146, v144
    v_mov_b32 v147, v145
    s_nop 0
    v_permlane32_swap_b32 v144, v146
    v_permlane32_swap_b32 v145, v147
    v_pk_add_f32 v[144:145], v[144:145], v[146:147]
    s_mov_b64 exec, 0xffff
    s_cmp_eq_u32 s18, 0
    s_cbranch_scc1 interleave_layers__linear_attn_block__geglu_ffn__prompt_kernel_ss84_slow
    buffer_store_dwordx2 v[144:145], v0, s[4:7], s27 offen
interleave_layers__linear_attn_block__geglu_ffn__prompt_kernel_ss84_join:
    s_mov_b64 exec, -1
    s_mov_b32 s17, 1
    s_add_u32 s38, s38, 0x10000
    s_add_u32 s75, s75, 1
    s_add_u32 s74, s74, 192
    ds_read_b128 v[108:111], v0 offset:0
    s_barrier
    ds_read_b128 v[112:115], v0 offset:1024
    ds_read_b128 v[116:119], v0 offset:2048
    ds_read_b128 v[120:123], v0 offset:3072
    ds_read_b128 v[124:127], v0 offset:4096
    ds_read_b128 v[128:131], v0 offset:5120
    s_waitcnt vmcnt(5) lgkmcnt(3)
    v_mfma_f32_16x16x32_bf16 v[44:47], a[0:3], v[108:111], 0
    buffer_load_dwordx4 a[24:27], v0, s[4:7], s24 offen offset:3072 sc1
    v_mfma_f32_16x16x32_bf16 v[48:51], a[4:7], v[108:111], 0
    ds_read_b128 v[108:111], v0 offset:6144
    v_mfma_f32_16x16x32_bf16 v[52:55], a[0:3], v[112:115], 0
    v_mfma_f32_16x16x32_bf16 v[56:59], a[4:7], v[112:115], 0
    ds_read_b128 v[112:115], v0 offset:7168
    v_mfma_f32_16x16x32_bf16 v[60:63], a[0:3], v[116:119], 0
    buffer_load_dwordx4 a[28:31], v14, s[4:7], s24 offen offset:3072 sc1
    v_mfma_f32_16x16x32_bf16 v[64:67], a[4:7], v[116:119], 0
    ds_read_b128 v[116:119], v0 offset:8192
    s_waitcnt lgkmcnt(3)
    v_mfma_f32_16x16x32_bf16 v[68:71], a[0:3], v[120:123], 0
    v_mfma_f32_16x16x32_bf16 v[72:75], a[4:7], v[120:123], 0
    ds_read_b128 v[120:123], v0 offset:9216
    v_mfma_f32_16x16x32_bf16 v[76:79], a[0:3], v[124:127], 0
    s_add_u32 s52, s24, 4096
    buffer_load_dwordx4 a[32:35], v0, s[4:7], s52 offen offset:0 sc1
    v_mfma_f32_16x16x32_bf16 v[80:83], a[4:7], v[124:127], 0
    ds_read_b128 v[124:127], v0 offset:10240
    s_waitcnt vmcnt(6)
    v_mfma_f32_16x16x32_bf16 v[44:47], a[8:11], v[128:131], v[44:47]
    v_mfma_f32_16x16x32_bf16 v[48:51], a[12:15], v[128:131], v[48:51]
    ds_read_b128 v[128:131], v0 offset:11264
    s_waitcnt lgkmcnt(3)
    v_mfma_f32_16x16x32_bf16 v[52:55], a[8:11], v[108:111], v[52:55]
    v_mfma_f32_16x16x32_bf16 v[56:59], a[12:15], v[108:111], v[56:59]
    ds_read_b128 v[108:111], v0 offset:12288
    v_mfma_f32_16x16x32_bf16 v[60:63], a[8:11], v[112:115], v[60:63]
    buffer_load_dwordx4 a[36:39], v14, s[4:7], s52 offen offset:0 sc1
    v_mfma_f32_16x16x32_bf16 v[64:67], a[12:15], v[112:115], v[64:67]
    ds_read_b128 v[112:115], v0 offset:13312
    v_mfma_f32_16x16x32_bf16 v[68:71], a[8:11], v[116:119], v[68:71]
    v_mfma_f32_16x16x32_bf16 v[72:75], a[12:15], v[116:119], v[72:75]
    ds_read_b128 v[116:119], v0 offset:14336
    s_waitcnt lgkmcnt(3)
    v_mfma_f32_16x16x32_bf16 v[76:79], a[8:11], v[120:123], v[76:79]
    buffer_load_dwordx4 a[40:43], v0, s[4:7], s52 offen offset:1024 sc1
    v_mfma_f32_16x16x32_bf16 v[80:83], a[12:15], v[120:123], v[80:83]
    ds_read_b128 v[120:123], v0 offset:15360
    s_waitcnt vmcnt(6)
    v_mfma_f32_16x16x32_bf16 v[44:47], a[16:19], v[124:127], v[44:47]
    s_add_u32 s19, s19, 1
    v_mov_b32 v41, s19
    v_mov_b32 v42, 0
    s_mov_b64 exec, 1
    s_waitcnt vmcnt(5)
    s_cmp_eq_u32 s18, 0
    s_cbranch_scc1 interleave_layers__linear_attn_block__geglu_ffn__prompt_kernel_fl85_slow
    buffer_store_dword v41, v42, s[4:7], s40 offen
interleave_layers__linear_attn_block__geglu_ffn__prompt_kernel_fl85_join:
    s_mov_b64 exec, -1
    v_mfma_f32_16x16x32_bf16 v[48:51], a[20:23], v[124:127], v[48:51]
    ds_read_b128 v[124:127], v0 offset:16384
    v_mfma_f32_16x16x32_bf16 v[52:55], a[16:19], v[128:131], v[52:55]
    v_mfma_f32_16x16x32_bf16 v[56:59], a[20:23], v[128:131], v[56:59]
    ds_read_b128 v[128:131], v0 offset:17408
    s_waitcnt lgkmcnt(3)
    v_mfma_f32_16x16x32_bf16 v[60:63], a[16:19], v[108:111], v[60:63]
    buffer_load_dwordx4 a[44:47], v14, s[4:7], s52 offen offset:1024 sc1
    v_mfma_f32_16x16x32_bf16 v[64:67], a[20:23], v[108:111], v[64:67]
    ds_read_b128 v[108:111], v0 offset:18432
    v_mfma_f32_16x16x32_bf16 v[68:71], a[16:19], v[112:115], v[68:71]
    v_mfma_f32_16x16x32_bf16 v[72:75], a[20:23], v[112:115], v[72:75]
    ds_read_b128 v[112:115], v0 offset:19456
    v_mfma_f32_16x16x32_bf16 v[76:79], a[16:19], v[116:119], v[76:79]
    buffer_load_dword v38, v31, s[4:7], s41 offen sc1
    v_mfma_f32_16x16x32_bf16 v[80:83], a[20:23], v[116:119], v[80:83]
    ds_read_b128 v[116:119], v0 offset:20480
    buffer_load_dwordx4 a[48:51], v0, s[4:7], s52 offen offset:2048 sc1
    s_waitcnt vmcnt(7) lgkmcnt(3)
    v_mfma_f32_16x16x32_bf16 v[44:47], a[24:27], v[120:123], v[44:47]
    v_mfma_f32_16x16x32_bf16 v[48:51], a[28:31], v[120:123], v[48:51]
    ds_read_b128 v[120:123], v0 offset:21504
    v_mfma_f32_16x16x32_bf16 v[52:55], a[24:27], v[124:127], v[52:55]
    v_mfma_f32_16x16x32_bf16 v[56:59], a[28:31], v[124:127], v[56:59]
    ds_read_b128 v[124:127], v0 offset:22528
    v_mfma_f32_16x16x32_bf16 v[60:63], a[24:27], v[128:131], v[60:63]
    buffer_load_dwordx4 a[52:55], v14, s[4:7], s52 offen offset:2048 sc1
    v_mfma_f32_16x16x32_bf16 v[64:67], a[28:31], v[128:131], v[64:67]
    ds_read_b128 v[128:131], v0 offset:23552
    s_waitcnt lgkmcnt(3)
    v_mfma_f32_16x16x32_bf16 v[68:71], a[24:27], v[108:111], v[68:71]
    v_mfma_f32_16x16x32_bf16 v[72:75], a[28:31], v[108:111], v[72:75]
    ds_read_b128 v[108:111], v0 offset:24576
    v_mfma_f32_16x16x32_bf16 v[76:79], a[24:27], v[112:115], v[76:79]
    buffer_load_dwordx4 a[56:59], v0, s[4:7], s52 offen offset:3072 sc1
    v_mfma_f32_16x16x32_bf16 v[80:83], a[28:31], v[112:115], v[80:83]
    ds_read_b128 v[112:115], v0 offset:25600
    s_waitcnt vmcnt(7)
    v_mfma_f32_16x16x32_bf16 v[44:47], a[32:35], v[116:119], v[44:47]
    v_mfma_f32_16x16x32_bf16 v[48:51], a[36:39], v[116:119], v[48:51]
    ds_read_b128 v[116:119], v0 offset:26624
    s_waitcnt lgkmcnt(3)
    v_mfma_f32_16x16x32_bf16 v[52:55], a[32:35], v[120:123], v[52:55]
    v_mfma_f32_16x16x32_bf16 v[56:59], a[36:39], v[120:123], v[56:59]
    ds_read_b128 v[120:123], v0 offset:27648
    v_mfma_f32_16x16x32_bf16 v[60:63], a[32:35], v[124:127], v[60:63]
    buffer_load_dwordx4 a[60:63], v14, s[4:7], s52 offen offset:3072 sc1
    v_mfma_f32_16x16x32_bf16 v[64:67], a[36:39], v[124:127], v[64:67]
    ds_read_b128 v[124:127], v0 offset:28672
    v_mfma_f32_16x16x32_bf16 v[68:71], a[32:35], v[128:131], v[68:71]
    v_mfma_f32_16x16x32_bf16 v[72:75], a[36:39], v[128:131], v[72:75]
    ds_read_b128 v[128:131], v0 offset:29696
    s_waitcnt lgkmcnt(3)
    v_mfma_f32_16x16x32_bf16 v[76:79], a[32:35], v[108:111], v[76:79]
    s_waitcnt vmcnt(4)
    v_subrev_u32 v38, s19, v38
    v_cmp_lt_u32 vcc, 12, v38
    s_nop 1
    s_and_b64 vcc, vcc, s[70:71]
    s_cbranch_scc1 interleave_layers__linear_attn_block__geglu_ffn__prompt_kernel_aspin87
interleave_layers__linear_attn_block__geglu_ffn__prompt_kernel_adone86:
    v_mfma_f32_16x16x32_bf16 v[80:83], a[36:39], v[108:111], v[80:83]
    ds_read_b128 v[108:111], v0 offset:30720
    s_add_u32 s52, s24, 8192
    buffer_load_dwordx4 a[64:67], v0, s[4:7], s52 offen offset:0 sc1
    v_mfma_f32_16x16x32_bf16 v[44:47], a[40:43], v[112:115], v[44:47]
    buffer_load_dwordx4 a[68:71], v14, s[4:7], s52 offen offset:0 sc1
    v_mfma_f32_16x16x32_bf16 v[48:51], a[44:47], v[112:115], v[48:51]
    ds_read_b128 v[112:115], v0 offset:31744
    v_mfma_f32_16x16x32_bf16 v[52:55], a[40:43], v[116:119], v[52:55]
    v_mfma_f32_16x16x32_bf16 v[56:59], a[44:47], v[116:119], v[56:59]
    ds_read_b128 v[116:119], v0 offset:32768
    s_waitcnt lgkmcnt(3)
    v_mfma_f32_16x16x32_bf16 v[60:63], a[40:43], v[120:123], v[60:63]
    s_add_u32 s54, s20, 81920
    s_add_u32 m0, s73, 81920
    s_nop 0
    buffer_load_dwordx4 v0, s[44:47], s54 offen offset:0 sc1 lds
    v_mfma_f32_16x16x32_bf16 v[64:67], a[44:47], v[120:123], v[64:67]
    ds_read_b128 v[120:123], v0 offset:33792
    buffer_load_dwordx4 a[72:75], v0, s[4:7], s52 offen offset:1024 sc1
    v_mfma_f32_16x16x32_bf16 v[68:71], a[40:43], v[124:127], v[68:71]
    v_mfma_f32_16x16x32_bf16 v[72:75], a[44:47], v[124:127], v[72:75]
    ds_read_b128 v[124:127], v0 offset:34816
    v_mfma_f32_16x16x32_bf16 v[76:79], a[40:43], v[128:131], v[76:79]
    buffer_load_dwordx4 a[76:79], v14, s[4:7], s52 offen offset:1024 sc1
    v_mfma_f32_16x16x32_bf16 v[80:83], a[44:47], v[128:131], v[80:83]
    ds_read_b128 v[128:131], v0 offset:35840
    s_waitcnt vmcnt(7) lgkmcnt(3)
    v_mfma_f32_16x16x32_bf16 v[44:47], a[48:51], v[108:111], v[44:47]
    buffer_load_dwordx4 v[132:135], v16, s[4:7], s26 offen offset:0 sc1
    buffer_load_dwordx4 v[136:139], v16, s[4:7], s26 offen offset:256 sc1
    v_mfma_f32_16x16x32_bf16 v[48:51], a[52:55], v[108:111], v[48:51]
    ds_read_b128 v[108:111], v0 offset:36864
    v_mfma_f32_16x16x32_bf16 v[52:55], a[48:51], v[112:115], v[52:55]
    v_mfma_f32_16x16x32_bf16 v[56:59], a[52:55], v[112:115], v[56:59]
    ds_read_b128 v[112:115], v0 offset:37888
    v_mfma_f32_16x16x32_bf16 v[60:63], a[48:51], v[116:119], v[60:63]
    buffer_load_dwordx4 v0, s[44:47], s54 offen offset:1024 sc1 lds
    v_mfma_f32_16x16x32_bf16 v[64:67], a[52:55], v[116:119], v[64:67]
    ds_read_b128 v[116:119], v0 offset:38912
    buffer_load_dwordx4 a[80:83], v0, s[4:7], s52 offen offset:2048 sc1
    s_waitcnt lgkmcnt(3)
    v_mfma_f32_16x16x32_bf16 v[68:71], a[48:51], v[120:123], v[68:71]
    v_mfma_f32_16x16x32_bf16 v[72:75], a[52:55], v[120:123], v[72:75]
    ds_read_b128 v[120:123], v0 offset:39936
    v_mfma_f32_16x16x32_bf16 v[76:79], a[48:51], v[124:127], v[76:79]
    buffer_load_dwordx4 a[84:87], v14, s[4:7], s52 offen offset:2048 sc1
    v_mfma_f32_16x16x32_bf16 v[80:83], a[52:55], v[124:127], v[80:83]
    ds_read_b128 v[124:127], v0 offset:40960
    s_waitcnt vmcnt(10)
    v_mfma_f32_16x16x32_bf16 v[44:47], a[56:59], v[128:131], v[44:47]
    v_mfma_f32_16x16x32_bf16 v[48:51], a[60:63], v[128:131], v[48:51]
    ds_read_b128 v[128:131], v0 offset:41984
    s_waitcnt lgkmcnt(3)
    v_mfma_f32_16x16x32_bf16 v[52:55], a[56:59], v[108:111], v[52:55]
    v_mfma_f32_16x16x32_bf16 v[56:59], a[60:63], v[108:111], v[56:59]
    ds_read_b128 v[108:111], v0 offset:43008
    v_mfma_f32_16x16x32_bf16 v[60:63], a[56:59], v[112:115], v[60:63]
    buffer_load_dwordx4 v0, s[44:47], s54 offen offset:2048 sc1 lds
    v_mfma_f32_16x16x32_bf16 v[64:67], a[60:63], v[112:115], v[64:67]
    ds_read_b128 v[112:115], v0 offset:44032
    buffer_load_dwordx4 a[88:91], v0, s[4:7], s52 offen offset:3072 sc1
    v_mfma_f32_16x16x32_bf16 v[68:71], a[56:59], v[116:119], v[68:71]
    v_mfma_f32_16x16x32_bf16 v[72:75], a[60:63], v[116:119], v[72:75]
    ds_read_b128 v[116:119], v0 offset:45056
    s_waitcnt lgkmcnt(3)
    v_mfma_f32_16x16x32_bf16 v[76:79], a[56:59], v[120:123], v[76:79]
    buffer_load_dwordx4 a[92:95], v14, s[4:7], s52 offen offset:3072 sc1
    v_mfma_f32_16x16x32_bf16 v[80:83], a[60:63], v[120:123], v[80:83]
    ds_read_b128 v[120:123], v0 offset:46080
    s_waitcnt vmcnt(11)
    s_barrier
    v_mfma_f32_16x16x32_bf16 v[44:47], a[64:67], v[124:127], v[44:47]
    v_mfma_f32_16x16x32_bf16 v[48:51], a[68:71], v[124:127], v[48:51]
    ds_read_b128 v[124:127], v0 offset:47104
    v_mfma_f32_16x16x32_bf16 v[52:55], a[64:67], v[128:131], v[52:55]
    v_mfma_f32_16x16x32_bf16 v[56:59], a[68:71], v[128:131], v[56:59]
    ds_read_b128 v[128:131], v0 offset:48128
    s_waitcnt lgkmcnt(3)
    v_mfma_f32_16x16x32_bf16 v[60:63], a[64:67], v[108:111], v[60:63]
    buffer_load_dwordx4 v0, s[44:47], s54 offen offset:3072 sc1 lds
    v_mfma_f32_16x16x32_bf16 v[64:67], a[68:71], v[108:111], v[64:67]
    ds_read_b128 v[108:111], v0 offset:49152
    s_add_u32 s52, s24, 12288
    buffer_load_dwordx4 a[96:99], v0, s[4:7], s52 offen offset:0 sc1
    v_mfma_f32_16x16x32_bf16 v[68:71], a[64:67], v[112:115], v[68:71]
    v_mfma_f32_16x16x32_bf16 v[72:75], a[68:71], v[112:115], v[72:75]
    ds_read_b128 v[112:115], v0 offset:50176
    v_mfma_f32_16x16x32_bf16 v[76:79], a[64:67], v[116:119], v[76:79]
    buffer_load_dwordx4 a[100:103], v14, s[4:7], s52 offen offset:0 sc1
    s_waitcnt vmcnt(9)
    v_mfma_f32_16x16x32_bf16 v[80:83], a[68:71], v[116:119], v[80:83]
    ds_read_b128 v[116:119], v0 offset:51200
    v_pk_add_f32 v[132:133], v[132:133], v[134:135]
    s_waitcnt lgkmcnt(3)
    v_mfma_f32_16x16x32_bf16 v[44:47], a[72:75], v[120:123], v[44:47]
    v_pk_add_f32 v[136:137], v[136:137], v[138:139]
    v_mfma_f32_16x16x32_bf16 v[48:51], a[76:79], v[120:123], v[48:51]
    ds_read_b128 v[120:123], v0 offset:52224
    v_mfma_f32_16x16x32_bf16 v[52:55], a[72:75], v[124:127], v[52:55]
    v_mov_b32 v134, v132
    v_mfma_f32_16x16x32_bf16 v[56:59], a[76:79], v[124:127], v[56:59]
    ds_read_b128 v[124:127], v0 offset:53248
    v_mfma_f32_16x16x32_bf16 v[60:63], a[72:75], v[128:131], v[60:63]
    s_add_u32 s54, s20, 98304
    s_add_u32 m0, s73, 98304
    s_nop 0
    buffer_load_dwordx4 v0, s[44:47], s54 offen offset:0 sc1 lds
    buffer_load_dwordx4 a[104:107], v0, s[4:7], s52 offen offset:1024 sc1
    v_mfma_f32_16x16x32_bf16 v[64:67], a[76:79], v[128:131], v[64:67]
    ds_read_b128 v[128:131], v0 offset:54272
    v_mov_b32 v135, v133
    s_waitcnt lgkmcnt(3)
    v_mfma_f32_16x16x32_bf16 v[68:71], a[72:75], v[108:111], v[68:71]
    v_mov_b32 v138, v136
    v_mfma_f32_16x16x32_bf16 v[72:75], a[76:79], v[108:111], v[72:75]
    ds_read_b128 v[108:111], v0 offset:55296
    v_mfma_f32_16x16x32_bf16 v[76:79], a[72:75], v[112:115], v[76:79]
    buffer_load_dwordx4 a[108:111], v14, s[4:7], s52 offen offset:1024 sc1
    v_mfma_f32_16x16x32_bf16 v[80:83], a[76:79], v[112:115], v[80:83]
    ds_read_b128 v[112:115], v0 offset:56320
    v_mov_b32 v139, v137
    s_waitcnt vmcnt(9)
    v_mfma_f32_16x16x32_bf16 v[44:47], a[80:83], v[116:119], v[44:47]
    v_permlane16_swap_b32 v132, v134
    v_mfma_f32_16x16x32_bf16 v[48:51], a[84:87], v[116:119], v[48:51]
    ds_read_b128 v[116:119], v0 offset:57344
    s_waitcnt lgkmcnt(3)
    v_mfma_f32_16x16x32_bf16 v[52:55], a[80:83], v[120:123], v[52:55]
    buffer_load_dwordx4 a[112:115], v0, s[4:7], s52 offen offset:2048 sc1
    v_mfma_f32_16x16x32_bf16 v[56:59], a[84:87], v[120:123], v[56:59]
    ds_read_b128 v[120:123], v0 offset:58368
    v_permlane16_swap_b32 v133, v135
    v_mfma_f32_16x16x32_bf16 v[60:63], a[80:83], v[124:127], v[60:63]
    buffer_load_dwordx4 v0, s[44:47], s54 offen offset:1024 sc1 lds
    v_mfma_f32_16x16x32_bf16 v[64:67], a[84:87], v[124:127], v[64:67]
    ds_read_b128 v[124:127], v0 offset:59392
    v_permlane16_swap_b32 v136, v138
    v_mfma_f32_16x16x32_bf16 v[68:71], a[80:83], v[128:131], v[68:71]
    v_permlane16_swap_b32 v137, v139
    v_mfma_f32_16x16x32_bf16 v[72:75], a[84:87], v[128:131], v[72:75]
    ds_read_b128 v[128:131], v0 offset:60416
    v_add_f32 v132, v132, v134
    s_waitcnt lgkmcnt(3)
    v_mfma_f32_16x16x32_bf16 v[76:79], a[80:83], v[108:111], v[76:79]
    buffer_load_dwordx4 a[116:119], v14, s[4:7], s52 offen offset:2048 sc1
    v_mfma_f32_16x16x32_bf16 v[80:83], a[84:87], v[108:111], v[80:83]
    ds_read_b128 v[108:111], v0 offset:61440
    v_add_f32 v133, v133, v135
    s_waitcnt vmcnt(9)
    v_mfma_f32_16x16x32_bf16 v[44:47], a[88:91], v[112:115], v[44:47]
    v_add_f32 v136, v136, v138
    v_mfma_f32_16x16x32_bf16 v[48:51], a[92:95], v[112:115], v[48:51]
    ds_read_b128 v[112:115], v0 offset:62464
    v_mfma_f32_16x16x32_bf16 v[52:55], a[88:91], v[116:119], v[52:55]
    buffer_load_dwordx4 a[120:123], v0, s[4:7], s52 offen offset:3072 sc1
    v_mfma_f32_16x16x32_bf16 v[56:59], a[92:95], v[116:119], v[56:59]
    ds_read_b128 v[116:119], v0 offset:63488
    v_add_f32 v137, v137, v139
    s_waitcnt lgkmcnt(3)
    v_mfma_f32_16x16x32_bf16 v[60:63], a[88:91], v[120:123], v[60:63]
    buffer_load_dwordx4 v0, s[44:47], s54 offen offset:2048 sc1 lds
    v_mfma_f32_16x16x32_bf16 v[64:67], a[92:95], v[120:123], v[64:67]
    ds_read_b128 v[120:123], v0 offset:64512
    v_mov_b32 v134, v132
    v_mfma_f32_16x16x32_bf16 v[68:71], a[88:91], v[124:127], v[68:71]
    v_mov_b32 v135, v133
    v_mfma_f32_16x16x32_bf16 v[72:75], a[92:95], v[124:127], v[72:75]
    ds_read_b128 v[124:127], v2 offset:0
    v_mfma_f32_16x16x32_bf16 v[76:79], a[88:91], v[128:131], v[76:79]
    buffer_load_dwordx4 a[124:127], v14, s[4:7], s52 offen offset:3072 sc1
    v_mfma_f32_16x16x32_bf16 v[80:83], a[92:95], v[128:131], v[80:83]
    ds_read_b128 v[128:131], v2 offset:1024
    v_mov_b32 v138, v136
    s_waitcnt vmcnt(9) lgkmcnt(3)
    v_mfma_f32_16x16x32_bf16 v[44:47], a[96:99], v[108:111], v[44:47]
    v_mov_b32 v139, v137
    v_mfma_f32_16x16x32_bf16 v[48:51], a[100:103], v[108:111], v[48:51]
    ds_read_b128 v[108:111], v2 offset:2048
    v_mfma_f32_16x16x32_bf16 v[52:55], a[96:99], v[112:115], v[52:55]
    s_add_u32 s52, s24, 16384
    buffer_load_dwordx4 a[128:131], v0, s[4:7], s52 offen offset:0 sc1
    v_mfma_f32_16x16x32_bf16 v[56:59], a[100:103], v[112:115], v[56:59]
    ds_read_b128 v[112:115], v2 offset:3072
    v_permlane32_swap_b32 v132, v134
    v_mfma_f32_16x16x32_bf16 v[60:63], a[96:99], v[116:119], v[60:63]
    buffer_load_dwordx4 v0, s[44:47], s54 offen offset:3072 sc1 lds
    v_permlane32_swap_b32 v133, v135
    v_mfma_f32_16x16x32_bf16 v[64:67], a[100:103], v[116:119], v[64:67]
    ds_read_b128 v[116:119], v2 offset:4096
    v_permlane32_swap_b32 v136, v138
    s_waitcnt lgkmcnt(3)
    v_mfma_f32_16x16x32_bf16 v[68:71], a[96:99], v[120:123], v[68:71]
    v_permlane32_swap_b32 v137, v139
    v_mfma_f32_16x16x32_bf16 v[72:75], a[100:103], v[120:123], v[72:75]
    ds_read_b128 v[120:123], v2 offset:5120
    v_mfma_f32_16x16x32_bf16 v[76:79], a[96:99], v[124:127], v[76:79]
    buffer_load_dwordx4 a[132:135], v14, s[4:7], s52 offen offset:0 sc1
    v_mfma_f32_16x16x32_bf16 v[80:83], a[100:103], v[124:127], v[80:83]
    ds_read_b128 v[124:127], v2 offset:6144
    v_add_f32 v132, v132, v134
    s_waitcnt vmcnt(9)
    v_mfma_f32_16x16x32_bf16 v[44:47], a[104:107], v[128:131], v[44:47]
    v_add_f32 v133, v133, v135
    v_mfma_f32_16x16x32_bf16 v[48:51], a[108:111], v[128:131], v[48:51]
    ds_read_b128 v[128:131], v2 offset:7168
    s_waitcnt lgkmcnt(3)
    v_mfma_f32_16x16x32_bf16 v[52:55], a[104:107], v[108:111], v[52:55]
    buffer_load_dwordx4 a[136:139], v0, s[4:7], s52 offen offset:1024 sc1
    v_mfma_f32_16x16x32_bf16 v[56:59], a[108:111], v[108:111], v[56:59]
    ds_read_b128 v[108:111], v2 offset:8192
    v_add_f32 v136, v136, v138
    v_mfma_f32_16x16x32_bf16 v[60:63], a[104:107], v[112:115], v[60:63]
    s_add_u32 s54, s20, 114688
    s_add_u32 m0, s73, 114688
    s_nop 0
    buffer_load_dwordx4 v0, s[44:47], s54 offen offset:0 sc1 lds
    v_mfma_f32_16x16x32_bf16 v[64:67], a[108:111], v[112:115], v[64:67]
    ds_read_b128 v[112:115], v2 offset:9216
    v_add_f32 v137, v137, v139
    v_mfma_f32_16x16x32_bf16 v[68:71], a[104:107], v[116:119], v[68:71]
    v_mul_f32 v135, 0x3acccccd, v133
    v_mfma_f32_16x16x32_bf16 v[72:75], a[108:111], v[116:119], v[72:75]
    ds_read_b128 v[116:119], v2 offset:10240
    s_waitcnt lgkmcnt(3)
    v_mfma_f32_16x16x32_bf16 v[76:79], a[104:107], v[120:123], v[76:79]
    buffer_load_dwordx4 a[140:143], v14, s[4:7], s52 offen offset:1024 sc1
    v_mfma_f32_16x16x32_bf16 v[80:83], a[108:111], v[120:123], v[80:83]
    ds_read_b128 v[120:123], v2 offset:11264
    v_mul_f32 v133, 0xbacccccd, v132
    s_waitcnt vmcnt(9)
    v_mfma_f32_16x16x32_bf16 v[44:47], a[112:115], v[124:127], v[44:47]
    v_mul_f32 v139, 0x3acccccd, v137
    v_mfma_f32_16x16x32_bf16 v[48:51], a[116:119], v[124:127], v[48:51]
    ds_read_b128 v[124:127], v2 offset:12288
    v_mfma_f32_16x16x32_bf16 v[52:55], a[112:115], v[128:131], v[52:55]
    buffer_load_dwordx4 a[144:147], v0, s[4:7], s52 offen offset:2048 sc1
    v_mul_f32 v137, 0xbacccccd, v136
    v_mfma_f32_16x16x32_bf16 v[56:59], a[116:119], v[128:131], v[56:59]
    ds_read_b128 v[128:131], v2 offset:13312
    v_fma_f32 v135, -v133, v133, v135
    s_waitcnt lgkmcnt(3)
    v_mfma_f32_16x16x32_bf16 v[60:63], a[112:115], v[108:111], v[60:63]
    buffer_load_dwordx4 v0, s[44:47], s54 offen offset:1024 sc1 lds
    v_mfma_f32_16x16x32_bf16 v[64:67], a[116:119], v[108:111], v[64:67]
    ds_read_b128 v[108:111], v2 offset:14336
    v_fma_f32 v139, -v137, v137, v139
    v_mfma_f32_16x16x32_bf16 v[68:71], a[112:115], v[112:115], v[68:71]
    v_max_f32 v135, 0, v135
    v_mfma_f32_16x16x32_bf16 v[72:75], a[116:119], v[112:115], v[72:75]
    ds_read_b128 v[112:115], v2 offset:15360
    v_mfma_f32_16x16x32_bf16 v[76:79], a[112:115], v[116:119], v[76:79]
    buffer_load_dwordx4 a[148:151], v14, s[4:7], s52 offen offset:2048 sc1
    v_mfma_f32_16x16x32_bf16 v[80:83], a[116:119], v[116:119], v[80:83]
    s_barrier
    ds_read_b128 v[116:119], v2 offset:16384
    v_max_f32 v139, 0, v139
    s_waitcnt vmcnt(9) lgkmcnt(3)
    v_mfma_f32_16x16x32_bf16 v[44:47], a[120:123], v[120:123], v[44:47]
    v_add_f32 v135, 0x3727c5ac, v135
    v_mfma_f32_16x16x32_bf16 v[48:51], a[124:127], v[120:123], v[48:51]
    ds_read_b128 v[120:123], v2 offset:17408
    v_mfma_f32_16x16x32_bf16 v[52:55], a[120:123], v[124:127], v[52:55]
    buffer_load_dwordx4 a[152:155], v0, s[4:7], s52 offen offset:3072 sc1
    v_mfma_f32_16x16x32_bf16 v[56:59], a[124:127], v[124:127], v[56:59]
    ds_read_b128 v[124:127], v2 offset:18432
    v_add_f32 v139, 0x3727c5ac, v139
    v_mfma_f32_16x16x32_bf16 v[60:63], a[120:123], v[128:131], v[60:63]
    buffer_load_dwordx4 v0, s[44:47], s54 offen offset:2048 sc1 lds
    v_mfma_f32_16x16x32_bf16 v[64:67], a[124:127], v[128:131], v[64:67]
    ds_read_b128 v[128:131], v2 offset:19456
    v_rsq_f32 v132, v135
    s_waitcnt lgkmcnt(3)
    v_mfma_f32_16x16x32_bf16 v[68:71], a[120:123], v[108:111], v[68:71]
    buffer_load_dwordx4 a[156:159], v14, s[4:7], s52 offen offset:3072 sc1
    v_mfma_f32_16x16x32_bf16 v[72:75], a[124:127], v[108:111], v[72:75]
    ds_read_b128 v[108:111], v2 offset:20480
    v_rsq_f32 v136, v139
    v_mfma_f32_16x16x32_bf16 v[76:79], a[120:123], v[112:115], v[76:79]
    s_mov_b32 s92, 0xffff0000
    v_mfma_f32_16x16x32_bf16 v[80:83], a[124:127], v[112:115], v[80:83]
    ds_read_b128 v[112:115], v2 offset:21504
    s_waitcnt vmcnt(9)
    v_mfma_f32_16x16x32_bf16 v[44:47], a[128:131], v[116:119], v[44:47]
    s_mov_b32 s93, 0xffff0000
    v_mfma_f32_16x16x32_bf16 v[48:51], a[132:135], v[116:119], v[48:51]
    ds_read_b128 v[116:119], v2 offset:22528
    v_cndmask_b32 v135, v132, v136, s[92:93]
    s_waitcnt lgkmcnt(3)
    v_mfma_f32_16x16x32_bf16 v[52:55], a[128:131], v[120:123], v[52:55]
    v_cndmask_b32 v139, v133, v137, s[92:93]
    v_mfma_f32_16x16x32_bf16 v[56:59], a[132:135], v[120:123], v[56:59]
    ds_read_b128 v[120:123], v2 offset:23552
    v_mfma_f32_16x16x32_bf16 v[60:63], a[128:131], v[124:127], v[60:63]
    buffer_load_dwordx4 v0, s[44:47], s54 offen offset:3072 sc1 lds
    v_mfma_f32_16x16x32_bf16 v[64:67], a[132:135], v[124:127], v[64:67]
    ds_read_b128 v[124:127], v2 offset:24576
    s_mov_b32 s92, 0x0
    v_mfma_f32_16x16x32_bf16 v[68:71], a[128:131], v[128:131], v[68:71]
    s_mov_b32 s93, 0xffffffff
    v_mfma_f32_16x16x32_bf16 v[72:75], a[132:135], v[128:131], v[72:75]
    ds_read_b128 v[128:131], v2 offset:25600
    s_waitcnt lgkmcnt(3)
    v_mfma_f32_16x16x32_bf16 v[76:79], a[128:131], v[108:111], v[76:79]
    v_cndmask_b32 v135, v135, v139, s[92:93]
    v_mfma_f32_16x16x32_bf16 v[80:83], a[132:135], v[108:111], v[80:83]
    ds_read_b128 v[108:111], v2 offset:26624
    s_waitcnt vmcnt(7)
    v_mfma_f32_16x16x32_bf16 v[44:47], a[136:139], v[112:115], v[44:47]
    ds_write_b32 v25, v135
    v_mfma_f32_16x16x32_bf16 v[48:51], a[140:143], v[112:115], v[48:51]
    ds_read_b128 v[112:115], v2 offset:27648
    v_mfma_f32_16x16x32_bf16 v[52:55], a[136:139], v[116:119], v[52:55]
    ds_read_b128 v[140:143], v26 offset:0
    v_mfma_f32_16x16x32_bf16 v[56:59], a[140:143], v[116:119], v[56:59]
    ds_read_b128 v[116:119], v2 offset:28672
    s_waitcnt lgkmcnt(5)
    v_mfma_f32_16x16x32_bf16 v[60:63], a[136:139], v[120:123], v[60:63]
    ds_read_b128 v[148:151], v26 offset:128
    v_mfma_f32_16x16x32_bf16 v[64:67], a[140:143], v[120:123], v[64:67]
    ds_read_b128 v[120:123], v2 offset:29696
    v_mfma_f32_16x16x32_bf16 v[68:71], a[136:139], v[124:127], v[68:71]
    ds_read_b128 v[144:147], v26 offset:64
    v_mfma_f32_16x16x32_bf16 v[72:75], a[140:143], v[124:127], v[72:75]
    ds_read_b128 v[124:127], v2 offset:30720
    v_mfma_f32_16x16x32_bf16 v[76:79], a[136:139], v[128:131], v[76:79]
    ds_read_b128 v[152:155], v26 offset:192
    v_mfma_f32_16x16x32_bf16 v[80:83], a[140:143], v[128:131], v[80:83]
    ds_read_b128 v[128:131], v2 offset:31744
    s_mov_b32 s92, 0x800080
    s_waitcnt vmcnt(4) lgkmcnt(6)
    v_mfma_f32_16x16x32_bf16 v[44:47], a[144:147], v[108:111], v[44:47]
    buffer_load_dword v43, v34, s[4:7], s28 offen sc1
    v_mfma_f32_16x16x32_bf16 v[48:51], a[148:151], v[108:111], v[48:51]
    ds_read_b128 v[108:111], v2 offset:32768
    s_mov_b32 s93, 0x800080
    v_mfma_f32_16x16x32_bf16 v[52:55], a[144:147], v[112:115], v[52:55]
    v_add_u32 v104, 1680, v17
    v_mfma_f32_16x16x32_bf16 v[56:59], a[148:151], v[112:115], v[56:59]
    ds_read_b128 v[112:115], v2 offset:33792
    v_mfma_f32_16x16x32_bf16 v[60:63], a[144:147], v[116:119], v[60:63]
    v_add_u32 v106, 2000, v17
    v_mfma_f32_16x16x32_bf16 v[64:67], a[148:151], v[116:119], v[64:67]
    s_barrier
    ds_read_b128 v[116:119], v2 offset:34816
    ds_read_b32 v156, v27 offset:0
    s_waitcnt lgkmcnt(4)
    v_mfma_f32_16x16x32_bf16 v[68:71], a[144:147], v[120:123], v[68:71]
    v_cndmask_b32 v104, v17, v104, s[92:93]
    v_mfma_f32_16x16x32_bf16 v[72:75], a[148:151], v[120:123], v[72:75]
    ds_read_b128 v[120:123], v2 offset:35840
    ds_read_b32 v157, v27 offset:64
    v_mfma_f32_16x16x32_bf16 v[76:79], a[144:147], v[124:127], v[76:79]
    v_cndmask_b32 v106, v17, v106, s[92:93]
    v_mfma_f32_16x16x32_bf16 v[80:83], a[148:151], v[124:127], v[80:83]
    ds_read_b32 v158, v27 offset:128
    s_waitcnt vmcnt(2)
    v_mfma_f32_16x16x32_bf16 v[44:47], a[152:155], v[128:131], v[44:47]
    s_mov_b32 s92, 0x800000
    v_mfma_f32_16x16x32_bf16 v[48:51], a[156:159], v[128:131], v[48:51]
    ds_read_b32 v159, v27 offset:192
    s_waitcnt lgkmcnt(5)
    v_mfma_f32_16x16x32_bf16 v[52:55], a[152:155], v[108:111], v[52:55]
    v_add_u32 v105, 1600, v104
    v_mfma_f32_16x16x32_bf16 v[56:59], a[156:159], v[108:111], v[56:59]
    ds_read_b32 v160, v27 offset:256
    v_mfma_f32_16x16x32_bf16 v[60:63], a[152:155], v[112:115], v[60:63]
    v_cndmask_b32 v105, v104, v105, s[92:93]
    v_mfma_f32_16x16x32_bf16 v[64:67], a[156:159], v[112:115], v[64:67]
    v_mfma_f32_16x16x32_bf16 v[68:71], a[152:155], v[116:119], v[68:71]
    v_mfma_f32_16x16x32_bf16 v[72:75], a[156:159], v[116:119], v[72:75]
    s_waitcnt lgkmcnt(4)
    v_mfma_f32_16x16x32_bf16 v[76:79], a[152:155], v[120:123], v[76:79]
    v_mfma_f32_16x16x32_bf16 v[80:83], a[156:159], v[120:123], v[80:83]
    s_waitcnt vmcnt(1)
    s_nop 6
    s_branch interleave_layers__linear_attn_block__geglu_ffn__prompt_kernel_merge
interleave_layers__linear_attn_block__geglu_ffn__prompt_kernel_last71:
    s_mul_i32 s39, s12, 163840
    s_mul_i32 s55, s15, 81920
    s_add_u32 s39, s39, s55
    s_mul_i32 s55, s14, 20480
    s_add_u32 s39, s39, s55
    s_mul_i32 s55, s16, 160
    s_add_u32 s39, s39, s55
    s_waitcnt vmcnt(9)
    s_waitcnt vmcnt(7)
    v_mfma_f32_16x16x32_bf16 v[44:47], v[184:187], a[40:43], 0
    s_add_u32 s52, s34, 8192
    buffer_load_dwordx4 a[64:67], v0, s[4:7], s52 offen offset:1024 sc1
    v_mfma_f32_16x16x32_bf16 v[48:51], v[188:191], a[40:43], 0
    v_mfma_f32_16x16x32_bf16 v[52:55], v[192:195], a[40:43], 0
    v_mfma_f32_16x16x32_bf16 v[56:59], v[196:199], a[40:43], 0
    v_mfma_f32_16x16x32_bf16 v[60:63], v[200:203], a[40:43], 0
    buffer_load_dwordx4 a[68:71], v0, s[4:7], s52 offen offset:2048 sc1
    s_waitcnt vmcnt(8)
    v_mfma_f32_16x16x32_bf16 v[44:47], v[204:207], a[44:47], v[44:47]
    v_mfma_f32_16x16x32_bf16 v[48:51], v[208:211], a[44:47], v[48:51]
    v_mfma_f32_16x16x32_bf16 v[52:55], v[212:215], a[44:47], v[52:55]
    v_mfma_f32_16x16x32_bf16 v[56:59], v[216:219], a[44:47], v[56:59]
    v_mfma_f32_16x16x32_bf16 v[60:63], v[220:223], a[44:47], v[60:63]
    buffer_load_dwordx4 a[72:75], v0, s[4:7], s35 offen offset:0 sc1
    s_waitcnt vmcnt(8)
    v_mfma_f32_16x16x32_bf16 v[44:47], v[224:227], a[48:51], v[44:47]
    v_mfma_f32_16x16x32_bf16 v[48:51], v[228:231], a[48:51], v[48:51]
    v_mfma_f32_16x16x32_bf16 v[52:55], v[232:235], a[48:51], v[52:55]
    v_mfma_f32_16x16x32_bf16 v[56:59], v[236:239], a[48:51], v[56:59]
    v_mfma_f32_16x16x32_bf16 v[60:63], v[240:243], a[48:51], v[60:63]
    buffer_load_dwordx4 a[76:79], v0, s[4:7], s35 offen offset:1024 sc1
    s_waitcnt vmcnt(8)
    v_mfma_f32_16x16x32_bf16 v[44:47], v[244:247], a[52:55], v[44:47]
    v_mfma_f32_16x16x32_bf16 v[48:51], v[248:251], a[52:55], v[48:51]
    v_mfma_f32_16x16x32_bf16 v[52:55], v[180:183], a[52:55], v[52:55]
    v_mfma_f32_16x16x32_bf16 v[56:59], v[176:179], a[52:55], v[56:59]
    v_mfma_f32_16x16x32_bf16 v[60:63], v[172:175], a[52:55], v[60:63]
    buffer_load_dwordx4 a[80:83], v0, s[4:7], s35 offen offset:3072 sc1
    s_waitcnt vmcnt(7)
    v_mfma_f32_16x16x32_bf16 v[44:47], v[168:171], a[56:59], v[44:47]
    v_mfma_f32_16x16x32_bf16 v[48:51], v[252:255], a[56:59], v[48:51]
    v_mfma_f32_16x16x32_bf16 v[52:55], a[160:163], a[56:59], v[52:55]
    v_mfma_f32_16x16x32_bf16 v[56:59], a[164:167], a[56:59], v[56:59]
    s_add_u32 s52, s35, 4096
    buffer_load_dwordx4 a[84:87], v0, s[4:7], s52 offen offset:0 sc1
    v_mfma_f32_16x16x32_bf16 v[60:63], a[168:171], a[56:59], v[60:63]
    s_waitcnt vmcnt(7)
    v_mfma_f32_16x16x32_bf16 v[44:47], a[172:175], a[60:63], v[44:47]
    v_mfma_f32_16x16x32_bf16 v[48:51], a[176:179], a[60:63], v[48:51]
    v_mfma_f32_16x16x32_bf16 v[52:55], a[180:183], a[60:63], v[52:55]
    v_mfma_f32_16x16x32_bf16 v[56:59], a[184:187], a[60:63], v[56:59]
    buffer_load_dwordx4 a[88:91], v0, s[4:7], s52 offen offset:2048 sc1
    v_mfma_f32_16x16x32_bf16 v[60:63], a[188:191], a[60:63], v[60:63]
    s_waitcnt vmcnt(6)
    v_mfma_f32_16x16x32_bf16 v[44:47], a[192:195], a[64:67], v[44:47]
    s_add_u32 s19, s19, 1
    v_mov_b32 v41, s19
    v_mov_b32 v42, 0
    s_mov_b64 exec, 1
    s_cmp_eq_u32 s18, 0
    s_cbranch_scc1 interleave_layers__linear_attn_block__geglu_ffn__prompt_kernel_fl90_slow
    buffer_store_dword v41, v42, s[4:7], s40 offen
interleave_layers__linear_attn_block__geglu_ffn__prompt_kernel_fl90_join:
    s_mov_b64 exec, -1
    v_mfma_f32_16x16x32_bf16 v[48:51], a[196:199], a[64:67], v[48:51]
    v_mfma_f32_16x16x32_bf16 v[52:55], a[200:203], a[64:67], v[52:55]
    v_mfma_f32_16x16x32_bf16 v[56:59], a[204:207], a[64:67], v[56:59]
    buffer_load_dwordx4 a[92:95], v0, s[4:7], s52 offen offset:3072 sc1
    v_mfma_f32_16x16x32_bf16 v[60:63], a[208:211], a[64:67], v[60:63]
    s_waitcnt vmcnt(7)
    v_mfma_f32_16x16x32_bf16 v[44:47], a[212:215], a[68:71], v[44:47]
    v_mfma_f32_16x16x32_bf16 v[48:51], a[216:219], a[68:71], v[48:51]
    v_mfma_f32_16x16x32_bf16 v[52:55], a[220:223], a[68:71], v[52:55]
    v_mfma_f32_16x16x32_bf16 v[56:59], a[224:227], a[68:71], v[56:59]
    s_add_u32 s52, s35, 8192
    buffer_load_dwordx4 a[96:99], v0, s[4:7], s52 offen offset:1024 sc1
    v_mfma_f32_16x16x32_bf16 v[60:63], a[228:231], a[68:71], v[60:63]
    s_waitcnt vmcnt(7)
    v_mfma_f32_16x16x32_bf16 v[64:67], v[184:187], a[72:75], 0
    v_mfma_f32_16x16x32_bf16 v[68:71], v[188:191], a[72:75], 0
    v_mfma_f32_16x16x32_bf16 v[72:75], v[192:195], a[72:75], 0
    buffer_load_dwordx4 a[100:103], v0, s[4:7], s52 offen offset:2048 sc1
    v_mfma_f32_16x16x32_bf16 v[76:79], v[196:199], a[72:75], 0
    v_mfma_f32_16x16x32_bf16 v[80:83], v[200:203], a[72:75], 0
    s_waitcnt vmcnt(7)
    v_mfma_f32_16x16x32_bf16 v[64:67], v[204:207], a[76:79], v[64:67]
    v_mfma_f32_16x16x32_bf16 v[68:71], v[208:211], a[76:79], v[68:71]
    v_mfma_f32_16x16x32_bf16 v[72:75], v[212:215], a[76:79], v[72:75]
    buffer_load_dwordx4 a[104:107], v0, s[4:7], s36 offen offset:0 sc1
    v_mfma_f32_16x16x32_bf16 v[76:79], v[216:219], a[76:79], v[76:79]
    v_mfma_f32_16x16x32_bf16 v[80:83], v[220:223], a[76:79], v[80:83]
    s_waitcnt vmcnt(7)
    v_mfma_f32_16x16x32_bf16 v[64:67], v[224:227], a[80:83], v[64:67]
    v_mfma_f32_16x16x32_bf16 v[68:71], v[228:231], a[80:83], v[68:71]
    v_mfma_f32_16x16x32_bf16 v[72:75], v[232:235], a[80:83], v[72:75]
    buffer_load_dwordx4 a[108:111], v0, s[4:7], s36 offen offset:1024 sc1
    v_mfma_f32_16x16x32_bf16 v[76:79], v[236:239], a[80:83], v[76:79]
    v_mfma_f32_16x16x32_bf16 v[80:83], v[240:243], a[80:83], v[80:83]
    s_waitcnt vmcnt(7)
    v_mfma_f32_16x16x32_bf16 v[64:67], v[244:247], a[84:87], v[64:67]
    buffer_load_dword v38, v31, s[4:7], s41 offen sc1
    v_mfma_f32_16x16x32_bf16 v[68:71], v[248:251], a[84:87], v[68:71]
    v_mfma_f32_16x16x32_bf16 v[72:75], v[180:183], a[84:87], v[72:75]
    buffer_load_dwordx4 a[112:115], v0, s[4:7], s36 offen offset:3072 sc1
    v_mfma_f32_16x16x32_bf16 v[76:79], v[176:179], a[84:87], v[76:79]
    v_mfma_f32_16x16x32_bf16 v[80:83], v[172:175], a[84:87], v[80:83]
    s_waitcnt vmcnt(8)
    v_mfma_f32_16x16x32_bf16 v[64:67], v[168:171], a[88:91], v[64:67]
    v_lshlrev_b32 v124, 16, v4
    v_mfma_f32_16x16x32_bf16 v[68:71], v[252:255], a[88:91], v[68:71]
    v_and_b32 v125, 0xffff0000, v4
    s_add_u32 s52, s36, 4096
    buffer_load_dwordx4 a[116:119], v0, s[4:7], s52 offen offset:0 sc1
    v_mfma_f32_16x16x32_bf16 v[72:75], a[160:163], a[88:91], v[72:75]
    v_lshlrev_b32 v126, 16, v5
    v_mfma_f32_16x16x32_bf16 v[76:79], a[164:167], a[88:91], v[76:79]
    v_and_b32 v127, 0xffff0000, v5
    v_mfma_f32_16x16x32_bf16 v[80:83], a[168:171], a[88:91], v[80:83]
    v_lshlrev_b32 v128, 16, v6
    s_waitcnt vmcnt(7)
    v_mfma_f32_16x16x32_bf16 v[64:67], a[172:175], a[92:95], v[64:67]
    v_and_b32 v129, 0xffff0000, v6
    v_mfma_f32_16x16x32_bf16 v[68:71], a[176:179], a[92:95], v[68:71]
    v_lshlrev_b32 v130, 16, v7
    buffer_load_dwordx4 a[120:123], v0, s[4:7], s52 offen offset:2048 sc1
    v_mfma_f32_16x16x32_bf16 v[72:75], a[180:183], a[92:95], v[72:75]
    v_and_b32 v131, 0xffff0000, v7
    v_mfma_f32_16x16x32_bf16 v[76:79], a[184:187], a[92:95], v[76:79]
    v_lshlrev_b32 v132, 16, v8
    v_mfma_f32_16x16x32_bf16 v[80:83], a[188:191], a[92:95], v[80:83]
    v_and_b32 v133, 0xffff0000, v8
    s_waitcnt vmcnt(7)
    v_mfma_f32_16x16x32_bf16 v[64:67], a[192:195], a[96:99], v[64:67]
    v_lshlrev_b32 v134, 16, v9
    v_mfma_f32_16x16x32_bf16 v[68:71], a[196:199], a[96:99], v[68:71]
    v_and_b32 v135, 0xffff0000, v9
    buffer_load_dwordx4 a[124:127], v0, s[4:7], s52 offen offset:3072 sc1
    v_mfma_f32_16x16x32_bf16 v[72:75], a[200:203], a[96:99], v[72:75]
    v_lshlrev_b32 v136, 16, v10
    v_mfma_f32_16x16x32_bf16 v[76:79], a[204:207], a[96:99], v[76:79]
    v_and_b32 v137, 0xffff0000, v10
    v_mfma_f32_16x16x32_bf16 v[80:83], a[208:211], a[96:99], v[80:83]
    v_lshlrev_b32 v138, 16, v11
    s_waitcnt vmcnt(7)
    v_mfma_f32_16x16x32_bf16 v[64:67], a[212:215], a[100:103], v[64:67]
    v_and_b32 v139, 0xffff0000, v11
    v_mfma_f32_16x16x32_bf16 v[68:71], a[216:219], a[100:103], v[68:71]
    v_lshlrev_b32 v140, 16, v12
    s_add_u32 s52, s36, 8192
    buffer_load_dwordx4 a[128:131], v0, s[4:7], s52 offen offset:1024 sc1
    v_mfma_f32_16x16x32_bf16 v[72:75], a[220:223], a[100:103], v[72:75]
    v_and_b32 v141, 0xffff0000, v12
    v_mfma_f32_16x16x32_bf16 v[76:79], a[224:227], a[100:103], v[76:79]
    v_lshlrev_b32 v142, 16, v13
    v_mfma_f32_16x16x32_bf16 v[80:83], a[228:231], a[100:103], v[80:83]
    v_and_b32 v143, 0xffff0000, v13
    s_waitcnt vmcnt(7)
    v_mfma_f32_16x16x32_bf16 v[84:87], v[184:187], a[104:107], 0
    buffer_load_dwordx4 a[132:135], v0, s[4:7], s52 offen offset:2048 sc1
    v_mfma_f32_16x16x32_bf16 v[88:91], v[188:191], a[104:107], 0
    v_mfma_f32_16x16x32_bf16 v[92:95], v[192:195], a[104:107], 0
    v_mfma_f32_16x16x32_bf16 v[96:99], v[196:199], a[104:107], 0
    v_mfma_f32_16x16x32_bf16 v[100:103], v[200:203], a[104:107], 0
    s_waitcnt vmcnt(7)
    v_mfma_f32_16x16x32_bf16 v[84:87], v[204:207], a[108:111], v[84:87]
    s_waitcnt vmcnt(6)
    v_subrev_u32 v38, s19, v38
    v_cmp_lt_u32 vcc, 12, v38
    s_nop 1
    s_and_b64 vcc, vcc, s[68:69]
    s_cbranch_scc1 interleave_layers__linear_attn_block__geglu_ffn__prompt_kernel_aspin92
interleave_layers__linear_attn_block__geglu_ffn__prompt_kernel_adone91:
    buffer_load_dwordx4 a[136:139], v0, s[4:7], s34 offen offset:2048 sc1
    s_add_u32 s52, s34, 4096
    buffer_load_dwordx4 a[140:143], v0, s[4:7], s52 offen offset:1024 sc1
    v_mfma_f32_16x16x32_bf16 v[88:91], v[208:211], a[108:111], v[88:91]
    v_mfma_f32_16x16x32_bf16 v[92:95], v[212:215], a[108:111], v[92:95]
    v_mfma_f32_16x16x32_bf16 v[96:99], v[216:219], a[108:111], v[96:99]
    v_mfma_f32_16x16x32_bf16 v[100:103], v[220:223], a[108:111], v[100:103]
    s_add_u32 s52, s34, 8192
    buffer_load_dwordx4 a[144:147], v0, s[4:7], s52 offen offset:0 sc1
    s_waitcnt vmcnt(8)
    v_mfma_f32_16x16x32_bf16 v[84:87], v[224:227], a[112:115], v[84:87]
    v_mfma_f32_16x16x32_bf16 v[88:91], v[228:231], a[112:115], v[88:91]
    v_mfma_f32_16x16x32_bf16 v[92:95], v[232:235], a[112:115], v[92:95]
    v_mfma_f32_16x16x32_bf16 v[96:99], v[236:239], a[112:115], v[96:99]
    v_mfma_f32_16x16x32_bf16 v[100:103], v[240:243], a[112:115], v[100:103]
    buffer_load_dwordx4 a[148:151], v0, s[4:7], s52 offen offset:3072 sc1
    s_waitcnt vmcnt(8)
    v_mfma_f32_16x16x32_bf16 v[84:87], v[244:247], a[116:119], v[84:87]
    v_mfma_f32_16x16x32_bf16 v[88:91], v[248:251], a[116:119], v[88:91]
    v_mfma_f32_16x16x32_bf16 v[92:95], v[180:183], a[116:119], v[92:95]
    v_mfma_f32_16x16x32_bf16 v[96:99], v[176:179], a[116:119], v[96:99]
    v_mfma_f32_16x16x32_bf16 v[100:103], v[172:175], a[116:119], v[100:103]
    buffer_load_dwordx4 a[152:155], v0, s[4:7], s35 offen offset:2048 sc1
    s_waitcnt vmcnt(8)
    v_mfma_f32_16x16x32_bf16 v[84:87], v[168:171], a[120:123], v[84:87]
    v_mfma_f32_16x16x32_bf16 v[88:91], v[252:255], a[120:123], v[88:91]
    v_mfma_f32_16x16x32_bf16 v[92:95], a[160:163], a[120:123], v[92:95]
    v_mfma_f32_16x16x32_bf16 v[96:99], a[164:167], a[120:123], v[96:99]
    v_mfma_f32_16x16x32_bf16 v[100:103], a[168:171], a[120:123], v[100:103]
    s_add_u32 s52, s35, 4096
    buffer_load_dwordx4 a[156:159], v0, s[4:7], s52 offen offset:1024 sc1
    s_waitcnt vmcnt(8)
    v_mfma_f32_16x16x32_bf16 v[84:87], a[172:175], a[124:127], v[84:87]
    v_mfma_f32_16x16x32_bf16 v[88:91], a[176:179], a[124:127], v[88:91]
    v_mfma_f32_16x16x32_bf16 v[92:95], a[180:183], a[124:127], v[92:95]
    v_mfma_f32_16x16x32_bf16 v[96:99], a[184:187], a[124:127], v[96:99]
    s_add_u32 s52, s35, 8192
    buffer_load_dwordx4 a[40:43], v0, s[4:7], s52 offen offset:0 sc1
    v_mfma_f32_16x16x32_bf16 v[100:103], a[188:191], a[124:127], v[100:103]
    s_waitcnt vmcnt(8)
    v_mfma_f32_16x16x32_bf16 v[84:87], a[192:195], a[128:131], v[84:87]
    v_mfma_f32_16x16x32_bf16 v[88:91], a[196:199], a[128:131], v[88:91]
    v_mfma_f32_16x16x32_bf16 v[92:95], a[200:203], a[128:131], v[92:95]
    v_mfma_f32_16x16x32_bf16 v[96:99], a[204:207], a[128:131], v[96:99]
    buffer_load_dwordx4 a[44:47], v0, s[4:7], s52 offen offset:3072 sc1
    v_mfma_f32_16x16x32_bf16 v[100:103], a[208:211], a[128:131], v[100:103]
    s_waitcnt vmcnt(8)
    v_mfma_f32_16x16x32_bf16 v[84:87], a[212:215], a[132:135], v[84:87]
    v_mfma_f32_16x16x32_bf16 v[88:91], a[216:219], a[132:135], v[88:91]
    v_mfma_f32_16x16x32_bf16 v[92:95], a[220:223], a[132:135], v[92:95]
    v_mfma_f32_16x16x32_bf16 v[96:99], a[224:227], a[132:135], v[96:99]
    buffer_load_dwordx4 a[48:51], v0, s[4:7], s36 offen offset:2048 sc1
    v_mfma_f32_16x16x32_bf16 v[100:103], a[228:231], a[132:135], v[100:103]
    s_waitcnt vmcnt(8)
    v_mfma_f32_16x16x32_bf16 v[44:47], a[232:235], a[136:139], v[44:47]
    v_mfma_f32_16x16x32_bf16 v[48:51], a[236:239], a[136:139], v[48:51]
    v_mfma_f32_16x16x32_bf16 v[52:55], a[240:243], a[136:139], v[52:55]
    v_mfma_f32_16x16x32_bf16 v[56:59], a[244:247], a[136:139], v[56:59]
    s_add_u32 s52, s36, 4096
    buffer_load_dwordx4 a[52:55], v0, s[4:7], s52 offen offset:1024 sc1
    v_mfma_f32_16x16x32_bf16 v[60:63], a[248:251], a[136:139], v[60:63]
    s_waitcnt vmcnt(8)
    v_mfma_f32_16x16x32_bf16 v[44:47], a[252:255], a[140:143], v[44:47]
    v_mfma_f32_16x16x32_bf16 v[48:51], v[152:155], a[140:143], v[48:51]
    v_mfma_f32_16x16x32_bf16 v[52:55], v[156:159], a[140:143], v[52:55]
    s_add_u32 s52, s36, 8192
    buffer_load_dwordx4 a[56:59], v0, s[4:7], s52 offen offset:0 sc1
    v_mfma_f32_16x16x32_bf16 v[56:59], v[160:163], a[140:143], v[56:59]
    v_mfma_f32_16x16x32_bf16 v[60:63], v[164:167], a[140:143], v[60:63]
    s_waitcnt vmcnt(8)
    v_mfma_f32_16x16x32_bf16 v[44:47], a[0:3], a[144:147], v[44:47]
    v_mfma_f32_16x16x32_bf16 v[48:51], a[4:7], a[144:147], v[48:51]
    v_mfma_f32_16x16x32_bf16 v[52:55], a[8:11], a[144:147], v[52:55]
    buffer_load_dwordx4 a[60:63], v0, s[4:7], s52 offen offset:3072 sc1
    v_mfma_f32_16x16x32_bf16 v[56:59], a[12:15], a[144:147], v[56:59]
    v_mfma_f32_16x16x32_bf16 v[60:63], a[16:19], a[144:147], v[60:63]
    s_waitcnt vmcnt(8)
    v_mfma_f32_16x16x32_bf16 v[44:47], a[20:23], a[148:151], v[44:47]
    v_mfma_f32_16x16x32_bf16 v[48:51], a[24:27], a[148:151], v[48:51]
    v_mfma_f32_16x16x32_bf16 v[52:55], a[28:31], a[148:151], v[52:55]
    buffer_load_dwordx4 a[64:67], v0, s[4:7], s37 offen offset:0 sc1
    v_mfma_f32_16x16x32_bf16 v[56:59], a[32:35], a[148:151], v[56:59]
    v_mfma_f32_16x16x32_bf16 v[60:63], a[36:39], a[148:151], v[60:63]
    s_waitcnt vmcnt(8)
    v_mfma_f32_16x16x32_bf16 v[64:67], a[232:235], a[152:155], v[64:67]
    v_mfma_f32_16x16x32_bf16 v[68:71], a[236:239], a[152:155], v[68:71]
    v_mfma_f32_16x16x32_bf16 v[72:75], a[240:243], a[152:155], v[72:75]
    buffer_load_dwordx4 a[68:71], v0, s[4:7], s37 offen offset:1024 sc1
    v_mfma_f32_16x16x32_bf16 v[76:79], a[244:247], a[152:155], v[76:79]
    v_add_u32 v150, s86, v0
    v_mfma_f32_16x16x32_bf16 v[80:83], a[248:251], a[152:155], v[80:83]
    s_barrier
    ds_write_b128 v150, v[44:47] offset:0
    s_waitcnt vmcnt(8)
    v_mfma_f32_16x16x32_bf16 v[64:67], a[252:255], a[156:159], v[64:67]
    v_mfma_f32_16x16x32_bf16 v[68:71], v[152:155], a[156:159], v[68:71]
    buffer_load_dwordx4 a[72:75], v0, s[4:7], s37 offen offset:3072 sc1
    v_mfma_f32_16x16x32_bf16 v[72:75], v[156:159], a[156:159], v[72:75]
    ds_write_b128 v150, v[48:51] offset:1024
    v_mfma_f32_16x16x32_bf16 v[76:79], v[160:163], a[156:159], v[76:79]
    v_mfma_f32_16x16x32_bf16 v[80:83], v[164:167], a[156:159], v[80:83]
    s_waitcnt vmcnt(8)
    v_mfma_f32_16x16x32_bf16 v[64:67], a[0:3], a[40:43], v[64:67]
    v_and_b32 v144, 15, v1
    ds_write_b128 v150, v[52:55] offset:2048
    v_mfma_f32_16x16x32_bf16 v[68:71], a[4:7], a[40:43], v[68:71]
    s_add_u32 s52, s37, 4096
    buffer_load_dwordx4 a[76:79], v0, s[4:7], s52 offen offset:0 sc1
    v_mfma_f32_16x16x32_bf16 v[72:75], a[8:11], a[40:43], v[72:75]
    v_mfma_f32_16x16x32_bf16 v[76:79], a[12:15], a[40:43], v[76:79]
    ds_write_b128 v150, v[56:59] offset:3072
    v_mfma_f32_16x16x32_bf16 v[80:83], a[16:19], a[40:43], v[80:83]
    s_waitcnt vmcnt(8)
    v_mfma_f32_16x16x32_bf16 v[64:67], a[20:23], a[44:47], v[64:67]
    v_lshrrev_b32 v145, 4, v1
    v_mfma_f32_16x16x32_bf16 v[68:71], a[24:27], a[44:47], v[68:71]
    ds_write_b128 v150, v[60:63] offset:4096
    buffer_load_dwordx4 a[80:83], v0, s[4:7], s52 offen offset:2048 sc1
    v_mfma_f32_16x16x32_bf16 v[72:75], a[28:31], a[44:47], v[72:75]
    v_mfma_f32_16x16x32_bf16 v[76:79], a[32:35], a[44:47], v[76:79]
    v_mfma_f32_16x16x32_bf16 v[80:83], a[36:39], a[44:47], v[80:83]
    s_waitcnt vmcnt(8)
    v_mfma_f32_16x16x32_bf16 v[84:87], a[232:235], a[48:51], v[84:87]
    v_mul_u32_u24 v144, 1280, v144
    v_mfma_f32_16x16x32_bf16 v[88:91], a[236:239], a[48:51], v[88:91]
    buffer_load_dwordx4 a[84:87], v0, s[4:7], s52 offen offset:3072 sc1
    v_mfma_f32_16x16x32_bf16 v[92:95], a[240:243], a[48:51], v[92:95]
    v_mfma_f32_16x16x32_bf16 v[96:99], a[244:247], a[48:51], v[96:99]
    v_add_u32 v150, s87, v0
    v_mfma_f32_16x16x32_bf16 v[100:103], a[248:251], a[48:51], v[100:103]
    ds_write_b128 v150, v[64:67] offset:0
    s_waitcnt vmcnt(8)
    v_mfma_f32_16x16x32_bf16 v[84:87], a[252:255], a[52:55], v[84:87]
    v_lshl_add_u32 v146, v145, 4, v144
    s_add_u32 s52, s37, 8192
    buffer_load_dwordx4 a[88:91], v0, s[4:7], s52 offen offset:1024 sc1
    v_mfma_f32_16x16x32_bf16 v[88:91], v[152:155], a[52:55], v[88:91]
    v_mfma_f32_16x16x32_bf16 v[92:95], v[156:159], a[52:55], v[92:95]
    ds_write_b128 v150, v[68:71] offset:1024
    v_mfma_f32_16x16x32_bf16 v[96:99], v[160:163], a[52:55], v[96:99]
    v_mfma_f32_16x16x32_bf16 v[100:103], v[164:167], a[52:55], v[100:103]
    s_waitcnt vmcnt(8)
    v_mfma_f32_16x16x32_bf16 v[84:87], a[0:3], a[56:59], v[84:87]
    v_lshl_add_u32 v147, v145, 3, v144
    ds_write_b128 v150, v[72:75] offset:2048
    buffer_load_dwordx4 a[92:95], v0, s[4:7], s52 offen offset:2048 sc1
    v_mfma_f32_16x16x32_bf16 v[88:91], a[4:7], a[56:59], v[88:91]
    v_mfma_f32_16x16x32_bf16 v[92:95], a[8:11], a[56:59], v[92:95]
    v_mfma_f32_16x16x32_bf16 v[96:99], a[12:15], a[56:59], v[96:99]
    ds_write_b128 v150, v[76:79] offset:3072
    v_mfma_f32_16x16x32_bf16 v[100:103], a[16:19], a[56:59], v[100:103]
    s_waitcnt vmcnt(8)
    v_mfma_f32_16x16x32_bf16 v[84:87], a[20:23], a[60:63], v[84:87]
    buffer_load_dwordx4 a[96:99], v0, s[4:7], s37 offen offset:2048 sc1
    v_mfma_f32_16x16x32_bf16 v[88:91], a[24:27], a[60:63], v[88:91]
    ds_write_b128 v150, v[80:83] offset:4096
    v_mfma_f32_16x16x32_bf16 v[92:95], a[28:31], a[60:63], v[92:95]
    v_mfma_f32_16x16x32_bf16 v[96:99], a[32:35], a[60:63], v[96:99]
    v_mfma_f32_16x16x32_bf16 v[100:103], a[36:39], a[60:63], v[100:103]
    s_waitcnt vmcnt(8)
    v_mfma_f32_16x16x32_bf16 v[104:107], v[184:187], a[64:67], 0
    s_add_u32 s52, s37, 4096
    buffer_load_dwordx4 a[100:103], v0, s[4:7], s52 offen offset:1024 sc1
    v_mfma_f32_16x16x32_bf16 v[108:111], v[188:191], a[64:67], 0
    v_mfma_f32_16x16x32_bf16 v[112:115], v[192:195], a[64:67], 0
    v_mfma_f32_16x16x32_bf16 v[116:119], v[196:199], a[64:67], 0
    v_add_u32 v150, s88, v0
    v_mfma_f32_16x16x32_bf16 v[120:123], v[200:203], a[64:67], 0
    ds_write_b128 v150, v[84:87] offset:0
    s_add_u32 s52, s37, 8192
    buffer_load_dwordx4 a[104:107], v0, s[4:7], s52 offen offset:0 sc1
    s_waitcnt vmcnt(9)
    v_mfma_f32_16x16x32_bf16 v[104:107], v[204:207], a[68:71], v[104:107]
    v_mfma_f32_16x16x32_bf16 v[108:111], v[208:211], a[68:71], v[108:111]
    v_mfma_f32_16x16x32_bf16 v[112:115], v[212:215], a[68:71], v[112:115]
    ds_write_b128 v150, v[88:91] offset:1024
    v_mfma_f32_16x16x32_bf16 v[116:119], v[216:219], a[68:71], v[116:119]
    v_mfma_f32_16x16x32_bf16 v[120:123], v[220:223], a[68:71], v[120:123]
    buffer_load_dwordx4 a[108:111], v0, s[4:7], s52 offen offset:3072 sc1
    s_waitcnt vmcnt(9)
    v_mfma_f32_16x16x32_bf16 v[104:107], v[224:227], a[72:75], v[104:107]
    ds_write_b128 v150, v[92:95] offset:2048
    v_mfma_f32_16x16x32_bf16 v[108:111], v[228:231], a[72:75], v[108:111]
    v_mfma_f32_16x16x32_bf16 v[112:115], v[232:235], a[72:75], v[112:115]
    v_mfma_f32_16x16x32_bf16 v[116:119], v[236:239], a[72:75], v[116:119]
    ds_write_b128 v150, v[96:99] offset:3072
    v_mfma_f32_16x16x32_bf16 v[120:123], v[240:243], a[72:75], v[120:123]
    s_waitcnt vmcnt(8)
    v_mfma_f32_16x16x32_bf16 v[104:107], v[244:247], a[76:79], v[104:107]
    v_mfma_f32_16x16x32_bf16 v[108:111], v[248:251], a[76:79], v[108:111]
    ds_write_b128 v150, v[100:103] offset:4096
    v_mfma_f32_16x16x32_bf16 v[112:115], v[180:183], a[76:79], v[112:115]
    v_mfma_f32_16x16x32_bf16 v[116:119], v[176:179], a[76:79], v[116:119]
    v_mfma_f32_16x16x32_bf16 v[120:123], v[172:175], a[76:79], v[120:123]
    s_waitcnt lgkmcnt(0)
    s_barrier
    v_add_u32 v40, s89, v0
    s_waitcnt vmcnt(7)
    v_mfma_f32_16x16x32_bf16 v[104:107], v[168:171], a[80:83], v[104:107]
    ds_read_b128 v[44:47], v40 offset:0
    v_mfma_f32_16x16x32_bf16 v[108:111], v[252:255], a[80:83], v[108:111]
    v_mfma_f32_16x16x32_bf16 v[112:115], a[160:163], a[80:83], v[112:115]
    ds_read_b128 v[48:51], v40 offset:1024
    v_mfma_f32_16x16x32_bf16 v[116:119], a[164:167], a[80:83], v[116:119]
    v_mfma_f32_16x16x32_bf16 v[120:123], a[168:171], a[80:83], v[120:123]
    ds_read_b128 v[52:55], v40 offset:2048
    s_waitcnt vmcnt(6)
    v_mfma_f32_16x16x32_bf16 v[104:107], a[172:175], a[84:87], v[104:107]
    v_mfma_f32_16x16x32_bf16 v[108:111], a[176:179], a[84:87], v[108:111]
    ds_read_b128 v[56:59], v40 offset:3072
    v_mfma_f32_16x16x32_bf16 v[112:115], a[180:183], a[84:87], v[112:115]
    v_mfma_f32_16x16x32_bf16 v[116:119], a[184:187], a[84:87], v[116:119]
    v_mfma_f32_16x16x32_bf16 v[120:123], a[188:191], a[84:87], v[120:123]
    ds_read_b128 v[60:63], v40 offset:4096
    s_waitcnt vmcnt(5)
    v_mfma_f32_16x16x32_bf16 v[104:107], a[192:195], a[88:91], v[104:107]
    v_mfma_f32_16x16x32_bf16 v[108:111], a[196:199], a[88:91], v[108:111]
    ds_read_b128 v[64:67], v40 offset:5120
    v_mfma_f32_16x16x32_bf16 v[112:115], a[200:203], a[88:91], v[112:115]
    v_mfma_f32_16x16x32_bf16 v[116:119], a[204:207], a[88:91], v[116:119]
    ds_read_b128 v[68:71], v40 offset:6144
    v_mfma_f32_16x16x32_bf16 v[120:123], a[208:211], a[88:91], v[120:123]
    s_waitcnt vmcnt(4)
    v_mfma_f32_16x16x32_bf16 v[104:107], a[212:215], a[92:95], v[104:107]
    v_mfma_f32_16x16x32_bf16 v[108:111], a[216:219], a[92:95], v[108:111]
    ds_read_b128 v[72:75], v40 offset:7168
    v_mfma_f32_16x16x32_bf16 v[112:115], a[220:223], a[92:95], v[112:115]
    v_mfma_f32_16x16x32_bf16 v[116:119], a[224:227], a[92:95], v[116:119]
    ds_read_b128 v[76:79], v40 offset:8192
    v_mfma_f32_16x16x32_bf16 v[120:123], a[228:231], a[92:95], v[120:123]
    s_waitcnt vmcnt(3)
    v_mfma_f32_16x16x32_bf16 v[104:107], a[232:235], a[96:99], v[104:107]
    ds_read_b128 v[80:83], v40 offset:9216
    v_mfma_f32_16x16x32_bf16 v[108:111], a[236:239], a[96:99], v[108:111]
    v_mfma_f32_16x16x32_bf16 v[112:115], a[240:243], a[96:99], v[112:115]
    v_mfma_f32_16x16x32_bf16 v[116:119], a[244:247], a[96:99], v[116:119]
    ds_read_b128 v[84:87], v40 offset:10240
    v_mfma_f32_16x16x32_bf16 v[120:123], a[248:251], a[96:99], v[120:123]
    s_waitcnt vmcnt(2)
    v_mfma_f32_16x16x32_bf16 v[104:107], a[252:255], a[100:103], v[104:107]
    ds_read_b128 v[88:91], v40 offset:11264
    v_mfma_f32_16x16x32_bf16 v[108:111], v[152:155], a[100:103], v[108:111]
    v_mfma_f32_16x16x32_bf16 v[112:115], v[156:159], a[100:103], v[112:115]
    ds_read_b128 v[92:95], v40 offset:12288
    v_mfma_f32_16x16x32_bf16 v[116:119], v[160:163], a[100:103], v[116:119]
    v_mfma_f32_16x16x32_bf16 v[120:123], v[164:167], a[100:103], v[120:123]
    ds_read_b128 v[96:99], v40 offset:13312
    s_waitcnt vmcnt(1)
    v_mfma_f32_16x16x32_bf16 v[104:107], a[0:3], a[104:107], v[104:107]
    v_mfma_f32_16x16x32_bf16 v[108:111], a[4:7], a[104:107], v[108:111]
    v_mfma_f32_16x16x32_bf16 v[112:115], a[8:11], a[104:107], v[112:115]
    ds_read_b128 v[100:103], v40 offset:14336
    v_mfma_f32_16x16x32_bf16 v[116:119], a[12:15], a[104:107], v[116:119]
    v_mfma_f32_16x16x32_bf16 v[120:123], a[16:19], a[104:107], v[120:123]
    s_waitcnt vmcnt(0)
    v_mfma_f32_16x16x32_bf16 v[104:107], a[20:23], a[108:111], v[104:107]
    v_mfma_f32_16x16x32_bf16 v[108:111], a[24:27], a[108:111], v[108:111]
    v_mfma_f32_16x16x32_bf16 v[112:115], a[28:31], a[108:111], v[112:115]
    v_mfma_f32_16x16x32_bf16 v[116:119], a[32:35], a[108:111], v[116:119]
    v_mfma_f32_16x16x32_bf16 v[120:123], a[36:39], a[108:111], v[120:123]
    s_waitcnt lgkmcnt(10)
    v_pk_add_f32 v[124:125], v[124:125], v[44:45]
    v_pk_add_f32 v[126:127], v[126:127], v[46:47]
    v_pk_add_f32 v[128:129], v[128:129], v[48:49]
    v_pk_add_f32 v[130:131], v[130:131], v[50:51]
    v_pk_add_f32 v[132:133], v[132:133], v[52:53]
    v_pk_add_f32 v[134:135], v[134:135], v[54:55]
    v_pk_add_f32 v[136:137], v[136:137], v[56:57]
    v_pk_add_f32 v[138:139], v[138:139], v[58:59]
    v_pk_add_f32 v[140:141], v[140:141], v[60:61]
    v_pk_add_f32 v[142:143], v[142:143], v[62:63]
    s_waitcnt lgkmcnt(5)
    v_pk_add_f32 v[124:125], v[124:125], v[64:65]
    v_pk_add_f32 v[126:127], v[126:127], v[66:67]
    v_pk_add_f32 v[128:129], v[128:129], v[68:69]
    v_pk_add_f32 v[130:131], v[130:131], v[70:71]
    v_pk_add_f32 v[132:133], v[132:133], v[72:73]
    v_pk_add_f32 v[134:135], v[134:135], v[74:75]
    v_pk_add_f32 v[136:137], v[136:137], v[76:77]
    v_pk_add_f32 v[138:139], v[138:139], v[78:79]
    v_pk_add_f32 v[140:141], v[140:141], v[80:81]
    v_pk_add_f32 v[142:143], v[142:143], v[82:83]
    s_waitcnt lgkmcnt(0)
    v_pk_add_f32 v[124:125], v[124:125], v[84:85]
    v_pk_add_f32 v[126:127], v[126:127], v[86:87]
    v_pk_add_f32 v[128:129], v[128:129], v[88:89]
    v_pk_add_f32 v[130:131], v[130:131], v[90:91]
    v_pk_add_f32 v[132:133], v[132:133], v[92:93]
    v_pk_add_f32 v[134:135], v[134:135], v[94:95]
    v_pk_add_f32 v[136:137], v[136:137], v[96:97]
    v_pk_add_f32 v[138:139], v[138:139], v[98:99]
    v_pk_add_f32 v[140:141], v[140:141], v[100:101]
    v_pk_add_f32 v[142:143], v[142:143], v[102:103]
    v_pk_add_f32 v[124:125], v[124:125], v[104:105]
    v_pk_add_f32 v[126:127], v[126:127], v[106:107]
    v_pk_add_f32 v[128:129], v[128:129], v[108:109]
    v_pk_add_f32 v[130:131], v[130:131], v[110:111]
    v_pk_add_f32 v[132:133], v[132:133], v[112:113]
    v_pk_add_f32 v[134:135], v[134:135], v[114:115]
    v_pk_add_f32 v[136:137], v[136:137], v[116:117]
    v_pk_add_f32 v[138:139], v[138:139], v[118:119]
    v_pk_add_f32 v[140:141], v[140:141], v[120:121]
    v_pk_add_f32 v[142:143], v[142:143], v[122:123]
    v_cvt_pk_bf16_f32 v4, v124, v125
    v_cvt_pk_bf16_f32 v5, v126, v127
    v_cvt_pk_bf16_f32 v6, v128, v129
    v_cvt_pk_bf16_f32 v7, v130, v131
    v_cvt_pk_bf16_f32 v8, v132, v133
    v_cvt_pk_bf16_f32 v9, v134, v135
    v_cvt_pk_bf16_f32 v10, v136, v137
    v_cvt_pk_bf16_f32 v11, v138, v139
    v_cvt_pk_bf16_f32 v12, v140, v141
    v_cvt_pk_bf16_f32 v13, v142, v143
    buffer_store_dwordx4 v[4:7], v146, s[8:11], s39 offen
    buffer_store_dwordx4 v[8:11], v146, s[8:11], s39 offen offset:64
    buffer_store_dwordx2 v[12:13], v147, s[8:11], s39 offen offset:128
interleave_layers__linear_attn_block__geglu_ffn__prompt_kernel_end:
    s_endpgm
interleave_layers__linear_attn_block__geglu_ffn__prompt_kernel_aspin16:
    s_mov_b32 s72, 0x20000
    s_mov_b64 exec, s[90:91]
interleave_layers__linear_attn_block__geglu_ffn__prompt_kernel_poll17:
    buffer_load_dword v41, v31, s[4:7], s41 offen sc1
    s_waitcnt vmcnt(0)
    v_subrev_u32 v42, s19, v41
    v_cmp_lt_u32 vcc, 12, v42
    s_cbranch_vccz interleave_layers__linear_attn_block__geglu_ffn__prompt_kernel_pdone18
    s_sub_u32 s72, s72, 1
    s_cbranch_scc0 interleave_layers__linear_attn_block__geglu_ffn__prompt_kernel_poll17
    s_branch interleave_layers__linear_attn_block__geglu_ffn__prompt_kernel_end
interleave_layers__linear_attn_block__geglu_ffn__prompt_kernel_pdone18:
    s_mov_b64 exec, -1
    v_mov_b32 v40, v42
    s_nop 1
    s_branch interleave_layers__linear_attn_block__geglu_ffn__prompt_kernel_adone15
interleave_layers__linear_attn_block__geglu_ffn__prompt_kernel_aspin21:
    s_mov_b32 s72, 0x20000
    s_mov_b64 exec, 0xffff
interleave_layers__linear_attn_block__geglu_ffn__prompt_kernel_poll22:
    buffer_load_dword v41, v31, s[4:7], s51 offen sc1
    s_waitcnt vmcnt(0)
    v_subrev_u32 v42, s19, v41
    v_cmp_lt_u32 vcc, 7, v42
    s_cbranch_vccz interleave_layers__linear_attn_block__geglu_ffn__prompt_kernel_pdone23
    s_sub_u32 s72, s72, 1
    s_cbranch_scc0 interleave_layers__linear_attn_block__geglu_ffn__prompt_kernel_poll22
    s_branch interleave_layers__linear_attn_block__geglu_ffn__prompt_kernel_end
interleave_layers__linear_attn_block__geglu_ffn__prompt_kernel_pdone23:
    s_mov_b64 exec, -1
    v_mov_b32 v38, v42
    s_nop 1
    s_branch interleave_layers__linear_attn_block__geglu_ffn__prompt_kernel_adone20
interleave_layers__linear_attn_block__geglu_ffn__prompt_kernel_aspin25:
    s_mov_b32 s72, 0x20000
    s_mov_b64 exec, s[64:65]
interleave_layers__linear_attn_block__geglu_ffn__prompt_kernel_poll26:
    buffer_load_dword v41, v31, s[4:7], s43 offen sc1
    s_waitcnt vmcnt(0)
    v_subrev_u32 v42, s48, v41
    v_cmp_lt_u32 vcc, 3, v42
    s_cbranch_vccz interleave_layers__linear_attn_block__geglu_ffn__prompt_kernel_pdone27
    s_sub_u32 s72, s72, 1
    s_cbranch_scc0 interleave_layers__linear_attn_block__geglu_ffn__prompt_kernel_poll26
    s_branch interleave_layers__linear_attn_block__geglu_ffn__prompt_kernel_end
interleave_layers__linear_attn_block__geglu_ffn__prompt_kernel_pdone27:
    s_mov_b64 exec, -1
    v_mov_b32 v40, v42
    s_nop 1
    s_branch interleave_layers__linear_attn_block__geglu_ffn__prompt_kernel_adone24
interleave_layers__linear_attn_block__geglu_ffn__prompt_kernel_aspin29:
    s_mov_b32 s72, 0x20000
    s_mov_b64 exec, s[64:65]
interleave_layers__linear_attn_block__geglu_ffn__prompt_kernel_poll30:
    buffer_load_dword v41, v31, s[4:7], s51 offen sc1
    s_waitcnt vmcnt(0)
    v_subrev_u32 v42, s48, v41
    v_cmp_lt_u32 vcc, 3, v42
    s_cbranch_vccz interleave_layers__linear_attn_block__geglu_ffn__prompt_kernel_pdone31
    s_sub_u32 s72, s72, 1
    s_cbranch_scc0 interleave_layers__linear_attn_block__geglu_ffn__prompt_kernel_poll30
    s_branch interleave_layers__linear_attn_block__geglu_ffn__prompt_kernel_end
interleave_layers__linear_attn_block__geglu_ffn__prompt_kernel_pdone31:
    s_mov_b64 exec, -1
    v_mov_b32 v38, v42
    s_nop 1
    s_branch interleave_layers__linear_attn_block__geglu_ffn__prompt_kernel_adone28
interleave_layers__linear_attn_block__geglu_ffn__prompt_kernel_c3x34:
    v_pk_add_f32 v[172:173], v[172:173], v[176:177]
    v_pk_add_f32 v[174:175], v[174:175], v[178:179]
    s_lshl_b32 s48, s14, 10
    s_add_u32 s48, s48, 153600
    v_add_u32 v176, s48, v0
    ds_write_b128 v176, v[172:175]
    v_lshrrev_b32 v176, 2, v29
    v_add_u32 v177, 153600, v176
    s_waitcnt lgkmcnt(0)
    s_barrier
    ds_read_b32 v172, v177 offset:0
    ds_read_b32 v173, v177 offset:1024
    ds_read_b32 v174, v177 offset:2048
    ds_read_b32 v175, v177 offset:3072
    v_cmp_gt_u32 vcc, 768, v176
    v_add_u32 v176, 147968, v176
    s_waitcnt lgkmcnt(0)
    v_pk_add_f32 v[172:173], v[172:173], v[174:175]
    v_add_f32 v172, v172, v173
    s_mov_b64 exec, vcc
    ds_write_b32 v176, v172
    s_mov_b64 exec, -1
    s_waitcnt lgkmcnt(0)
    s_branch interleave_layers__linear_attn_block__geglu_ffn__prompt_kernel_c333
interleave_layers__linear_attn_block__geglu_ffn__prompt_kernel_aspin36:
    s_mov_b32 s72, 0x20000
    s_mov_b64 exec, s[64:65]
interleave_layers__linear_attn_block__geglu_ffn__prompt_kernel_poll37:
    buffer_load_dword v41, v31, s[4:7], s43 offen sc1
    s_waitcnt vmcnt(0)
    v_subrev_u32 v42, s75, v41
    v_cmp_lt_u32 vcc, 3, v42
    s_cbranch_vccz interleave_layers__linear_attn_block__geglu_ffn__prompt_kernel_pdone38
    s_sub_u32 s72, s72, 1
    s_cbranch_scc0 interleave_layers__linear_attn_block__geglu_ffn__prompt_kernel_poll37
    s_branch interleave_layers__linear_attn_block__geglu_ffn__prompt_kernel_end
interleave_layers__linear_attn_block__geglu_ffn__prompt_kernel_pdone38:
    s_mov_b64 exec, -1
    v_mov_b32 v38, v42
    s_nop 1
    s_branch interleave_layers__linear_attn_block__geglu_ffn__prompt_kernel_adone35
interleave_layers__linear_attn_block__geglu_ffn__prompt_kernel_os40_slow:
    buffer_store_dwordx4 v[64:67], v0, s[4:7], s28 offen sc1
    buffer_store_dwordx4 v[72:75], v0, s[4:7], s48 offen sc1
    s_mov_b32 exec_hi, 0
    buffer_store_dwordx2 v[68:69], v15, s[4:7], s28 offen offset:1024 sc1
    buffer_store_dwordx2 v[76:77], v15, s[4:7], s48 offen offset:1024 sc1
    s_branch interleave_layers__linear_attn_block__geglu_ffn__prompt_kernel_os40_join
interleave_layers__linear_attn_block__geglu_ffn__prompt_kernel_fl41_slow:
    buffer_store_dword v41, v42, s[4:7], s40 offen sc1
    s_branch interleave_layers__linear_attn_block__geglu_ffn__prompt_kernel_fl41_join
interleave_layers__linear_attn_block__geglu_ffn__prompt_kernel_xs46_slow:
    buffer_store_dwordx4 v[4:7], v0, s[4:7], s25 offen sc1
    s_nop 4
    s_branch interleave_layers__linear_attn_block__geglu_ffn__prompt_kernel_xs46_join
interleave_layers__linear_attn_block__geglu_ffn__prompt_kernel_fl48_slow:
    buffer_store_dword v41, v42, s[4:7], s40 offen sc1
    s_branch interleave_layers__linear_attn_block__geglu_ffn__prompt_kernel_fl48_join
interleave_layers__linear_attn_block__geglu_ffn__prompt_kernel_xs49_slow:
    buffer_store_dwordx4 v[8:11], v0, s[4:7], s66 offen sc1
    buffer_store_dwordx2 v[12:13], v15, s[4:7], s66 offen offset:1024 sc1
    s_nop 0
    s_branch interleave_layers__linear_attn_block__geglu_ffn__prompt_kernel_xs49_join
interleave_layers__linear_attn_block__geglu_ffn__prompt_kernel_aspin51:
    s_mov_b32 s72, 0x20000
    s_mov_b64 exec, s[70:71]
interleave_layers__linear_attn_block__geglu_ffn__prompt_kernel_poll52:
    buffer_load_dword v41, v31, s[4:7], s41 offen sc1
    s_waitcnt vmcnt(0)
    v_subrev_u32 v42, s19, v41
    v_cmp_lt_u32 vcc, 12, v42
    s_cbranch_vccz interleave_layers__linear_attn_block__geglu_ffn__prompt_kernel_pdone53
    s_sub_u32 s72, s72, 1
    s_cbranch_scc0 interleave_layers__linear_attn_block__geglu_ffn__prompt_kernel_poll52
    s_branch interleave_layers__linear_attn_block__geglu_ffn__prompt_kernel_end
interleave_layers__linear_attn_block__geglu_ffn__prompt_kernel_pdone53:
    s_mov_b64 exec, -1
    v_mov_b32 v38, v42
    s_nop 1
    s_branch interleave_layers__linear_attn_block__geglu_ffn__prompt_kernel_adone50
interleave_layers__linear_attn_block__geglu_ffn__prompt_kernel_ss54_slow:
    buffer_store_dwordx2 v[144:145], v0, s[4:7], s27 offen sc1
    s_branch interleave_layers__linear_attn_block__geglu_ffn__prompt_kernel_ss54_join
interleave_layers__linear_attn_block__geglu_ffn__prompt_kernel_fl55_slow:
    buffer_store_dword v41, v42, s[4:7], s40 offen sc1
    s_branch interleave_layers__linear_attn_block__geglu_ffn__prompt_kernel_fl55_join
interleave_layers__linear_attn_block__geglu_ffn__prompt_kernel_aspin57:
    s_mov_b32 s72, 0x20000
    s_mov_b64 exec, s[70:71]
interleave_layers__linear_attn_block__geglu_ffn__prompt_kernel_poll58:
    buffer_load_dword v41, v31, s[4:7], s41 offen sc1
    s_waitcnt vmcnt(0)
    v_subrev_u32 v42, s19, v41
    v_cmp_lt_u32 vcc, 12, v42
    s_cbranch_vccz interleave_layers__linear_attn_block__geglu_ffn__prompt_kernel_pdone59
    s_sub_u32 s72, s72, 1
    s_cbranch_scc0 interleave_layers__linear_attn_block__geglu_ffn__prompt_kernel_poll58
    s_branch interleave_layers__linear_attn_block__geglu_ffn__prompt_kernel_end
interleave_layers__linear_attn_block__geglu_ffn__prompt_kernel_pdone59:
    s_mov_b64 exec, -1
    v_mov_b32 v38, v42
    s_nop 1
    s_branch interleave_layers__linear_attn_block__geglu_ffn__prompt_kernel_adone56
interleave_layers__linear_attn_block__geglu_ffn__prompt_kernel_fl66_slow:
    buffer_store_dword v41, v42, s[4:7], s40 offen sc1
    s_branch interleave_layers__linear_attn_block__geglu_ffn__prompt_kernel_fl66_join
interleave_layers__linear_attn_block__geglu_ffn__prompt_kernel_aspin68:
    s_mov_b32 s72, 0x20000
    s_mov_b64 exec, s[68:69]
interleave_layers__linear_attn_block__geglu_ffn__prompt_kernel_poll69:
    buffer_load_dword v41, v31, s[4:7], s41 offen sc1
    s_waitcnt vmcnt(0)
    v_subrev_u32 v42, s19, v41
    v_cmp_lt_u32 vcc, 12, v42
    s_cbranch_vccz interleave_layers__linear_attn_block__geglu_ffn__prompt_kernel_pdone70
    s_sub_u32 s72, s72, 1
    s_cbranch_scc0 interleave_layers__linear_attn_block__geglu_ffn__prompt_kernel_poll69
    s_branch interleave_layers__linear_attn_block__geglu_ffn__prompt_kernel_end
interleave_layers__linear_attn_block__geglu_ffn__prompt_kernel_pdone70:
    s_mov_b64 exec, -1
    v_mov_b32 v38, v42
    s_nop 1
    s_branch interleave_layers__linear_attn_block__geglu_ffn__prompt_kernel_adone67
interleave_layers__linear_attn_block__geglu_ffn__prompt_kernel_fl72_slow:
    buffer_store_dword v41, v42, s[4:7], s40 offen sc1
    s_nop 0
    s_branch interleave_layers__linear_attn_block__geglu_ffn__prompt_kernel_fl72_join
interleave_layers__linear_attn_block__geglu_ffn__prompt_kernel_aspin74:
    s_mov_b32 s72, 0x20000
    s_mov_b64 exec, s[68:69]
interleave_layers__linear_attn_block__geglu_ffn__prompt_kernel_poll75:
    buffer_load_dword v41, v31, s[4:7], s41 offen sc1
    s_waitcnt vmcnt(0)
    v_subrev_u32 v42, s19, v41
    v_cmp_lt_u32 vcc, 12, v42
    s_cbranch_vccz interleave_layers__linear_attn_block__geglu_ffn__prompt_kernel_pdone76
    s_sub_u32 s72, s72, 1
    s_cbranch_scc0 interleave_layers__linear_attn_block__geglu_ffn__prompt_kernel_poll75
    s_branch interleave_layers__linear_attn_block__geglu_ffn__prompt_kernel_end
interleave_layers__linear_attn_block__geglu_ffn__prompt_kernel_pdone76:
    s_mov_b64 exec, -1
    v_mov_b32 v38, v42
    s_nop 1
    s_branch interleave_layers__linear_attn_block__geglu_ffn__prompt_kernel_adone73
interleave_layers__linear_attn_block__geglu_ffn__prompt_kernel_xs77_slow:
    buffer_store_dwordx4 v[4:7], v0, s[4:7], s25 offen sc1
    s_nop 4
    s_branch interleave_layers__linear_attn_block__geglu_ffn__prompt_kernel_xs77_join
interleave_layers__linear_attn_block__geglu_ffn__prompt_kernel_fl78_slow:
    buffer_store_dword v41, v42, s[4:7], s40 offen sc1
    s_branch interleave_layers__linear_attn_block__geglu_ffn__prompt_kernel_fl78_join
interleave_layers__linear_attn_block__geglu_ffn__prompt_kernel_xs79_slow:
    buffer_store_dwordx4 v[8:11], v0, s[4:7], s66 offen sc1
    buffer_store_dwordx2 v[12:13], v15, s[4:7], s66 offen offset:1024 sc1
    s_nop 0
    s_branch interleave_layers__linear_attn_block__geglu_ffn__prompt_kernel_xs79_join
interleave_layers__linear_attn_block__geglu_ffn__prompt_kernel_aspin81:
    s_mov_b32 s72, 0x20000
    s_mov_b64 exec, s[70:71]
interleave_layers__linear_attn_block__geglu_ffn__prompt_kernel_poll82:
    buffer_load_dword v41, v31, s[4:7], s41 offen sc1
    s_waitcnt vmcnt(0)
    v_subrev_u32 v42, s19, v41
    v_cmp_lt_u32 vcc, 12, v42
    s_cbranch_vccz interleave_layers__linear_attn_block__geglu_ffn__prompt_kernel_pdone83
    s_sub_u32 s72, s72, 1
    s_cbranch_scc0 interleave_layers__linear_attn_block__geglu_ffn__prompt_kernel_poll82
    s_branch interleave_layers__linear_attn_block__geglu_ffn__prompt_kernel_end
interleave_layers__linear_attn_block__geglu_ffn__prompt_kernel_pdone83:
    s_mov_b64 exec, -1
    v_mov_b32 v38, v42
    s_nop 1
    s_branch interleave_layers__linear_attn_block__geglu_ffn__prompt_kernel_adone80
interleave_layers__linear_attn_block__geglu_ffn__prompt_kernel_ss84_slow:
    buffer_store_dwordx2 v[144:145], v0, s[4:7], s27 offen sc1
    s_branch interleave_layers__linear_attn_block__geglu_ffn__prompt_kernel_ss84_join
interleave_layers__linear_attn_block__geglu_ffn__prompt_kernel_fl85_slow:
    buffer_store_dword v41, v42, s[4:7], s40 offen sc1
    s_branch interleave_layers__linear_attn_block__geglu_ffn__prompt_kernel_fl85_join
interleave_layers__linear_attn_block__geglu_ffn__prompt_kernel_aspin87:
    s_mov_b32 s72, 0x20000
    s_mov_b64 exec, s[70:71]
interleave_layers__linear_attn_block__geglu_ffn__prompt_kernel_poll88:
    buffer_load_dword v41, v31, s[4:7], s41 offen sc1
    s_waitcnt vmcnt(0)
    v_subrev_u32 v42, s19, v41
    v_cmp_lt_u32 vcc, 12, v42
    s_cbranch_vccz interleave_layers__linear_attn_block__geglu_ffn__prompt_kernel_pdone89
    s_sub_u32 s72, s72, 1
    s_cbranch_scc0 interleave_layers__linear_attn_block__geglu_ffn__prompt_kernel_poll88
    s_branch interleave_layers__linear_attn_block__geglu_ffn__prompt_kernel_end
interleave_layers__linear_attn_block__geglu_ffn__prompt_kernel_pdone89:
    s_mov_b64 exec, -1
    v_mov_b32 v38, v42
    s_nop 1
    s_branch interleave_layers__linear_attn_block__geglu_ffn__prompt_kernel_adone86
interleave_layers__linear_attn_block__geglu_ffn__prompt_kernel_fl90_slow:
    buffer_store_dword v41, v42, s[4:7], s40 offen sc1
    s_nop 0
    s_branch interleave_layers__linear_attn_block__geglu_ffn__prompt_kernel_fl90_join
interleave_layers__linear_attn_block__geglu_ffn__prompt_kernel_aspin92:
    s_mov_b32 s72, 0x20000
    s_mov_b64 exec, s[68:69]
interleave_layers__linear_attn_block__geglu_ffn__prompt_kernel_poll93:
    buffer_load_dword v41, v31, s[4:7], s41 offen sc1
    s_waitcnt vmcnt(0)
    v_subrev_u32 v42, s19, v41
    v_cmp_lt_u32 vcc, 12, v42
    s_cbranch_vccz interleave_layers__linear_attn_block__geglu_ffn__prompt_kernel_pdone94
    s_sub_u32 s72, s72, 1
    s_cbranch_scc0 interleave_layers__linear_attn_block__geglu_ffn__prompt_kernel_poll93
    s_branch interleave_layers__linear_attn_block__geglu_ffn__prompt_kernel_end
interleave_layers__linear_attn_block__geglu_ffn__prompt_kernel_pdone94:
    s_mov_b64 exec, -1
    v_mov_b32 v38, v42
    s_nop 1
    s_branch interleave_layers__linear_attn_block__geglu_ffn__prompt_kernel_adone91
.section .rodata,"a"
.p2align 6

.amdhsa_kernel interleave_layers__linear_attn_block__geglu_ffn__prompt_kernel
  .amdhsa_next_free_vgpr 512
  .amdhsa_next_free_sgpr 102
  .amdhsa_accum_offset 256
  .amdhsa_group_segment_fixed_size 0
  .amdhsa_kernarg_size 80
  .amdhsa_user_sgpr_count 2
  .amdhsa_user_sgpr_kernarg_segment_ptr 1
  .amdhsa_system_sgpr_workgroup_id_x 1
.end_amdhsa_kernel
```
